```python
import torch

def _softmax(x, axis=-1):
    return torch.softmax(x, dim=axis)

def _gelu(x):
    return torch.nn.functional.gelu(x, approximate='tanh')

def _silu(x):
    return torch.nn.functional.silu(x)

def _sigmoid(x):
    return torch.sigmoid(x)

def _layernorm(x, axis=-1, eps=1e-05):
    m = x.mean(dim=axis, keepdim=True)
    v = x.var(dim=axis, keepdim=True, unbiased=False)
    return (x - m) / torch.sqrt(v + eps)

def _scatter_add(tgt, idx, src, axis=0):
    return tgt.clone().index_add_(axis, idx, src)

def _segment_sum(src, seg, n):
    out = torch.zeros((n,) + src.shape[1:], dtype=src.dtype)
    return out.index_add_(0, seg, src)

def _pad(x, pw):
    flat = tuple((v for pair in reversed(pw) for v in pair))
    return torch.nn.functional.pad(x, flat)
kernel_name = 'adaLN_cond__sliding_block__glu_gated_glu__prompt'

def setup_inputs():

    _w = lambda a: (lambda t: t.to(torch.bfloat16) if t.is_floating_point() else t)(torch.as_tensor(a))

    def _A_setup():
        B, S, D = (1, 2048, 640)
        return {'x': _w((lambda *s: torch.randn(*s, dtype=torch.bfloat16) * 0.05)(B, S, D)), 'wqkv': _w((lambda *s: torch.randn(*s, dtype=torch.bfloat16) * 0.05)(D, 3 * D)), 'wo': _w((lambda *s: torch.randn(*s, dtype=torch.bfloat16) * 0.05)(D, D))}
    _A_in = _A_setup()

    def _B_setup():
        B, S, D, F = (1, 2048, 640, 1536)
        return {'x': _w((lambda *s: torch.randn(*s, dtype=torch.bfloat16) * 0.05)(B, S, D)), 'w_gate': _w((lambda *s: torch.randn(*s, dtype=torch.bfloat16) * 0.05)(D, F)), 'w_up': _w((lambda *s: torch.randn(*s, dtype=torch.bfloat16) * 0.05)(D, F)), 'w_down': _w((lambda *s: torch.randn(*s, dtype=torch.bfloat16) * 0.05)(F, D))}
    _B_in = _B_setup()
    return {'A_x': _A_in['x'], 'A_wqkv': _A_in['wqkv'], 'A_wo': _A_in['wo'], 'B_x': _B_in['x'], 'B_w_gate': _B_in['w_gate'], 'B_w_up': _B_in['w_up'], 'B_w_down': _B_in['w_down'], 'c': _w((lambda *s: torch.randn(*s, dtype=torch.bfloat16) * 0.1)(1, 640) * 8.0), 'w_mod': _w((lambda *s: torch.randn(*s, dtype=torch.bfloat16) * 0.1)(640, 6 * 640) * 640 ** (-0.5) * 8.0)}

def reference(A_x, A_wqkv, A_wo, B_x, B_w_gate, B_w_up, B_w_down, c, w_mod):

    def _A_ref(x, wqkv, wo):
        B, S, D = x.shape
        H = 32
        Dh = D // H
        W = 256
        qkv = (lambda x, *d: x.permute(*d))((x @ wqkv).reshape(B, S, 3, H, Dh), 2, 0, 3, 1, 4)
        q, k, v = (qkv[0], qkv[1], qkv[2])
        scores = torch.einsum('bhqd,bhkd->bhqk', q, k) * Dh ** (-0.5)
        idx = torch.arange(S)
        mask = (idx[:, None] - idx[None, :] >= 0) & (idx[:, None] - idx[None, :] < W)
        scores = torch.where(mask[None, None], scores, -1000000000.0)
        p = _softmax(scores, axis=-1)
        o = torch.einsum('bhqk,bhkd->bhqd', p, v)
        return (lambda x, *d: x.permute(*d))(o, 0, 2, 1, 3).reshape(B, S, D) @ wo

    def _B_ref(x, w_gate, w_up, w_down):
        g = torch.einsum('bsd,df->bsf', x, w_gate)
        u = torch.einsum('bsd,df->bsf', x, w_up)
        h = _sigmoid(g) * u
        return torch.einsum('bsf,fd->bsd', h, w_down)
    x = A_x
    mod = (_silu(c) @ w_mod).reshape(c.shape[0], 6, 1, -1)
    sa, ca, ga, sb, cb, gb = (mod[:, 0].clone(), mod[:, 1].clone(), mod[:, 2].clone(), mod[:, 3].clone(), mod[:, 4].clone(), mod[:, 5].clone())
    h = _layernorm(x, axis=-1) * (1 + ca) + sa
    x = x + ga * _A_ref(h, A_wqkv, A_wo)
    h = _layernorm(x, axis=-1) * (1 + cb) + sb
    x = x + gb * _B_ref(h, B_w_gate, B_w_up, B_w_down)
    return x
```

```asm
; @launch grid=(256,1,1) block=(512,1,1) lds=163840
.amdgcn_target "amdgcn-amd-amdhsa--gfx950"
.text
.globl adaLN_cond__sliding_block__glu_gated_glu__prompt_kernel
.p2align 8
.type adaLN_cond__sliding_block__glu_gated_glu__prompt_kernel,@function
adaLN_cond__sliding_block__glu_gated_glu__prompt_kernel:
  s_cmp_ge_u32 s2, 256
  s_cbranch_scc1 L_end
  s_getpc_b64 s[68:69]
L_pc:
  s_load_dwordx2 s[40:41], s[0:1], 64
  s_load_dwordx2 s[36:37], s[0:1], 56
  s_load_dwordx2 s[12:13], s[0:1], 88
  s_load_dwordx2 s[4:5], s[0:1], 0
  v_lshrrev_b32 v2, 6, v0
  s_lshr_b32 s55, s2, 3
  v_readfirstlane_b32 s56, v2
  v_and_b32 v1, 63, v0
  s_and_b32 s54, s2, 7
  s_and_b32 s57, s56, 3
  s_cmp_ge_u32 s56, 4
  v_lshlrev_b32 v0, 4, v1
  s_cbranch_scc0 L_compute
  s_lshl_b32 s60, s55, 2
  s_add_u32 s60, s60, s57
  s_lshl_b32 s60, s60, 9
  v_and_b32 v2, 7, v1
  v_lshl_add_u32 v2, v2, 6, s60
  v_min_u32 v2, L_end-L_pc, v2
  global_load_dword v3, v2, s[68:69]
  s_branch L_helper
L_compute:
  v_lshrrev_b32 v2, 1, v1
  s_lshl_b32 s60, s57, 5
  v_add_u32 v2, s60, v2
  v_lshlrev_b32 v29, 1, v2
  v_mul_u32_u24 v30, 0x1e00, v2
  v_and_b32 v2, 1, v1
  v_lshl_add_u32 v30, v2, 4, v30
  s_mov_b32 s42, 4915200
  s_mov_b32 s43, 0x20000
  s_mov_b32 s38, 1280
  s_mov_b32 s39, 0x20000
  s_mov_b32 s14, 35127296
  s_mov_b32 s15, 0x20000
  s_mov_b32 s6, 2621440
  s_mov_b32 s7, 0x20000
  s_mul_i32 s63, s54, 10
  s_mul_i32 s62, s54, 20
  s_add_u32 s62, s62, 70
  s_cmp_lt_u32 s55, 10
  s_cselect_b32 s63, s63, s62
  s_add_u32 s63, s63, s55
  s_lshl_b32 s62, s63, 5
  s_cmp_lt_u32 s55, 30
  s_cselect_b32 s62, s62, 2130706432
  v_and_b32 v45, 31, v1
  v_lshrrev_b32 v46, 5, v1
  s_lshl_b32 s60, s55, 3
  s_lshl_b32 s61, s57, 1
  s_add_u32 s60, s60, s61
  v_add_u32 v46, s60, v46
  v_mul_u32_u24 v31, 0x500, v46
  v_lshl_add_u32 v31, v45, 4, v31
  s_mul_i32 s61, s54, 327680
  v_mov_b32 v44, 2130706432
  v_cmp_gt_u32 s[70:71], 16, v45
  s_nop 1
  v_cndmask_b32_e64 v44, v44, v31, s[70:71]
  s_waitcnt lgkmcnt(0)
  s_load_dword s52, s[12:13], 0
  buffer_load_ushort v24, v29, s[36:39], 0 offen offset:0
  buffer_load_ushort v25, v29, s[36:39], 0 offen offset:256
  buffer_load_ushort v26, v29, s[36:39], 0 offen offset:512
  buffer_load_ushort v27, v29, s[36:39], 0 offen offset:768
  buffer_load_ushort v28, v29, s[36:39], 0 offen offset:1024
  buffer_load_dwordx4 v[4:7], v30, s[40:43], s62 offen
  s_add_u32 s62, s62, 983040
  buffer_load_dwordx4 v[8:11], v30, s[40:43], s62 offen
  s_add_u32 s62, s62, 983040
  buffer_load_dwordx4 v[12:15], v30, s[40:43], s62 offen
  s_add_u32 s62, s62, 983040
  buffer_load_dwordx4 v[16:19], v30, s[40:43], s62 offen
  s_add_u32 s62, s62, 983040
  buffer_load_dwordx4 v[20:23], v30, s[40:43], s62 offen
  buffer_load_dwordx4 v[32:35], v31, s[4:7], s61 offen
  buffer_load_dwordx4 v[36:39], v31, s[4:7], s61 offen offset:512
  buffer_load_dwordx4 v[40:43], v44, s[4:7], s61 offen offset:1024
  s_load_dwordx2 s[20:21], s[0:1], 8
  s_load_dwordx2 s[16:17], s[0:1], 16
  s_load_dwordx2 s[24:25], s[0:1], 32
  s_load_dwordx2 s[28:29], s[0:1], 40
  s_load_dwordx2 s[32:33], s[0:1], 48
  s_load_dwordx2 s[8:9], s[0:1], 72
  s_mov_b32 s22, 2457600
  s_mov_b32 s23, 0x20000
  s_mov_b32 s18, 819200
  s_mov_b32 s19, 0x20000
  s_mov_b32 s26, 1966080
  s_mov_b32 s27, 0x20000
  s_mov_b32 s30, 1966080
  s_mov_b32 s31, 0x20000
  s_mov_b32 s34, 1966080
  s_mov_b32 s35, 0x20000
  s_mov_b32 s10, 2621440
  s_mov_b32 s11, 0x20000
  s_getreg_b32 s58, hwreg(HW_REG_XCC_ID, 0, 4)
  s_mov_b32 s72, 0
  s_mov_b32 s73, -1
  s_lshr_b32 s77, s55, 3
  s_and_b32 s78, s55, 7
  s_waitcnt vmcnt(12)
  v_lshlrev_b32 v24, 16, v24
  s_waitcnt vmcnt(11)
  v_lshlrev_b32 v25, 16, v25
  s_waitcnt vmcnt(10)
  v_lshlrev_b32 v26, 16, v26
  s_waitcnt vmcnt(9)
  v_lshlrev_b32 v27, 16, v27
  s_waitcnt vmcnt(8)
  v_lshlrev_b32 v28, 16, v28
  v_mul_f32 v48, 0xbfb8aa3b, v24
  v_mul_f32 v49, 0xbfb8aa3b, v25
  v_mul_f32 v50, 0xbfb8aa3b, v26
  v_mul_f32 v51, 0xbfb8aa3b, v27
  v_mul_f32 v52, 0xbfb8aa3b, v28
  v_exp_f32 v48, v48
  v_exp_f32 v49, v49
  v_exp_f32 v50, v50
  v_exp_f32 v51, v51
  v_exp_f32 v52, v52
  v_add_f32 v48, 1.0, v48
  v_add_f32 v49, 1.0, v49
  v_add_f32 v50, 1.0, v50
  v_add_f32 v51, 1.0, v51
  v_add_f32 v52, 1.0, v52
  v_rcp_f32 v48, v48
  v_rcp_f32 v49, v49
  v_rcp_f32 v50, v50
  v_rcp_f32 v51, v51
  v_rcp_f32 v52, v52
  v_mul_f32 v24, v24, v48
  v_mul_f32 v25, v25, v49
  v_mul_f32 v26, v26, v50
  v_mul_f32 v27, v27, v51
  v_mul_f32 v28, v28, v52
  v_cvt_pk_bf16_f32 v48, 0, v24
  v_cvt_pk_bf16_f32 v49, 0, v25
  v_cvt_pk_bf16_f32 v50, 0, v26
  v_cvt_pk_bf16_f32 v51, 0, v27
  v_cvt_pk_bf16_f32 v52, 0, v28
  v_cvt_pk_bf16_f32 v24, v24, 0
  v_cvt_pk_bf16_f32 v25, v25, 0
  v_cvt_pk_bf16_f32 v26, v26, 0
  v_cvt_pk_bf16_f32 v27, v27, 0
  v_cvt_pk_bf16_f32 v28, v28, 0
  s_waitcnt vmcnt(7)
  v_dot2_f32_bf16 v54, v4, v24, 0
  v_dot2_f32_bf16 v55, v4, v48, 0
  v_dot2_f32_bf16 v56, v5, v24, 0
  v_dot2_f32_bf16 v57, v5, v48, 0
  v_dot2_f32_bf16 v58, v6, v24, 0
  v_dot2_f32_bf16 v59, v6, v48, 0
  v_dot2_f32_bf16 v60, v7, v24, 0
  v_dot2_f32_bf16 v61, v7, v48, 0
  s_waitcnt vmcnt(6)
  v_dot2_f32_bf16 v54, v8, v25, v54
  v_dot2_f32_bf16 v55, v8, v49, v55
  v_dot2_f32_bf16 v56, v9, v25, v56
  v_dot2_f32_bf16 v57, v9, v49, v57
  v_dot2_f32_bf16 v58, v10, v25, v58
  v_dot2_f32_bf16 v59, v10, v49, v59
  v_dot2_f32_bf16 v60, v11, v25, v60
  v_dot2_f32_bf16 v61, v11, v49, v61
  s_waitcnt vmcnt(5)
  v_dot2_f32_bf16 v54, v12, v26, v54
  v_dot2_f32_bf16 v55, v12, v50, v55
  v_dot2_f32_bf16 v56, v13, v26, v56
  v_dot2_f32_bf16 v57, v13, v50, v57
  v_dot2_f32_bf16 v58, v14, v26, v58
  v_dot2_f32_bf16 v59, v14, v50, v59
  v_dot2_f32_bf16 v60, v15, v26, v60
  v_dot2_f32_bf16 v61, v15, v50, v61
  s_waitcnt vmcnt(4)
  v_dot2_f32_bf16 v54, v16, v27, v54
  v_dot2_f32_bf16 v55, v16, v51, v55
  v_dot2_f32_bf16 v56, v17, v27, v56
  v_dot2_f32_bf16 v57, v17, v51, v57
  v_dot2_f32_bf16 v58, v18, v27, v58
  v_dot2_f32_bf16 v59, v18, v51, v59
  v_dot2_f32_bf16 v60, v19, v27, v60
  v_dot2_f32_bf16 v61, v19, v51, v61
  s_waitcnt vmcnt(3)
  v_dot2_f32_bf16 v54, v20, v28, v54
  v_dot2_f32_bf16 v55, v20, v52, v55
  v_dot2_f32_bf16 v56, v21, v28, v56
  v_dot2_f32_bf16 v57, v21, v52, v57
  v_dot2_f32_bf16 v58, v22, v28, v58
  v_dot2_f32_bf16 v59, v22, v52, v59
  v_dot2_f32_bf16 v60, v23, v28, v60
  v_dot2_f32_bf16 v61, v23, v52, v61
  v_permlane32_swap_b32 v54, v58
  v_permlane32_swap_b32 v55, v59
  v_permlane32_swap_b32 v56, v60
  v_permlane32_swap_b32 v57, v61
  v_add_f32 v54, v54, v58
  v_add_f32 v55, v55, v59
  v_add_f32 v56, v56, v60
  v_add_f32 v57, v57, v61
  s_nop 0
  v_permlane16_swap_b32 v54, v56
  v_permlane16_swap_b32 v55, v57
  v_add_f32 v30, v54, v56
  v_add_f32 v31, v55, v57
  s_nop 0
  v_add_f32_dpp v30, v30, v30 row_ror:8 row_mask:0xf bank_mask:0xf
  v_add_f32_dpp v31, v31, v31 row_ror:8 row_mask:0xf bank_mask:0xf
  s_nop 0
  v_add_f32_dpp v30, v30, v30 row_ror:4 row_mask:0xf bank_mask:0xf
  v_add_f32_dpp v31, v31, v31 row_ror:4 row_mask:0xf bank_mask:0xf
  s_nop 0
  v_add_f32_dpp v30, v30, v30 row_ror:2 row_mask:0xf bank_mask:0xf
  v_add_f32_dpp v31, v31, v31 row_ror:2 row_mask:0xf bank_mask:0xf
  v_lshlrev_b32 v2, 5, v2
  v_lshrrev_b32 v29, 4, v1
  v_lshl_add_u32 v2, v29, 3, v2
  s_lshl_b32 s60, s57, 6
  v_add_u32 v2, s60, v2
  ds_write_b64 v2, v[30:31] offset:1536
  s_waitcnt lgkmcnt(0)
  s_add_u32 s52, s52, 1
  s_not_b32 s53, s52
  s_barrier
  s_cmp_lg_u32 s57, 0
  s_cbranch_scc1 L_nopub_1
  s_mov_b64 exec, 15
  ds_read_b128 v[4:7], v0 offset:1536
  ds_read_b128 v[8:11], v0 offset:1600
  ds_read_b128 v[12:15], v0 offset:1664
  ds_read_b128 v[16:19], v0 offset:1728
  s_lshl_b32 s60, s63, 7
  s_add_u32 s60, s60, 4096
  s_cmp_lt_u32 s55, 30
  s_cselect_b32 s60, s60, 2130706432
  v_mov_b32 v22, s52
  v_mov_b32 v23, s53
  s_waitcnt lgkmcnt(2)
  v_add_f32 v4, v4, v8
  v_add_f32 v5, v5, v9
  v_add_f32 v6, v6, v10
  v_add_f32 v7, v7, v11
  s_waitcnt lgkmcnt(1)
  v_add_f32 v4, v4, v12
  v_add_f32 v5, v5, v13
  v_add_f32 v6, v6, v14
  v_add_f32 v7, v7, v15
  s_waitcnt lgkmcnt(0)
  v_add_f32 v4, v4, v16
  v_add_f32 v5, v5, v17
  v_add_f32 v6, v6, v18
  v_add_f32 v7, v7, v19
  v_cvt_pk_bf16_f32 v20, v4, v5
  v_cvt_pk_bf16_f32 v21, v6, v7
  buffer_store_dwordx4 v[20:23], v0, s[12:15], s60 offen sc1
  s_mov_b64 exec, -1
  s_waitcnt vmcnt(1)
  s_branch L_pubdone_2
L_nopub_1:
  s_waitcnt vmcnt(0)
L_pubdone_2:
  v_lshlrev_b32 v2, 16, v32
  v_and_b32 v3, 0xffff0000, v32
  v_lshlrev_b32 v4, 16, v33
  v_and_b32 v5, 0xffff0000, v33
  v_lshlrev_b32 v6, 16, v34
  v_and_b32 v7, 0xffff0000, v34
  v_lshlrev_b32 v8, 16, v35
  v_and_b32 v9, 0xffff0000, v35
  v_lshlrev_b32 v10, 16, v36
  v_and_b32 v11, 0xffff0000, v36
  v_lshlrev_b32 v12, 16, v37
  v_and_b32 v13, 0xffff0000, v37
  v_lshlrev_b32 v14, 16, v38
  v_and_b32 v15, 0xffff0000, v38
  v_lshlrev_b32 v16, 16, v39
  v_and_b32 v17, 0xffff0000, v39
  v_lshlrev_b32 v18, 16, v40
  v_and_b32 v19, 0xffff0000, v40
  v_lshlrev_b32 v20, 16, v41
  v_and_b32 v21, 0xffff0000, v41
  v_lshlrev_b32 v22, 16, v42
  v_and_b32 v23, 0xffff0000, v42
  v_lshlrev_b32 v24, 16, v43
  v_and_b32 v25, 0xffff0000, v43
  v_pk_add_f32 v[30:31], v[2:3], v[4:5]
  v_pk_add_f32 v[30:31], v[30:31], v[6:7]
  v_pk_add_f32 v[30:31], v[30:31], v[8:9]
  v_pk_add_f32 v[30:31], v[30:31], v[10:11]
  v_pk_add_f32 v[30:31], v[30:31], v[12:13]
  v_pk_add_f32 v[30:31], v[30:31], v[14:15]
  v_pk_add_f32 v[30:31], v[30:31], v[16:17]
  v_pk_add_f32 v[30:31], v[30:31], v[18:19]
  v_pk_add_f32 v[30:31], v[30:31], v[20:21]
  v_pk_add_f32 v[30:31], v[30:31], v[22:23]
  v_pk_add_f32 v[30:31], v[30:31], v[24:25]
  v_add_f32 v26, v30, v31
  s_nop 1
  v_add_f32_dpp v26, v26, v26 quad_perm:[1,0,3,2] row_mask:0xf bank_mask:0xf
  s_nop 1
  v_add_f32_dpp v26, v26, v26 quad_perm:[2,3,0,1] row_mask:0xf bank_mask:0xf
  s_nop 1
  v_add_f32_dpp v26, v26, v26 row_half_mirror row_mask:0xf bank_mask:0xf
  s_nop 1
  v_add_f32_dpp v26, v26, v26 row_mirror row_mask:0xf bank_mask:0xf
  v_mov_b32 v44, v26
  s_nop 1
  v_permlane16_swap_b32 v44, v26
  v_add_f32 v26, v26, v44
  v_mul_f32 v26, 0x3acccccd, v26
  v_cndmask_b32_e64 v28, 0, v26, s[70:71]
  v_pk_add_f32 v[2:3], v[2:3], v[26:27] op_sel_hi:[1,0] neg_lo:[0,1] neg_hi:[0,1]
  v_pk_add_f32 v[4:5], v[4:5], v[26:27] op_sel_hi:[1,0] neg_lo:[0,1] neg_hi:[0,1]
  v_pk_add_f32 v[6:7], v[6:7], v[26:27] op_sel_hi:[1,0] neg_lo:[0,1] neg_hi:[0,1]
  v_pk_add_f32 v[8:9], v[8:9], v[26:27] op_sel_hi:[1,0] neg_lo:[0,1] neg_hi:[0,1]
  v_pk_add_f32 v[10:11], v[10:11], v[26:27] op_sel_hi:[1,0] neg_lo:[0,1] neg_hi:[0,1]
  v_pk_add_f32 v[12:13], v[12:13], v[26:27] op_sel_hi:[1,0] neg_lo:[0,1] neg_hi:[0,1]
  v_pk_add_f32 v[14:15], v[14:15], v[26:27] op_sel_hi:[1,0] neg_lo:[0,1] neg_hi:[0,1]
  v_pk_add_f32 v[16:17], v[16:17], v[26:27] op_sel_hi:[1,0] neg_lo:[0,1] neg_hi:[0,1]
  v_pk_add_f32 v[18:19], v[18:19], v[28:29] op_sel_hi:[1,0] neg_lo:[0,1] neg_hi:[0,1]
  v_pk_add_f32 v[20:21], v[20:21], v[28:29] op_sel_hi:[1,0] neg_lo:[0,1] neg_hi:[0,1]
  v_pk_add_f32 v[22:23], v[22:23], v[28:29] op_sel_hi:[1,0] neg_lo:[0,1] neg_hi:[0,1]
  v_pk_add_f32 v[24:25], v[24:25], v[28:29] op_sel_hi:[1,0] neg_lo:[0,1] neg_hi:[0,1]
  v_pk_mul_f32 v[30:31], v[2:3], v[2:3]
  v_pk_fma_f32 v[30:31], v[4:5], v[4:5], v[30:31]
  v_pk_fma_f32 v[30:31], v[6:7], v[6:7], v[30:31]
  v_pk_fma_f32 v[30:31], v[8:9], v[8:9], v[30:31]
  v_pk_fma_f32 v[30:31], v[10:11], v[10:11], v[30:31]
  v_pk_fma_f32 v[30:31], v[12:13], v[12:13], v[30:31]
  v_pk_fma_f32 v[30:31], v[14:15], v[14:15], v[30:31]
  v_pk_fma_f32 v[30:31], v[16:17], v[16:17], v[30:31]
  v_pk_fma_f32 v[30:31], v[18:19], v[18:19], v[30:31]
  v_pk_fma_f32 v[30:31], v[20:21], v[20:21], v[30:31]
  v_pk_fma_f32 v[30:31], v[22:23], v[22:23], v[30:31]
  v_pk_fma_f32 v[30:31], v[24:25], v[24:25], v[30:31]
  v_add_f32 v27, v30, v31
  s_nop 1
  v_add_f32_dpp v27, v27, v27 quad_perm:[1,0,3,2] row_mask:0xf bank_mask:0xf
  s_nop 1
  v_add_f32_dpp v27, v27, v27 quad_perm:[2,3,0,1] row_mask:0xf bank_mask:0xf
  s_nop 1
  v_add_f32_dpp v27, v27, v27 row_half_mirror row_mask:0xf bank_mask:0xf
  s_nop 1
  v_add_f32_dpp v27, v27, v27 row_mirror row_mask:0xf bank_mask:0xf
  v_mov_b32 v44, v27
  s_nop 1
  v_permlane16_swap_b32 v44, v27
  v_add_f32 v27, v27, v44
  v_mul_f32 v27, 0x3acccccd, v27
  v_add_f32 v27, 0x3727c5ac, v27
  v_rsq_f32 v27, v27
  s_nop 0
  v_pk_mul_f32 v[2:3], v[2:3], v[26:27] op_sel:[0,1] op_sel_hi:[1,1]
  v_pk_mul_f32 v[4:5], v[4:5], v[26:27] op_sel:[0,1] op_sel_hi:[1,1]
  v_pk_mul_f32 v[6:7], v[6:7], v[26:27] op_sel:[0,1] op_sel_hi:[1,1]
  v_pk_mul_f32 v[8:9], v[8:9], v[26:27] op_sel:[0,1] op_sel_hi:[1,1]
  v_pk_mul_f32 v[10:11], v[10:11], v[26:27] op_sel:[0,1] op_sel_hi:[1,1]
  v_pk_mul_f32 v[12:13], v[12:13], v[26:27] op_sel:[0,1] op_sel_hi:[1,1]
  v_pk_mul_f32 v[14:15], v[14:15], v[26:27] op_sel:[0,1] op_sel_hi:[1,1]
  v_pk_mul_f32 v[16:17], v[16:17], v[26:27] op_sel:[0,1] op_sel_hi:[1,1]
  v_pk_mul_f32 v[18:19], v[18:19], v[26:27] op_sel:[0,1] op_sel_hi:[1,1]
  v_pk_mul_f32 v[20:21], v[20:21], v[26:27] op_sel:[0,1] op_sel_hi:[1,1]
  v_pk_mul_f32 v[22:23], v[22:23], v[26:27] op_sel:[0,1] op_sel_hi:[1,1]
  v_pk_mul_f32 v[24:25], v[24:25], v[26:27] op_sel:[0,1] op_sel_hi:[1,1]
  s_cmp_ge_u32 s55, 15
  s_cselect_b32 s46, 1, 0
  s_cselect_b32 s60, 15, 0
  s_sub_u32 s47, s55, s60
  s_min_u32 s47, s47, 14
  v_lshrrev_b32 v30, 5, v1
  v_bfe_u32 v47, v1, 2, 2
  v_lshl_add_u32 v30, v30, 3, v47
  v_lshlrev_b32 v30, 8, v30
  v_bfe_u32 v31, v1, 4, 1
  v_lshl_add_u32 v30, v31, 5, v30
  v_and_b32 v31, 3, v1
  v_lshl_add_u32 v30, v31, 3, v30
  v_add_u32 v30, 12288, v30
  v_xor_b32 v31, 0, v47
  v_lshl_add_u32 v26, v31, 6, v30
  v_xor_b32 v31, 1, v47
  v_lshl_add_u32 v27, v31, 6, v30
  v_xor_b32 v31, 2, v47
  v_lshl_add_u32 v28, v31, 6, v30
  v_xor_b32 v31, 3, v47
  v_lshl_add_u32 v29, v31, 6, v30
  v_and_b32 v30, 15, v1
  v_lshlrev_b32 v30, 4, v30
  v_bfe_u32 v47, v1, 4, 1
  v_lshrrev_b32 v31, 5, v1
  v_lshl_add_u32 v48, v47, 12, v30
  v_lshl_add_u32 v48, v31, 11, v48
  v_lshl_add_u32 v30, v47, 3, v30
  v_lshl_add_u32 v49, v31, 11, v30
  v_mov_b32 v31, 2130706432
  v_cndmask_b32_e64 v50, v30, v31, s[72:73]
  v_lshrrev_b32 v30, 5, v46
  v_mul_u32_u24 v30, 0xa000, v30
  v_and_b32 v31, 31, v46
  v_lshl_add_u32 v30, v31, 4, v30
  v_lshl_add_u32 v30, v45, 9, v30
  v_mov_b32 v31, 2130706432
  v_cndmask_b32_e64 v31, v31, v30, s[70:71]
  v_lshlrev_b32 v47, 5, v45
  v_and_b32 v51, 15, v45
  v_lshlrev_b32 v51, 5, v51
  s_mul_i32 s61, s57, 1280
  s_lshl_b32 s62, s61, 1
  s_add_u32 s62, s62, 4096
  s_lshl_b32 s63, s54, 9
  s_lshl_b32 s64, s57, 7
  s_add_u32 s63, s63, s64
  s_add_u32 s63, s63, 36864
  s_add_u32 s64, s62, 2048
  v_and_b32 v45, 3, v1
  v_lshlrev_b32 v45, 4, v45
  v_lshrrev_b32 v60, 2, v1
  v_lshl_add_u32 v60, v60, 7, v45
  v_and_b32 v52, 0x1ff, v60
  v_add_u32 v52, s64, v52
  v_and_b32 v46, 7, v1
  v_lshl_add_u32 v46, v46, 4, s63
  v_cndmask_b32_e64 v46, v52, v46, s[72:73]
  v_and_b32 v45, 15, v1
  v_lshlrev_b32 v45, 4, v45
  s_mov_b32 s74, 0
L_poll_3:
  buffer_load_dwordx4 v[52:55], v60, s[12:15], s62 offen sc1
  buffer_load_dwordx4 v[56:59], v46, s[12:15], 0 offen sc1
  s_add_u32 s74, s74, 1
  s_cmp_gt_u32 s74, 131072
  s_cbranch_scc1 L_pdone_4
  s_waitcnt vmcnt(0)
  v_xor_b32 v55, s53, v55
  v_xor_b32 v59, s53, v59
  v_cmp_ne_u32 vcc, s52, v54
  v_cmp_ne_u32 s[68:69], s52, v58
  v_or_b32 v44, v55, v59
  s_or_b64 vcc, vcc, s[68:69]
  v_cmp_lt_u32 s[68:69], 15, v44
  s_nop 0
  s_or_b64 vcc, vcc, s[68:69]
  s_nop 1
  s_cbranch_vccnz L_poll_3
L_pdone_4:
  s_waitcnt vmcnt(0)
  v_cmp_ne_u32 vcc, s58, v59
  s_nop 0
  s_cmp_lg_u32 vcc_hi, 0
  s_cselect_b32 s63, 1, 0
  s_cmp_ge_u32 s57, 2
  s_cselect_b32 s64, 1.0, 0
  v_lshlrev_b32 v60, 16, v52
  v_and_b32 v61, 0xffff0000, v52
  v_lshlrev_b32 v62, 16, v53
  v_and_b32 v63, 0xffff0000, v53
  v_add_f32 v60, s64, v60
  v_add_f32 v61, s64, v61
  v_add_f32 v62, s64, v62
  v_add_f32 v63, s64, v63
  v_lshlrev_b32 v64, 16, v56
  v_and_b32 v65, 0xffff0000, v56
  v_lshlrev_b32 v66, 16, v57
  v_and_b32 v67, 0xffff0000, v57
  v_add_f32 v64, s64, v64
  v_add_f32 v65, s64, v65
  v_add_f32 v66, s64, v66
  v_add_f32 v67, s64, v67
  s_add_u32 s61, s61, 2048
  v_add_u32 v52, s61, v0
  v_add_u32 v45, s61, v45
  s_lshl_b32 s60, s57, 2
  v_mov_b32 v53, s60
  v_mov_b32 v54, s63
  v_mov_b32 v55, 0
  v_mov_b32 v46, 1
  ds_write_b128 v52, v[60:63]
  s_mov_b64 exec, 0xffff
  ds_write_b128 v45, v[64:67] offset:1024
  s_mov_b64 exec, 1
  ds_write_b32 v53, v54 offset:1792
  ds_add_u32 v55, v46 offset:1284
  s_mov_b64 exec, -1
  v_mov_b32 v45, 0
  s_mov_b32 s74, 0
L_lspin_5:
  ds_read_b32 v46, v45 offset:1284
  s_add_u32 s74, s74, 1
  s_cmp_gt_u32 s74, 1048576
  s_cbranch_scc1 L_lsdone_6
  s_waitcnt lgkmcnt(0)
  v_cmp_gt_u32 vcc, 4, v46
  s_nop 3
  s_cbranch_vccnz L_lspin_5
L_lsdone_6:
  s_waitcnt lgkmcnt(0)
  v_mov_b32 v52, 0
  ds_read_b128 v[52:55], v52 offset:1792
  ds_read_b128 v[56:59], v47 offset:4608
  ds_read_b128 v[80:83], v47 offset:2048
  ds_read_b128 v[60:63], v47 offset:4624
  ds_read_b128 v[84:87], v47 offset:2064
  ds_read_b128 v[64:67], v47 offset:5632
  ds_read_b128 v[88:91], v47 offset:3072
  ds_read_b128 v[68:71], v47 offset:5648
  ds_read_b128 v[92:95], v47 offset:3088
  ds_read_b128 v[72:75], v51 offset:6656
  ds_read_b128 v[96:99], v51 offset:4096
  ds_read_b128 v[76:79], v51 offset:6672
  ds_read_b128 v[100:103], v51 offset:4112
  s_waitcnt lgkmcnt(12)
  v_or_b32 v52, v52, v53
  v_or3_b32 v52, v52, v54, v55
  s_nop 0
  v_readfirstlane_b32 s59, v52
  s_mul_i32 s65, s54, 327680
  s_cmp_eq_u32 s59, 0
  s_cselect_b32 s66, 14155776, 0
  s_add_u32 s65, s65, s66
  s_add_u32 s65, s65, 1048576
  s_add_u32 s66, s65, 16384
  s_add_u32 s67, s65, 32768
  s_waitcnt lgkmcnt(10)
  v_pk_fma_f32 v[2:3], v[2:3], v[56:57], v[80:81]
  v_cvt_pk_bf16_f32 v104, v2, v3
  v_pk_fma_f32 v[4:5], v[4:5], v[58:59], v[82:83]
  v_cvt_pk_bf16_f32 v105, v4, v5
  s_waitcnt lgkmcnt(8)
  v_pk_fma_f32 v[6:7], v[6:7], v[60:61], v[84:85]
  v_cvt_pk_bf16_f32 v106, v6, v7
  v_pk_fma_f32 v[8:9], v[8:9], v[62:63], v[86:87]
  v_cvt_pk_bf16_f32 v107, v8, v9
  buffer_store_dwordx4 v[104:107], v30, s[12:15], s65 offen
  s_waitcnt lgkmcnt(6)
  v_pk_fma_f32 v[10:11], v[10:11], v[64:65], v[88:89]
  v_cvt_pk_bf16_f32 v108, v10, v11
  v_pk_fma_f32 v[12:13], v[12:13], v[66:67], v[90:91]
  v_cvt_pk_bf16_f32 v109, v12, v13
  s_waitcnt lgkmcnt(4)
  v_pk_fma_f32 v[14:15], v[14:15], v[68:69], v[92:93]
  v_cvt_pk_bf16_f32 v110, v14, v15
  v_pk_fma_f32 v[16:17], v[16:17], v[70:71], v[94:95]
  v_cvt_pk_bf16_f32 v111, v16, v17
  buffer_store_dwordx4 v[108:111], v30, s[12:15], s66 offen
  s_waitcnt lgkmcnt(2)
  v_pk_fma_f32 v[18:19], v[18:19], v[72:73], v[96:97]
  v_cvt_pk_bf16_f32 v112, v18, v19
  v_pk_fma_f32 v[20:21], v[20:21], v[74:75], v[98:99]
  v_cvt_pk_bf16_f32 v113, v20, v21
  s_waitcnt lgkmcnt(0)
  v_pk_fma_f32 v[22:23], v[22:23], v[76:77], v[100:101]
  v_cvt_pk_bf16_f32 v114, v22, v23
  v_pk_fma_f32 v[24:25], v[24:25], v[78:79], v[102:103]
  v_cvt_pk_bf16_f32 v115, v24, v25
  buffer_store_dwordx4 v[112:115], v31, s[12:15], s67 offen
  s_lshl_b32 s60, s54, 12
  s_lshl_b32 s61, s55, 4
  s_add_u32 s60, s60, s61
  s_lshl_b32 s61, s57, 2
  s_add_u32 s60, s60, s61
  s_add_u32 s60, s60, 65536
  v_mov_b32 v2, 0
  v_mov_b32 v3, s52
  s_mov_b64 exec, 1
  s_cmp_lg_u32 s59, 0
  s_waitcnt vmcnt(0)
  s_cbranch_scc1 L_sigslow_7
  buffer_store_dword v3, v2, s[12:15], s60 offen
L_sigdone_8:
  s_mov_b64 exec, -1
  s_lshl_b32 s64, s46, 2
  s_add_u32 s64, s64, s57
  s_mul_i32 s66, s64, 40960
  s_mul_i32 s60, s46, 20480
  s_add_u32 s66, s66, s65
  s_add_u32 s66, s66, s60
  s_mul_i32 s67, s46, 40960
  s_sub_u32 s67, 4096, s67
  s_lshl_b32 s61, s64, 6
  s_lshl_b32 s60, s54, 12
  s_add_u32 s60, s60, 65536
  v_and_b32 v2, 15, v1
  v_lshl_add_u32 v2, v2, 2, s61
  s_mov_b32 s74, 0
L_poll_9:
  buffer_load_dword v3, v2, s[12:15], s60 offen sc1
  s_add_u32 s74, s74, 1
  s_cmp_gt_u32 s74, 131072
  s_cbranch_scc1 L_pdone_10
  s_waitcnt vmcnt(0)
  v_cmp_ne_u32 vcc, s52, v3
  s_nop 3
  s_cbranch_vccnz L_poll_9
L_pdone_10:
  s_waitcnt vmcnt(0)
  s_cmp_eq_u32 s59, 0
  s_cbranch_scc1 L_noacq_11
  buffer_inv sc1
  s_waitcnt vmcnt(0)
L_noacq_11:
  buffer_load_dwordx4 v[4:7], v0, s[12:15], s66 offen offset:0 sc1
  buffer_load_dwordx4 v[8:11], v0, s[12:15], s66 offen offset:1024 sc1
  buffer_load_dwordx4 v[12:15], v0, s[12:15], s66 offen offset:2048 sc1
  v_mov_b32 v2, 0
  v_mov_b32 v3, 1
  s_mov_b64 exec, 1
  ds_add_u32 v2, v3 offset:1288
  s_mov_b64 exec, -1
  s_barrier
  ds_read_b64_tr_b16 v[52:53], v26 offset:0
  ds_read_b64_tr_b16 v[54:55], v26 offset:1024
  ds_read_b64_tr_b16 v[56:57], v27 offset:0
  ds_read_b64_tr_b16 v[58:59], v27 offset:1024
  ds_read_b64_tr_b16 v[60:61], v28 offset:0
  ds_read_b64_tr_b16 v[62:63], v28 offset:1024
  ds_read_b64_tr_b16 v[64:65], v29 offset:0
  ds_read_b64_tr_b16 v[66:67], v29 offset:1024
  s_waitcnt vmcnt(2) lgkmcnt(6)
  v_mfma_f32_32x32x16_bf16 v[84:99], v[52:55], v[4:7], 0
  ds_read_b64_tr_b16 v[68:69], v26 offset:4096
  ds_read_b64_tr_b16 v[70:71], v26 offset:5120
  buffer_load_dwordx4 v[16:19], v0, s[12:15], s66 offen offset:3072 sc1
  s_add_u32 s66, s66, 4096
  s_waitcnt lgkmcnt(6)
  v_mfma_f32_32x32x16_bf16 v[100:115], v[56:59], v[4:7], 0
  ds_read_b64_tr_b16 v[72:73], v27 offset:4096
  ds_read_b64_tr_b16 v[74:75], v27 offset:5120
  s_waitcnt lgkmcnt(6)
  v_mfma_f32_32x32x16_bf16 v[116:131], v[60:63], v[4:7], 0
  ds_read_b64_tr_b16 v[76:77], v28 offset:4096
  ds_read_b64_tr_b16 v[78:79], v28 offset:5120
  buffer_load_dwordx4 v[20:23], v0, s[12:15], s66 offen offset:0 sc1
  s_waitcnt lgkmcnt(6)
  v_mfma_f32_32x32x16_bf16 v[132:147], v[64:67], v[4:7], 0
  ds_read_b64_tr_b16 v[80:81], v29 offset:4096
  ds_read_b64_tr_b16 v[82:83], v29 offset:5120
  s_waitcnt vmcnt(3) lgkmcnt(6)
  v_mfma_f32_32x32x16_bf16 v[84:99], v[68:71], v[8:11], v[84:99]
  ds_read_b64_tr_b16 v[52:53], v26 offset:8192
  ds_read_b64_tr_b16 v[54:55], v26 offset:9216
  buffer_load_dwordx4 v[32:35], v0, s[12:15], s66 offen offset:1024 sc1
  s_waitcnt lgkmcnt(6)
  v_mfma_f32_32x32x16_bf16 v[100:115], v[72:75], v[8:11], v[100:115]
  ds_read_b64_tr_b16 v[56:57], v27 offset:8192
  ds_read_b64_tr_b16 v[58:59], v27 offset:9216
  s_waitcnt lgkmcnt(6)
  v_mfma_f32_32x32x16_bf16 v[116:131], v[76:79], v[8:11], v[116:131]
  ds_read_b64_tr_b16 v[60:61], v28 offset:8192
  ds_read_b64_tr_b16 v[62:63], v28 offset:9216
  buffer_load_dwordx4 v[4:7], v0, s[12:15], s66 offen offset:2048 sc1
  s_waitcnt lgkmcnt(6)
  v_mfma_f32_32x32x16_bf16 v[132:147], v[80:83], v[8:11], v[132:147]
  ds_read_b64_tr_b16 v[64:65], v29 offset:8192
  ds_read_b64_tr_b16 v[66:67], v29 offset:9216
  s_waitcnt vmcnt(4) lgkmcnt(6)
  v_mfma_f32_32x32x16_bf16 v[84:99], v[52:55], v[12:15], v[84:99]
  ds_read_b64_tr_b16 v[68:69], v26 offset:12288
  ds_read_b64_tr_b16 v[70:71], v26 offset:13312
  buffer_load_dwordx4 v[8:11], v0, s[12:15], s66 offen offset:3072 sc1
  s_add_u32 s66, s66, 4096
  s_waitcnt lgkmcnt(6)
  v_mfma_f32_32x32x16_bf16 v[100:115], v[56:59], v[12:15], v[100:115]
  ds_read_b64_tr_b16 v[72:73], v27 offset:12288
  ds_read_b64_tr_b16 v[74:75], v27 offset:13312
  s_waitcnt lgkmcnt(6)
  v_mfma_f32_32x32x16_bf16 v[116:131], v[60:63], v[12:15], v[116:131]
  ds_read_b64_tr_b16 v[76:77], v28 offset:12288
  ds_read_b64_tr_b16 v[78:79], v28 offset:13312
  s_waitcnt lgkmcnt(6)
  v_mfma_f32_32x32x16_bf16 v[132:147], v[64:67], v[12:15], v[132:147]
  ds_read_b64_tr_b16 v[80:81], v29 offset:12288
  ds_read_b64_tr_b16 v[82:83], v29 offset:13312
  s_waitcnt vmcnt(4) lgkmcnt(6)
  v_mfma_f32_32x32x16_bf16 v[84:99], v[68:71], v[16:19], v[84:99]
  ds_read_b64_tr_b16 v[52:53], v26 offset:16384
  ds_read_b64_tr_b16 v[54:55], v26 offset:17408
  buffer_load_dwordx4 v[12:15], v0, s[12:15], s66 offen offset:0 sc1
  s_waitcnt lgkmcnt(6)
  v_mfma_f32_32x32x16_bf16 v[100:115], v[72:75], v[16:19], v[100:115]
  ds_read_b64_tr_b16 v[56:57], v27 offset:16384
  ds_read_b64_tr_b16 v[58:59], v27 offset:17408
  s_waitcnt lgkmcnt(6)
  v_mfma_f32_32x32x16_bf16 v[116:131], v[76:79], v[16:19], v[116:131]
  ds_read_b64_tr_b16 v[60:61], v28 offset:16384
  ds_read_b64_tr_b16 v[62:63], v28 offset:17408
  s_waitcnt lgkmcnt(6)
  v_mfma_f32_32x32x16_bf16 v[132:147], v[80:83], v[16:19], v[132:147]
  ds_read_b64_tr_b16 v[64:65], v29 offset:16384
  ds_read_b64_tr_b16 v[66:67], v29 offset:17408
  s_waitcnt vmcnt(4) lgkmcnt(6)
  v_mfma_f32_32x32x16_bf16 v[84:99], v[52:55], v[20:23], v[84:99]
  ds_read_b64_tr_b16 v[68:69], v26 offset:20480
  ds_read_b64_tr_b16 v[70:71], v26 offset:21504
  buffer_load_dwordx4 v[16:19], v0, s[12:15], s66 offen offset:1024 sc1
  s_waitcnt lgkmcnt(6)
  v_mfma_f32_32x32x16_bf16 v[100:115], v[56:59], v[20:23], v[100:115]
  ds_read_b64_tr_b16 v[72:73], v27 offset:20480
  ds_read_b64_tr_b16 v[74:75], v27 offset:21504
  s_waitcnt lgkmcnt(6)
  v_mfma_f32_32x32x16_bf16 v[116:131], v[60:63], v[20:23], v[116:131]
  ds_read_b64_tr_b16 v[76:77], v28 offset:20480
  ds_read_b64_tr_b16 v[78:79], v28 offset:21504
  s_waitcnt lgkmcnt(6)
  v_mfma_f32_32x32x16_bf16 v[132:147], v[64:67], v[20:23], v[132:147]
  ds_read_b64_tr_b16 v[80:81], v29 offset:20480
  ds_read_b64_tr_b16 v[82:83], v29 offset:21504
  s_waitcnt vmcnt(4) lgkmcnt(6)
  v_mfma_f32_32x32x16_bf16 v[84:99], v[68:71], v[32:35], v[84:99]
  ds_read_b64_tr_b16 v[52:53], v26 offset:24576
  ds_read_b64_tr_b16 v[54:55], v26 offset:25600
  buffer_load_dwordx4 v[20:23], v0, s[12:15], s66 offen offset:2048 sc1
  s_waitcnt lgkmcnt(6)
  v_mfma_f32_32x32x16_bf16 v[100:115], v[72:75], v[32:35], v[100:115]
  ds_read_b64_tr_b16 v[56:57], v27 offset:24576
  ds_read_b64_tr_b16 v[58:59], v27 offset:25600
  s_waitcnt lgkmcnt(6)
  v_mfma_f32_32x32x16_bf16 v[116:131], v[76:79], v[32:35], v[116:131]
  ds_read_b64_tr_b16 v[60:61], v28 offset:24576
  ds_read_b64_tr_b16 v[62:63], v28 offset:25600
  s_waitcnt lgkmcnt(6)
  v_mfma_f32_32x32x16_bf16 v[132:147], v[80:83], v[32:35], v[132:147]
  ds_read_b64_tr_b16 v[64:65], v29 offset:24576
  ds_read_b64_tr_b16 v[66:67], v29 offset:25600
  s_waitcnt vmcnt(4) lgkmcnt(6)
  v_mfma_f32_32x32x16_bf16 v[84:99], v[52:55], v[4:7], v[84:99]
  ds_read_b64_tr_b16 v[68:69], v26 offset:28672
  ds_read_b64_tr_b16 v[70:71], v26 offset:29696
  buffer_load_dwordx4 v[32:35], v0, s[12:15], s66 offen offset:3072 sc1
  s_add_u32 s66, s66, 4096
  s_waitcnt lgkmcnt(6)
  v_mfma_f32_32x32x16_bf16 v[100:115], v[56:59], v[4:7], v[100:115]
  ds_read_b64_tr_b16 v[72:73], v27 offset:28672
  ds_read_b64_tr_b16 v[74:75], v27 offset:29696
  s_waitcnt lgkmcnt(6)
  v_mfma_f32_32x32x16_bf16 v[116:131], v[60:63], v[4:7], v[116:131]
  ds_read_b64_tr_b16 v[76:77], v28 offset:28672
  ds_read_b64_tr_b16 v[78:79], v28 offset:29696
  s_waitcnt lgkmcnt(6)
  v_mfma_f32_32x32x16_bf16 v[132:147], v[64:67], v[4:7], v[132:147]
  ds_read_b64_tr_b16 v[80:81], v29 offset:28672
  ds_read_b64_tr_b16 v[82:83], v29 offset:29696
  s_waitcnt lgkmcnt(0)
  s_barrier
  s_waitcnt vmcnt(4)
  v_mfma_f32_32x32x16_bf16 v[84:99], v[68:71], v[8:11], v[84:99]
  ds_read_b64_tr_b16 v[52:53], v26 offset:32768
  ds_read_b64_tr_b16 v[54:55], v26 offset:33792
  buffer_load_dwordx4 v[4:7], v0, s[12:15], s66 offen offset:0 sc1
  v_mfma_f32_32x32x16_bf16 v[100:115], v[72:75], v[8:11], v[100:115]
  ds_read_b64_tr_b16 v[56:57], v27 offset:32768
  ds_read_b64_tr_b16 v[58:59], v27 offset:33792
  v_mfma_f32_32x32x16_bf16 v[116:131], v[76:79], v[8:11], v[116:131]
  ds_read_b64_tr_b16 v[60:61], v28 offset:32768
  ds_read_b64_tr_b16 v[62:63], v28 offset:33792
  v_mfma_f32_32x32x16_bf16 v[132:147], v[80:83], v[8:11], v[132:147]
  ds_read_b64_tr_b16 v[64:65], v29 offset:32768
  ds_read_b64_tr_b16 v[66:67], v29 offset:33792
  s_waitcnt vmcnt(4) lgkmcnt(6)
  v_mfma_f32_32x32x16_bf16 v[84:99], v[52:55], v[12:15], v[84:99]
  ds_read_b64_tr_b16 v[68:69], v26 offset:36864
  ds_read_b64_tr_b16 v[70:71], v26 offset:37888
  buffer_load_dwordx4 v[8:11], v0, s[12:15], s66 offen offset:1024 sc1
  s_waitcnt lgkmcnt(6)
  v_mfma_f32_32x32x16_bf16 v[100:115], v[56:59], v[12:15], v[100:115]
  ds_read_b64_tr_b16 v[72:73], v27 offset:36864
  ds_read_b64_tr_b16 v[74:75], v27 offset:37888
  s_waitcnt lgkmcnt(6)
  v_mfma_f32_32x32x16_bf16 v[116:131], v[60:63], v[12:15], v[116:131]
  ds_read_b64_tr_b16 v[76:77], v28 offset:36864
  ds_read_b64_tr_b16 v[78:79], v28 offset:37888
  s_waitcnt lgkmcnt(6)
  v_mfma_f32_32x32x16_bf16 v[132:147], v[64:67], v[12:15], v[132:147]
  ds_read_b64_tr_b16 v[80:81], v29 offset:36864
  ds_read_b64_tr_b16 v[82:83], v29 offset:37888
  s_waitcnt vmcnt(4) lgkmcnt(6)
  v_mfma_f32_32x32x16_bf16 v[84:99], v[68:71], v[16:19], v[84:99]
  ds_read_b64_tr_b16 v[52:53], v26 offset:40960
  ds_read_b64_tr_b16 v[54:55], v26 offset:41984
  buffer_load_dwordx4 v[12:15], v0, s[12:15], s66 offen offset:2048 sc1
  s_waitcnt lgkmcnt(6)
  v_mfma_f32_32x32x16_bf16 v[100:115], v[72:75], v[16:19], v[100:115]
  ds_read_b64_tr_b16 v[56:57], v27 offset:40960
  ds_read_b64_tr_b16 v[58:59], v27 offset:41984
  s_waitcnt lgkmcnt(6)
  v_mfma_f32_32x32x16_bf16 v[116:131], v[76:79], v[16:19], v[116:131]
  ds_read_b64_tr_b16 v[60:61], v28 offset:40960
  ds_read_b64_tr_b16 v[62:63], v28 offset:41984
  s_waitcnt lgkmcnt(6)
  v_mfma_f32_32x32x16_bf16 v[132:147], v[80:83], v[16:19], v[132:147]
  ds_read_b64_tr_b16 v[64:65], v29 offset:40960
  ds_read_b64_tr_b16 v[66:67], v29 offset:41984
  s_waitcnt vmcnt(4) lgkmcnt(6)
  v_mfma_f32_32x32x16_bf16 v[84:99], v[52:55], v[20:23], v[84:99]
  ds_read_b64_tr_b16 v[68:69], v26 offset:45056
  ds_read_b64_tr_b16 v[70:71], v26 offset:46080
  buffer_load_dwordx4 v[16:19], v0, s[12:15], s66 offen offset:3072 sc1
  s_add_u32 s66, s66, 4096
  s_waitcnt lgkmcnt(6)
  v_mfma_f32_32x32x16_bf16 v[100:115], v[56:59], v[20:23], v[100:115]
  ds_read_b64_tr_b16 v[72:73], v27 offset:45056
  ds_read_b64_tr_b16 v[74:75], v27 offset:46080
  s_waitcnt lgkmcnt(6)
  v_mfma_f32_32x32x16_bf16 v[116:131], v[60:63], v[20:23], v[116:131]
  ds_read_b64_tr_b16 v[76:77], v28 offset:45056
  ds_read_b64_tr_b16 v[78:79], v28 offset:46080
  s_waitcnt lgkmcnt(6)
  v_mfma_f32_32x32x16_bf16 v[132:147], v[64:67], v[20:23], v[132:147]
  ds_read_b64_tr_b16 v[80:81], v29 offset:45056
  ds_read_b64_tr_b16 v[82:83], v29 offset:46080
  s_waitcnt vmcnt(4) lgkmcnt(6)
  v_mfma_f32_32x32x16_bf16 v[84:99], v[68:71], v[32:35], v[84:99]
  ds_read_b64_tr_b16 v[52:53], v26 offset:49152
  ds_read_b64_tr_b16 v[54:55], v26 offset:50176
  buffer_load_dwordx4 v[20:23], v0, s[12:15], s66 offen offset:0 sc1
  s_waitcnt lgkmcnt(6)
  v_mfma_f32_32x32x16_bf16 v[100:115], v[72:75], v[32:35], v[100:115]
  ds_read_b64_tr_b16 v[56:57], v27 offset:49152
  ds_read_b64_tr_b16 v[58:59], v27 offset:50176
  s_waitcnt lgkmcnt(6)
  v_mfma_f32_32x32x16_bf16 v[116:131], v[76:79], v[32:35], v[116:131]
  ds_read_b64_tr_b16 v[60:61], v28 offset:49152
  ds_read_b64_tr_b16 v[62:63], v28 offset:50176
  s_waitcnt lgkmcnt(6)
  v_mfma_f32_32x32x16_bf16 v[132:147], v[80:83], v[32:35], v[132:147]
  ds_read_b64_tr_b16 v[64:65], v29 offset:49152
  ds_read_b64_tr_b16 v[66:67], v29 offset:50176
  s_waitcnt vmcnt(4) lgkmcnt(6)
  v_mfma_f32_32x32x16_bf16 v[84:99], v[52:55], v[4:7], v[84:99]
  ds_read_b64_tr_b16 v[68:69], v26 offset:53248
  ds_read_b64_tr_b16 v[70:71], v26 offset:54272
  buffer_load_dwordx4 v[32:35], v0, s[12:15], s66 offen offset:1024 sc1
  s_waitcnt lgkmcnt(6)
  v_mfma_f32_32x32x16_bf16 v[100:115], v[56:59], v[4:7], v[100:115]
  ds_read_b64_tr_b16 v[72:73], v27 offset:53248
  ds_read_b64_tr_b16 v[74:75], v27 offset:54272
  s_waitcnt lgkmcnt(6)
  v_mfma_f32_32x32x16_bf16 v[116:131], v[60:63], v[4:7], v[116:131]
  ds_read_b64_tr_b16 v[76:77], v28 offset:53248
  ds_read_b64_tr_b16 v[78:79], v28 offset:54272
  s_waitcnt lgkmcnt(6)
  v_mfma_f32_32x32x16_bf16 v[132:147], v[64:67], v[4:7], v[132:147]
  ds_read_b64_tr_b16 v[80:81], v29 offset:53248
  ds_read_b64_tr_b16 v[82:83], v29 offset:54272
  s_waitcnt vmcnt(4) lgkmcnt(6)
  v_mfma_f32_32x32x16_bf16 v[84:99], v[68:71], v[8:11], v[84:99]
  ds_read_b64_tr_b16 v[52:53], v26 offset:57344
  ds_read_b64_tr_b16 v[54:55], v26 offset:58368
  buffer_load_dwordx4 v[4:7], v0, s[12:15], s66 offen offset:2048 sc1
  s_waitcnt lgkmcnt(6)
  v_mfma_f32_32x32x16_bf16 v[100:115], v[72:75], v[8:11], v[100:115]
  ds_read_b64_tr_b16 v[56:57], v27 offset:57344
  ds_read_b64_tr_b16 v[58:59], v27 offset:58368
  s_waitcnt lgkmcnt(6)
  v_mfma_f32_32x32x16_bf16 v[116:131], v[76:79], v[8:11], v[116:131]
  ds_read_b64_tr_b16 v[60:61], v28 offset:57344
  ds_read_b64_tr_b16 v[62:63], v28 offset:58368
  s_waitcnt lgkmcnt(6)
  v_mfma_f32_32x32x16_bf16 v[132:147], v[80:83], v[8:11], v[132:147]
  ds_read_b64_tr_b16 v[64:65], v29 offset:57344
  ds_read_b64_tr_b16 v[66:67], v29 offset:58368
  s_waitcnt vmcnt(4) lgkmcnt(6)
  v_mfma_f32_32x32x16_bf16 v[84:99], v[52:55], v[12:15], v[84:99]
  ds_read_b64_tr_b16 v[68:69], v26 offset:61440
  ds_read_b64_tr_b16 v[70:71], v26 offset:62464
  buffer_load_dwordx4 v[8:11], v0, s[12:15], s66 offen offset:3072 sc1
  s_add_u32 s66, s66, s67
  s_waitcnt lgkmcnt(6)
  v_mfma_f32_32x32x16_bf16 v[100:115], v[56:59], v[12:15], v[100:115]
  ds_read_b64_tr_b16 v[72:73], v27 offset:61440
  ds_read_b64_tr_b16 v[74:75], v27 offset:62464
  s_waitcnt lgkmcnt(6)
  v_mfma_f32_32x32x16_bf16 v[116:131], v[60:63], v[12:15], v[116:131]
  ds_read_b64_tr_b16 v[76:77], v28 offset:61440
  ds_read_b64_tr_b16 v[78:79], v28 offset:62464
  s_waitcnt lgkmcnt(6)
  v_mfma_f32_32x32x16_bf16 v[132:147], v[64:67], v[12:15], v[132:147]
  ds_read_b64_tr_b16 v[80:81], v29 offset:61440
  ds_read_b64_tr_b16 v[82:83], v29 offset:62464
  s_barrier
  s_waitcnt vmcnt(4) lgkmcnt(6)
  v_mfma_f32_32x32x16_bf16 v[84:99], v[68:71], v[16:19], v[84:99]
  v_add_u32 v26, 65536, v26
  ds_read_b64_tr_b16 v[52:53], v26 offset:0
  ds_read_b64_tr_b16 v[54:55], v26 offset:1024
  buffer_load_dwordx4 v[12:15], v0, s[12:15], s66 offen offset:0 sc1
  s_waitcnt lgkmcnt(6)
  v_mfma_f32_32x32x16_bf16 v[100:115], v[72:75], v[16:19], v[100:115]
  v_add_u32 v27, 65536, v27
  ds_read_b64_tr_b16 v[56:57], v27 offset:0
  ds_read_b64_tr_b16 v[58:59], v27 offset:1024
  s_waitcnt lgkmcnt(6)
  v_mfma_f32_32x32x16_bf16 v[116:131], v[76:79], v[16:19], v[116:131]
  v_add_u32 v28, 65536, v28
  ds_read_b64_tr_b16 v[60:61], v28 offset:0
  ds_read_b64_tr_b16 v[62:63], v28 offset:1024
  s_waitcnt lgkmcnt(6)
  v_mfma_f32_32x32x16_bf16 v[132:147], v[80:83], v[16:19], v[132:147]
  v_add_u32 v29, 65536, v29
  ds_read_b64_tr_b16 v[64:65], v29 offset:0
  ds_read_b64_tr_b16 v[66:67], v29 offset:1024
  s_waitcnt vmcnt(4) lgkmcnt(6)
  v_mfma_f32_32x32x16_bf16 v[84:99], v[52:55], v[20:23], v[84:99]
  ds_read_b64_tr_b16 v[68:69], v26 offset:4096
  ds_read_b64_tr_b16 v[70:71], v26 offset:5120
  buffer_load_dwordx4 v[16:19], v0, s[12:15], s66 offen offset:1024 sc1
  s_waitcnt lgkmcnt(6)
  v_mfma_f32_32x32x16_bf16 v[100:115], v[56:59], v[20:23], v[100:115]
  ds_read_b64_tr_b16 v[72:73], v27 offset:4096
  ds_read_b64_tr_b16 v[74:75], v27 offset:5120
  s_waitcnt lgkmcnt(6)
  v_mfma_f32_32x32x16_bf16 v[116:131], v[60:63], v[20:23], v[116:131]
  ds_read_b64_tr_b16 v[76:77], v28 offset:4096
  ds_read_b64_tr_b16 v[78:79], v28 offset:5120
  s_waitcnt lgkmcnt(6)
  v_mfma_f32_32x32x16_bf16 v[132:147], v[64:67], v[20:23], v[132:147]
  ds_read_b64_tr_b16 v[80:81], v29 offset:4096
  ds_read_b64_tr_b16 v[82:83], v29 offset:5120
  s_waitcnt vmcnt(4) lgkmcnt(6)
  v_mfma_f32_32x32x16_bf16 v[84:99], v[68:71], v[32:35], v[84:99]
  ds_read_b64_tr_b16 v[52:53], v26 offset:8192
  ds_read_b64_tr_b16 v[54:55], v26 offset:9216
  buffer_load_dwordx4 v[20:23], v0, s[12:15], s66 offen offset:2048 sc1
  s_waitcnt lgkmcnt(6)
  v_mfma_f32_32x32x16_bf16 v[100:115], v[72:75], v[32:35], v[100:115]
  ds_read_b64_tr_b16 v[56:57], v27 offset:8192
  ds_read_b64_tr_b16 v[58:59], v27 offset:9216
  s_waitcnt lgkmcnt(6)
  v_mfma_f32_32x32x16_bf16 v[116:131], v[76:79], v[32:35], v[116:131]
  ds_read_b64_tr_b16 v[60:61], v28 offset:8192
  ds_read_b64_tr_b16 v[62:63], v28 offset:9216
  s_waitcnt lgkmcnt(6)
  v_mfma_f32_32x32x16_bf16 v[132:147], v[80:83], v[32:35], v[132:147]
  ds_read_b64_tr_b16 v[64:65], v29 offset:8192
  ds_read_b64_tr_b16 v[66:67], v29 offset:9216
  s_waitcnt vmcnt(4) lgkmcnt(6)
  v_mfma_f32_32x32x16_bf16 v[84:99], v[52:55], v[4:7], v[84:99]
  ds_read_b64_tr_b16 v[68:69], v26 offset:12288
  ds_read_b64_tr_b16 v[70:71], v26 offset:13312
  buffer_load_dwordx4 v[32:35], v0, s[12:15], s66 offen offset:3072 sc1
  s_add_u32 s66, s66, 4096
  s_waitcnt lgkmcnt(6)
  v_mfma_f32_32x32x16_bf16 v[100:115], v[56:59], v[4:7], v[100:115]
  ds_read_b64_tr_b16 v[72:73], v27 offset:12288
  ds_read_b64_tr_b16 v[74:75], v27 offset:13312
  s_waitcnt lgkmcnt(6)
  v_mfma_f32_32x32x16_bf16 v[116:131], v[60:63], v[4:7], v[116:131]
  ds_read_b64_tr_b16 v[76:77], v28 offset:12288
  ds_read_b64_tr_b16 v[78:79], v28 offset:13312
  s_waitcnt lgkmcnt(6)
  v_mfma_f32_32x32x16_bf16 v[132:147], v[64:67], v[4:7], v[132:147]
  ds_read_b64_tr_b16 v[80:81], v29 offset:12288
  ds_read_b64_tr_b16 v[82:83], v29 offset:13312
  s_waitcnt vmcnt(4) lgkmcnt(6)
  v_mfma_f32_32x32x16_bf16 v[84:99], v[68:71], v[8:11], v[84:99]
  ds_read_b64_tr_b16 v[52:53], v26 offset:16384
  ds_read_b64_tr_b16 v[54:55], v26 offset:17408
  buffer_load_dwordx4 v[4:7], v0, s[12:15], s66 offen offset:0 sc1
  s_waitcnt lgkmcnt(6)
  v_mfma_f32_32x32x16_bf16 v[100:115], v[72:75], v[8:11], v[100:115]
  ds_read_b64_tr_b16 v[56:57], v27 offset:16384
  ds_read_b64_tr_b16 v[58:59], v27 offset:17408
  s_waitcnt lgkmcnt(6)
  v_mfma_f32_32x32x16_bf16 v[116:131], v[76:79], v[8:11], v[116:131]
  ds_read_b64_tr_b16 v[60:61], v28 offset:16384
  ds_read_b64_tr_b16 v[62:63], v28 offset:17408
  s_waitcnt lgkmcnt(6)
  v_mfma_f32_32x32x16_bf16 v[132:147], v[80:83], v[8:11], v[132:147]
  ds_read_b64_tr_b16 v[64:65], v29 offset:16384
  ds_read_b64_tr_b16 v[66:67], v29 offset:17408
  s_waitcnt vmcnt(4) lgkmcnt(6)
  v_mfma_f32_32x32x16_bf16 v[84:99], v[52:55], v[12:15], v[84:99]
  ds_read_b64_tr_b16 v[68:69], v26 offset:20480
  ds_read_b64_tr_b16 v[70:71], v26 offset:21504
  buffer_load_dwordx4 v[8:11], v0, s[12:15], s66 offen offset:1024 sc1
  s_waitcnt lgkmcnt(6)
  v_mfma_f32_32x32x16_bf16 v[100:115], v[56:59], v[12:15], v[100:115]
  ds_read_b64_tr_b16 v[72:73], v27 offset:20480
  ds_read_b64_tr_b16 v[74:75], v27 offset:21504
  s_waitcnt lgkmcnt(6)
  v_mfma_f32_32x32x16_bf16 v[116:131], v[60:63], v[12:15], v[116:131]
  ds_read_b64_tr_b16 v[76:77], v28 offset:20480
  ds_read_b64_tr_b16 v[78:79], v28 offset:21504
  s_waitcnt lgkmcnt(6)
  v_mfma_f32_32x32x16_bf16 v[132:147], v[64:67], v[12:15], v[132:147]
  ds_read_b64_tr_b16 v[80:81], v29 offset:20480
  ds_read_b64_tr_b16 v[82:83], v29 offset:21504
  s_waitcnt vmcnt(4) lgkmcnt(6)
  v_mfma_f32_32x32x16_bf16 v[84:99], v[68:71], v[16:19], v[84:99]
  ds_read_b64_tr_b16 v[52:53], v26 offset:24576
  ds_read_b64_tr_b16 v[54:55], v26 offset:25600
  buffer_load_dwordx4 v[12:15], v0, s[12:15], s66 offen offset:2048 sc1
  s_waitcnt lgkmcnt(6)
  v_mfma_f32_32x32x16_bf16 v[100:115], v[72:75], v[16:19], v[100:115]
  ds_read_b64_tr_b16 v[56:57], v27 offset:24576
  ds_read_b64_tr_b16 v[58:59], v27 offset:25600
  s_waitcnt lgkmcnt(6)
  v_mfma_f32_32x32x16_bf16 v[116:131], v[76:79], v[16:19], v[116:131]
  ds_read_b64_tr_b16 v[60:61], v28 offset:24576
  ds_read_b64_tr_b16 v[62:63], v28 offset:25600
  s_waitcnt lgkmcnt(6)
  v_mfma_f32_32x32x16_bf16 v[132:147], v[80:83], v[16:19], v[132:147]
  ds_read_b64_tr_b16 v[64:65], v29 offset:24576
  ds_read_b64_tr_b16 v[66:67], v29 offset:25600
  s_waitcnt vmcnt(4) lgkmcnt(6)
  v_mfma_f32_32x32x16_bf16 v[84:99], v[52:55], v[20:23], v[84:99]
  ds_read_b64_tr_b16 v[68:69], v26 offset:28672
  ds_read_b64_tr_b16 v[70:71], v26 offset:29696
  buffer_load_dwordx4 v[16:19], v0, s[12:15], s66 offen offset:3072 sc1
  s_add_u32 s66, s66, 4096
  s_waitcnt lgkmcnt(6)
  v_mfma_f32_32x32x16_bf16 v[100:115], v[56:59], v[20:23], v[100:115]
  ds_read_b64_tr_b16 v[72:73], v27 offset:28672
  ds_read_b64_tr_b16 v[74:75], v27 offset:29696
  s_waitcnt lgkmcnt(6)
  v_mfma_f32_32x32x16_bf16 v[116:131], v[60:63], v[20:23], v[116:131]
  ds_read_b64_tr_b16 v[76:77], v28 offset:28672
  ds_read_b64_tr_b16 v[78:79], v28 offset:29696
  s_waitcnt lgkmcnt(6)
  v_mfma_f32_32x32x16_bf16 v[132:147], v[64:67], v[20:23], v[132:147]
  ds_read_b64_tr_b16 v[80:81], v29 offset:28672
  ds_read_b64_tr_b16 v[82:83], v29 offset:29696
  s_barrier
  s_waitcnt vmcnt(4) lgkmcnt(6)
  v_mfma_f32_32x32x16_bf16 v[84:99], v[68:71], v[32:35], v[84:99]
  ds_read_b64_tr_b16 v[52:53], v26 offset:32768
  ds_read_b64_tr_b16 v[54:55], v26 offset:33792
  buffer_load_dwordx4 v[20:23], v0, s[12:15], s66 offen offset:0 sc1
  s_waitcnt lgkmcnt(6)
  v_mfma_f32_32x32x16_bf16 v[100:115], v[72:75], v[32:35], v[100:115]
  ds_read_b64_tr_b16 v[56:57], v27 offset:32768
  ds_read_b64_tr_b16 v[58:59], v27 offset:33792
  s_waitcnt lgkmcnt(6)
  v_mfma_f32_32x32x16_bf16 v[116:131], v[76:79], v[32:35], v[116:131]
  ds_read_b64_tr_b16 v[60:61], v28 offset:32768
  ds_read_b64_tr_b16 v[62:63], v28 offset:33792
  s_waitcnt lgkmcnt(6)
  v_mfma_f32_32x32x16_bf16 v[132:147], v[80:83], v[32:35], v[132:147]
  ds_read_b64_tr_b16 v[64:65], v29 offset:32768
  ds_read_b64_tr_b16 v[66:67], v29 offset:33792
  s_waitcnt vmcnt(4) lgkmcnt(6)
  v_mfma_f32_32x32x16_bf16 v[84:99], v[52:55], v[4:7], v[84:99]
  ds_read_b64_tr_b16 v[68:69], v26 offset:36864
  ds_read_b64_tr_b16 v[70:71], v26 offset:37888
  buffer_load_dwordx4 v[32:35], v0, s[12:15], s66 offen offset:1024 sc1
  s_waitcnt lgkmcnt(6)
  v_mfma_f32_32x32x16_bf16 v[100:115], v[56:59], v[4:7], v[100:115]
  ds_read_b64_tr_b16 v[72:73], v27 offset:36864
  ds_read_b64_tr_b16 v[74:75], v27 offset:37888
  s_waitcnt lgkmcnt(6)
  v_mfma_f32_32x32x16_bf16 v[116:131], v[60:63], v[4:7], v[116:131]
  ds_read_b64_tr_b16 v[76:77], v28 offset:36864
  ds_read_b64_tr_b16 v[78:79], v28 offset:37888
  s_waitcnt lgkmcnt(6)
  v_mfma_f32_32x32x16_bf16 v[132:147], v[64:67], v[4:7], v[132:147]
  ds_read_b64_tr_b16 v[80:81], v29 offset:36864
  ds_read_b64_tr_b16 v[82:83], v29 offset:37888
  s_waitcnt vmcnt(4) lgkmcnt(6)
  v_mfma_f32_32x32x16_bf16 v[84:99], v[68:71], v[8:11], v[84:99]
  ds_read_b64_tr_b16 v[52:53], v26 offset:40960
  ds_read_b64_tr_b16 v[54:55], v26 offset:41984
  buffer_load_dwordx4 v[4:7], v0, s[12:15], s66 offen offset:2048 sc1
  s_waitcnt lgkmcnt(6)
  v_mfma_f32_32x32x16_bf16 v[100:115], v[72:75], v[8:11], v[100:115]
  ds_read_b64_tr_b16 v[56:57], v27 offset:40960
  ds_read_b64_tr_b16 v[58:59], v27 offset:41984
  s_waitcnt lgkmcnt(6)
  v_mfma_f32_32x32x16_bf16 v[116:131], v[76:79], v[8:11], v[116:131]
  ds_read_b64_tr_b16 v[60:61], v28 offset:40960
  ds_read_b64_tr_b16 v[62:63], v28 offset:41984
  s_waitcnt lgkmcnt(6)
  v_mfma_f32_32x32x16_bf16 v[132:147], v[80:83], v[8:11], v[132:147]
  ds_read_b64_tr_b16 v[64:65], v29 offset:40960
  ds_read_b64_tr_b16 v[66:67], v29 offset:41984
  s_waitcnt vmcnt(4) lgkmcnt(6)
  v_mfma_f32_32x32x16_bf16 v[84:99], v[52:55], v[12:15], v[84:99]
  ds_read_b64_tr_b16 v[68:69], v26 offset:45056
  ds_read_b64_tr_b16 v[70:71], v26 offset:46080
  buffer_load_dwordx4 v[8:11], v0, s[12:15], s66 offen offset:3072 sc1
  s_add_u32 s66, s66, 4096
  s_waitcnt lgkmcnt(6)
  v_mfma_f32_32x32x16_bf16 v[100:115], v[56:59], v[12:15], v[100:115]
  ds_read_b64_tr_b16 v[72:73], v27 offset:45056
  ds_read_b64_tr_b16 v[74:75], v27 offset:46080
  s_waitcnt lgkmcnt(6)
  v_mfma_f32_32x32x16_bf16 v[116:131], v[60:63], v[12:15], v[116:131]
  ds_read_b64_tr_b16 v[76:77], v28 offset:45056
  ds_read_b64_tr_b16 v[78:79], v28 offset:46080
  s_waitcnt lgkmcnt(6)
  v_mfma_f32_32x32x16_bf16 v[132:147], v[64:67], v[12:15], v[132:147]
  ds_read_b64_tr_b16 v[80:81], v29 offset:45056
  ds_read_b64_tr_b16 v[82:83], v29 offset:46080
  s_waitcnt vmcnt(4) lgkmcnt(6)
  v_mfma_f32_32x32x16_bf16 v[84:99], v[68:71], v[16:19], v[84:99]
  ds_read_b64_tr_b16 v[52:53], v26 offset:49152
  ds_read_b64_tr_b16 v[54:55], v26 offset:50176
  buffer_load_dwordx4 v[12:15], v0, s[12:15], s66 offen offset:0 sc1
  s_waitcnt lgkmcnt(6)
  v_mfma_f32_32x32x16_bf16 v[100:115], v[72:75], v[16:19], v[100:115]
  ds_read_b64_tr_b16 v[56:57], v27 offset:49152
  ds_read_b64_tr_b16 v[58:59], v27 offset:50176
  s_waitcnt lgkmcnt(6)
  v_mfma_f32_32x32x16_bf16 v[116:131], v[76:79], v[16:19], v[116:131]
  ds_read_b64_tr_b16 v[60:61], v28 offset:49152
  ds_read_b64_tr_b16 v[62:63], v28 offset:50176
  s_waitcnt lgkmcnt(6)
  v_mfma_f32_32x32x16_bf16 v[132:147], v[80:83], v[16:19], v[132:147]
  ds_read_b64_tr_b16 v[64:65], v29 offset:49152
  ds_read_b64_tr_b16 v[66:67], v29 offset:50176
  s_waitcnt vmcnt(4) lgkmcnt(6)
  v_mfma_f32_32x32x16_bf16 v[84:99], v[52:55], v[20:23], v[84:99]
  ds_read_b64_tr_b16 v[68:69], v26 offset:53248
  ds_read_b64_tr_b16 v[70:71], v26 offset:54272
  buffer_load_dwordx4 v[16:19], v0, s[12:15], s66 offen offset:1024 sc1
  s_waitcnt lgkmcnt(6)
  v_mfma_f32_32x32x16_bf16 v[100:115], v[56:59], v[20:23], v[100:115]
  ds_read_b64_tr_b16 v[72:73], v27 offset:53248
  ds_read_b64_tr_b16 v[74:75], v27 offset:54272
  s_waitcnt lgkmcnt(6)
  v_mfma_f32_32x32x16_bf16 v[116:131], v[60:63], v[20:23], v[116:131]
  ds_read_b64_tr_b16 v[76:77], v28 offset:53248
  ds_read_b64_tr_b16 v[78:79], v28 offset:54272
  s_waitcnt lgkmcnt(6)
  v_mfma_f32_32x32x16_bf16 v[132:147], v[64:67], v[20:23], v[132:147]
  ds_read_b64_tr_b16 v[80:81], v29 offset:53248
  ds_read_b64_tr_b16 v[82:83], v29 offset:54272
  s_waitcnt vmcnt(4) lgkmcnt(6)
  v_mfma_f32_32x32x16_bf16 v[84:99], v[68:71], v[32:35], v[84:99]
  ds_read_b64_tr_b16 v[52:53], v26 offset:57344
  ds_read_b64_tr_b16 v[54:55], v26 offset:58368
  buffer_load_dwordx4 v[20:23], v0, s[12:15], s66 offen offset:2048 sc1
  s_waitcnt lgkmcnt(6)
  v_mfma_f32_32x32x16_bf16 v[100:115], v[72:75], v[32:35], v[100:115]
  ds_read_b64_tr_b16 v[56:57], v27 offset:57344
  ds_read_b64_tr_b16 v[58:59], v27 offset:58368
  s_waitcnt lgkmcnt(6)
  v_mfma_f32_32x32x16_bf16 v[116:131], v[76:79], v[32:35], v[116:131]
  ds_read_b64_tr_b16 v[60:61], v28 offset:57344
  ds_read_b64_tr_b16 v[62:63], v28 offset:58368
  s_waitcnt lgkmcnt(6)
  v_mfma_f32_32x32x16_bf16 v[132:147], v[80:83], v[32:35], v[132:147]
  ds_read_b64_tr_b16 v[64:65], v29 offset:57344
  ds_read_b64_tr_b16 v[66:67], v29 offset:58368
  s_waitcnt vmcnt(4) lgkmcnt(6)
  v_mfma_f32_32x32x16_bf16 v[84:99], v[52:55], v[4:7], v[84:99]
  ds_read_b64_tr_b16 v[68:69], v26 offset:61440
  ds_read_b64_tr_b16 v[70:71], v26 offset:62464
  buffer_load_dwordx4 v[32:35], v0, s[12:15], s66 offen offset:3072 sc1
  s_add_u32 s66, s66, 4096
  s_waitcnt lgkmcnt(6)
  v_mfma_f32_32x32x16_bf16 v[100:115], v[56:59], v[4:7], v[100:115]
  ds_read_b64_tr_b16 v[72:73], v27 offset:61440
  ds_read_b64_tr_b16 v[74:75], v27 offset:62464
  s_waitcnt lgkmcnt(6)
  v_mfma_f32_32x32x16_bf16 v[116:131], v[60:63], v[4:7], v[116:131]
  ds_read_b64_tr_b16 v[76:77], v28 offset:61440
  ds_read_b64_tr_b16 v[78:79], v28 offset:62464
  s_waitcnt lgkmcnt(6)
  v_mfma_f32_32x32x16_bf16 v[132:147], v[64:67], v[4:7], v[132:147]
  ds_read_b64_tr_b16 v[80:81], v29 offset:61440
  ds_read_b64_tr_b16 v[82:83], v29 offset:62464
  s_barrier
  s_waitcnt vmcnt(4) lgkmcnt(6)
  v_mfma_f32_32x32x16_bf16 v[84:99], v[68:71], v[8:11], v[84:99]
  v_add_u32 v26, 65536, v26
  ds_read_b64_tr_b16 v[52:53], v26 offset:0
  ds_read_b64_tr_b16 v[54:55], v26 offset:1024
  buffer_load_dwordx4 v[4:7], v0, s[12:15], s66 offen offset:0 sc1
  s_waitcnt lgkmcnt(6)
  v_mfma_f32_32x32x16_bf16 v[100:115], v[72:75], v[8:11], v[100:115]
  v_add_u32 v27, 65536, v27
  ds_read_b64_tr_b16 v[56:57], v27 offset:0
  ds_read_b64_tr_b16 v[58:59], v27 offset:1024
  s_waitcnt lgkmcnt(6)
  v_mfma_f32_32x32x16_bf16 v[116:131], v[76:79], v[8:11], v[116:131]
  v_add_u32 v28, 65536, v28
  ds_read_b64_tr_b16 v[60:61], v28 offset:0
  ds_read_b64_tr_b16 v[62:63], v28 offset:1024
  s_waitcnt lgkmcnt(6)
  v_mfma_f32_32x32x16_bf16 v[132:147], v[80:83], v[8:11], v[132:147]
  v_add_u32 v29, 65536, v29
  ds_read_b64_tr_b16 v[64:65], v29 offset:0
  ds_read_b64_tr_b16 v[66:67], v29 offset:1024
  s_waitcnt vmcnt(4) lgkmcnt(6)
  v_mfma_f32_32x32x16_bf16 v[84:99], v[52:55], v[12:15], v[84:99]
  ds_read_b64_tr_b16 v[68:69], v26 offset:4096
  ds_read_b64_tr_b16 v[70:71], v26 offset:5120
  buffer_load_dwordx4 v[8:11], v0, s[12:15], s66 offen offset:1024 sc1
  s_waitcnt lgkmcnt(6)
  v_mfma_f32_32x32x16_bf16 v[100:115], v[56:59], v[12:15], v[100:115]
  ds_read_b64_tr_b16 v[72:73], v27 offset:4096
  ds_read_b64_tr_b16 v[74:75], v27 offset:5120
  s_waitcnt lgkmcnt(6)
  v_mfma_f32_32x32x16_bf16 v[116:131], v[60:63], v[12:15], v[116:131]
  ds_read_b64_tr_b16 v[76:77], v28 offset:4096
  ds_read_b64_tr_b16 v[78:79], v28 offset:5120
  s_waitcnt lgkmcnt(6)
  v_mfma_f32_32x32x16_bf16 v[132:147], v[64:67], v[12:15], v[132:147]
  ds_read_b64_tr_b16 v[80:81], v29 offset:4096
  ds_read_b64_tr_b16 v[82:83], v29 offset:5120
  s_waitcnt vmcnt(4) lgkmcnt(6)
  v_mfma_f32_32x32x16_bf16 v[84:99], v[68:71], v[16:19], v[84:99]
  ds_read_b64_tr_b16 v[52:53], v26 offset:8192
  ds_read_b64_tr_b16 v[54:55], v26 offset:9216
  buffer_load_dwordx4 v[12:15], v0, s[12:15], s66 offen offset:2048 sc1
  s_waitcnt lgkmcnt(6)
  v_mfma_f32_32x32x16_bf16 v[100:115], v[72:75], v[16:19], v[100:115]
  ds_read_b64_tr_b16 v[56:57], v27 offset:8192
  ds_read_b64_tr_b16 v[58:59], v27 offset:9216
  s_waitcnt lgkmcnt(6)
  v_mfma_f32_32x32x16_bf16 v[116:131], v[76:79], v[16:19], v[116:131]
  ds_read_b64_tr_b16 v[60:61], v28 offset:8192
  ds_read_b64_tr_b16 v[62:63], v28 offset:9216
  s_waitcnt lgkmcnt(6)
  v_mfma_f32_32x32x16_bf16 v[132:147], v[80:83], v[16:19], v[132:147]
  ds_read_b64_tr_b16 v[64:65], v29 offset:8192
  ds_read_b64_tr_b16 v[66:67], v29 offset:9216
  s_waitcnt vmcnt(4) lgkmcnt(6)
  v_mfma_f32_32x32x16_bf16 v[84:99], v[52:55], v[20:23], v[84:99]
  ds_read_b64_tr_b16 v[68:69], v26 offset:12288
  ds_read_b64_tr_b16 v[70:71], v26 offset:13312
  buffer_load_dwordx4 v[16:19], v0, s[12:15], s66 offen offset:3072 sc1
  s_waitcnt lgkmcnt(6)
  v_mfma_f32_32x32x16_bf16 v[100:115], v[56:59], v[20:23], v[100:115]
  ds_read_b64_tr_b16 v[72:73], v27 offset:12288
  ds_read_b64_tr_b16 v[74:75], v27 offset:13312
  s_waitcnt lgkmcnt(6)
  v_mfma_f32_32x32x16_bf16 v[116:131], v[60:63], v[20:23], v[116:131]
  ds_read_b64_tr_b16 v[76:77], v28 offset:12288
  ds_read_b64_tr_b16 v[78:79], v28 offset:13312
  s_waitcnt lgkmcnt(6)
  v_mfma_f32_32x32x16_bf16 v[132:147], v[64:67], v[20:23], v[132:147]
  ds_read_b64_tr_b16 v[80:81], v29 offset:12288
  ds_read_b64_tr_b16 v[82:83], v29 offset:13312
  s_waitcnt vmcnt(4) lgkmcnt(6)
  v_mfma_f32_32x32x16_bf16 v[84:99], v[68:71], v[32:35], v[84:99]
  ds_read_b64_tr_b16 v[52:53], v26 offset:16384
  ds_read_b64_tr_b16 v[54:55], v26 offset:17408
  s_waitcnt lgkmcnt(6)
  v_mfma_f32_32x32x16_bf16 v[100:115], v[72:75], v[32:35], v[100:115]
  ds_read_b64_tr_b16 v[56:57], v27 offset:16384
  ds_read_b64_tr_b16 v[58:59], v27 offset:17408
  s_waitcnt lgkmcnt(6)
  v_mfma_f32_32x32x16_bf16 v[116:131], v[76:79], v[32:35], v[116:131]
  ds_read_b64_tr_b16 v[60:61], v28 offset:16384
  ds_read_b64_tr_b16 v[62:63], v28 offset:17408
  s_waitcnt lgkmcnt(6)
  v_mfma_f32_32x32x16_bf16 v[132:147], v[80:83], v[32:35], v[132:147]
  ds_read_b64_tr_b16 v[64:65], v29 offset:16384
  ds_read_b64_tr_b16 v[66:67], v29 offset:17408
  s_waitcnt vmcnt(3) lgkmcnt(6)
  v_mfma_f32_32x32x16_bf16 v[84:99], v[52:55], v[4:7], v[84:99]
  v_subrev_u32 v26, 131072, v26
  ds_read_b64_tr_b16 v[68:69], v26 offset:0
  ds_read_b64_tr_b16 v[70:71], v26 offset:1024
  s_waitcnt lgkmcnt(6)
  v_mfma_f32_32x32x16_bf16 v[100:115], v[56:59], v[4:7], v[100:115]
  v_subrev_u32 v27, 131072, v27
  ds_read_b64_tr_b16 v[72:73], v27 offset:0
  ds_read_b64_tr_b16 v[74:75], v27 offset:1024
  s_waitcnt lgkmcnt(6)
  v_mfma_f32_32x32x16_bf16 v[116:131], v[60:63], v[4:7], v[116:131]
  v_subrev_u32 v28, 131072, v28
  ds_read_b64_tr_b16 v[76:77], v28 offset:0
  ds_read_b64_tr_b16 v[78:79], v28 offset:1024
  s_waitcnt lgkmcnt(6)
  v_mfma_f32_32x32x16_bf16 v[132:147], v[64:67], v[4:7], v[132:147]
  v_subrev_u32 v29, 131072, v29
  ds_read_b64_tr_b16 v[80:81], v29 offset:0
  ds_read_b64_tr_b16 v[82:83], v29 offset:1024
  s_waitcnt vmcnt(2) lgkmcnt(6)
  v_mfma_f32_32x32x16_bf16 v[84:99], v[68:71], v[8:11], v[84:99]
  ds_read_b64_tr_b16 v[52:53], v26 offset:4096
  ds_read_b64_tr_b16 v[54:55], v26 offset:5120
  s_waitcnt lgkmcnt(6)
  v_mfma_f32_32x32x16_bf16 v[100:115], v[72:75], v[8:11], v[100:115]
  ds_read_b64_tr_b16 v[56:57], v27 offset:4096
  ds_read_b64_tr_b16 v[58:59], v27 offset:5120
  s_waitcnt lgkmcnt(6)
  v_mfma_f32_32x32x16_bf16 v[116:131], v[76:79], v[8:11], v[116:131]
  ds_read_b64_tr_b16 v[60:61], v28 offset:4096
  ds_read_b64_tr_b16 v[62:63], v28 offset:5120
  s_waitcnt lgkmcnt(6)
  v_mfma_f32_32x32x16_bf16 v[132:147], v[80:83], v[8:11], v[132:147]
  ds_read_b64_tr_b16 v[64:65], v29 offset:4096
  ds_read_b64_tr_b16 v[66:67], v29 offset:5120
  s_waitcnt vmcnt(1) lgkmcnt(6)
  v_mfma_f32_32x32x16_bf16 v[84:99], v[52:55], v[12:15], v[84:99]
  ds_read_b64_tr_b16 v[68:69], v26 offset:8192
  ds_read_b64_tr_b16 v[70:71], v26 offset:9216
  s_waitcnt lgkmcnt(6)
  v_mfma_f32_32x32x16_bf16 v[100:115], v[56:59], v[12:15], v[100:115]
  ds_read_b64_tr_b16 v[72:73], v27 offset:8192
  ds_read_b64_tr_b16 v[74:75], v27 offset:9216
  s_waitcnt lgkmcnt(6)
  v_mfma_f32_32x32x16_bf16 v[116:131], v[60:63], v[12:15], v[116:131]
  ds_read_b64_tr_b16 v[76:77], v28 offset:8192
  ds_read_b64_tr_b16 v[78:79], v28 offset:9216
  s_waitcnt lgkmcnt(6)
  v_mfma_f32_32x32x16_bf16 v[132:147], v[64:67], v[12:15], v[132:147]
  ds_read_b64_tr_b16 v[80:81], v29 offset:8192
  ds_read_b64_tr_b16 v[82:83], v29 offset:9216
  s_waitcnt vmcnt(0) lgkmcnt(6)
  v_mfma_f32_32x32x16_bf16 v[84:99], v[68:71], v[16:19], v[84:99]
  s_waitcnt lgkmcnt(4)
  v_mfma_f32_32x32x16_bf16 v[100:115], v[72:75], v[16:19], v[100:115]
  s_waitcnt lgkmcnt(2)
  v_mfma_f32_32x32x16_bf16 v[116:131], v[76:79], v[16:19], v[116:131]
  s_waitcnt lgkmcnt(0)
  v_mfma_f32_32x32x16_bf16 v[132:147], v[80:83], v[16:19], v[132:147]
  s_barrier
  s_mul_i32 s65, s54, 983040
  s_add_u32 s65, s65, 24117248
  s_lshl_b32 s60, s47, 16
  s_lshl_b32 s61, s64, 8
  s_add_u32 s60, s60, s61
  s_add_u32 s60, s60, s65
  s_cmp_lt_u32 s55, 30
  s_cselect_b32 s62, s60, 2130706432
  s_mov_b32 s68, 0x3ea52b5c
  s_mov_b32 s69, 0x3ea52b5c
  s_cmp_ge_u32 s47, 5
  s_cbranch_scc1 L_noq_12
  v_pk_mul_f32 v[84:85], v[84:85], s[68:69]
  v_pk_mul_f32 v[86:87], v[86:87], s[68:69]
  v_pk_mul_f32 v[88:89], v[88:89], s[68:69]
  v_pk_mul_f32 v[90:91], v[90:91], s[68:69]
  v_pk_mul_f32 v[92:93], v[92:93], s[68:69]
  v_pk_mul_f32 v[94:95], v[94:95], s[68:69]
  v_pk_mul_f32 v[96:97], v[96:97], s[68:69]
  v_pk_mul_f32 v[98:99], v[98:99], s[68:69]
  v_pk_mul_f32 v[100:101], v[100:101], s[68:69]
  v_pk_mul_f32 v[102:103], v[102:103], s[68:69]
  v_pk_mul_f32 v[104:105], v[104:105], s[68:69]
  v_pk_mul_f32 v[106:107], v[106:107], s[68:69]
  v_pk_mul_f32 v[108:109], v[108:109], s[68:69]
  v_pk_mul_f32 v[110:111], v[110:111], s[68:69]
  v_pk_mul_f32 v[112:113], v[112:113], s[68:69]
  v_pk_mul_f32 v[114:115], v[114:115], s[68:69]
  v_pk_mul_f32 v[116:117], v[116:117], s[68:69]
  v_pk_mul_f32 v[118:119], v[118:119], s[68:69]
  v_pk_mul_f32 v[120:121], v[120:121], s[68:69]
  v_pk_mul_f32 v[122:123], v[122:123], s[68:69]
  v_pk_mul_f32 v[124:125], v[124:125], s[68:69]
  v_pk_mul_f32 v[126:127], v[126:127], s[68:69]
  v_pk_mul_f32 v[128:129], v[128:129], s[68:69]
  v_pk_mul_f32 v[130:131], v[130:131], s[68:69]
  v_pk_mul_f32 v[132:133], v[132:133], s[68:69]
  v_pk_mul_f32 v[134:135], v[134:135], s[68:69]
  v_pk_mul_f32 v[136:137], v[136:137], s[68:69]
  v_pk_mul_f32 v[138:139], v[138:139], s[68:69]
  v_pk_mul_f32 v[140:141], v[140:141], s[68:69]
  v_pk_mul_f32 v[142:143], v[142:143], s[68:69]
  v_pk_mul_f32 v[144:145], v[144:145], s[68:69]
  v_pk_mul_f32 v[146:147], v[146:147], s[68:69]
L_noq_12:
  v_cvt_pk_bf16_f32 v4, v84, v85
  v_cvt_pk_bf16_f32 v5, v86, v87
  v_cvt_pk_bf16_f32 v6, v88, v89
  v_cvt_pk_bf16_f32 v7, v90, v91
  v_cvt_pk_bf16_f32 v8, v92, v93
  v_cvt_pk_bf16_f32 v9, v94, v95
  v_cvt_pk_bf16_f32 v10, v96, v97
  v_cvt_pk_bf16_f32 v11, v98, v99
  v_permlane16_swap_b32 v4, v6
  v_permlane16_swap_b32 v5, v7
  buffer_store_dwordx4 v[4:7], v48, s[12:15], s62 offen sc1
  s_add_u32 s62, s62, 8192
  v_permlane16_swap_b32 v8, v10
  v_permlane16_swap_b32 v9, v11
  buffer_store_dwordx4 v[8:11], v48, s[12:15], s62 offen sc1
  s_add_u32 s62, s62, 8192
  v_cvt_pk_bf16_f32 v12, v100, v101
  v_cvt_pk_bf16_f32 v13, v102, v103
  v_cvt_pk_bf16_f32 v14, v104, v105
  v_cvt_pk_bf16_f32 v15, v106, v107
  v_cvt_pk_bf16_f32 v16, v108, v109
  v_cvt_pk_bf16_f32 v17, v110, v111
  v_cvt_pk_bf16_f32 v18, v112, v113
  v_cvt_pk_bf16_f32 v19, v114, v115
  v_permlane16_swap_b32 v12, v14
  v_permlane16_swap_b32 v13, v15
  buffer_store_dwordx4 v[12:15], v48, s[12:15], s62 offen sc1
  s_add_u32 s62, s62, 8192
  v_permlane16_swap_b32 v16, v18
  v_permlane16_swap_b32 v17, v19
  buffer_store_dwordx4 v[16:19], v48, s[12:15], s62 offen sc1
  s_add_u32 s62, s62, 8192
  v_cvt_pk_bf16_f32 v20, v116, v117
  v_cvt_pk_bf16_f32 v21, v118, v119
  v_cvt_pk_bf16_f32 v22, v120, v121
  v_cvt_pk_bf16_f32 v23, v122, v123
  v_cvt_pk_bf16_f32 v24, v124, v125
  v_cvt_pk_bf16_f32 v25, v126, v127
  v_cvt_pk_bf16_f32 v26, v128, v129
  v_cvt_pk_bf16_f32 v27, v130, v131
  v_permlane16_swap_b32 v20, v22
  v_permlane16_swap_b32 v21, v23
  buffer_store_dwordx4 v[20:23], v48, s[12:15], s62 offen sc1
  s_add_u32 s62, s62, 8192
  v_permlane16_swap_b32 v24, v26
  v_permlane16_swap_b32 v25, v27
  buffer_store_dwordx4 v[24:27], v48, s[12:15], s62 offen sc1
  s_add_u32 s62, s62, 8192
  v_cvt_pk_bf16_f32 v28, v132, v133
  v_cvt_pk_bf16_f32 v29, v134, v135
  v_cvt_pk_bf16_f32 v30, v136, v137
  v_cvt_pk_bf16_f32 v31, v138, v139
  v_cvt_pk_bf16_f32 v32, v140, v141
  v_cvt_pk_bf16_f32 v33, v142, v143
  v_cvt_pk_bf16_f32 v34, v144, v145
  v_cvt_pk_bf16_f32 v35, v146, v147
  v_permlane16_swap_b32 v28, v30
  v_permlane16_swap_b32 v29, v31
  buffer_store_dwordx4 v[28:31], v48, s[12:15], s62 offen sc1
  s_add_u32 s62, s62, 8192
  v_permlane16_swap_b32 v32, v34
  v_permlane16_swap_b32 v33, v35
  buffer_store_dwordx4 v[32:35], v48, s[12:15], s62 offen sc1
  v_lshrrev_b32 v2, 5, v1
  v_lshlrev_b32 v2, 2, v2
  v_and_b32 v3, 31, v1
  v_sub_u32 v2, v3, v2
  v_mov_b32 v3, 0xf1800000
  v_subrev_u32 v52, 0, v2
  v_ashrrev_i32 v52, 31, v52
  v_and_b32 v52, v3, v52
  v_subrev_u32 v53, 1, v2
  v_ashrrev_i32 v53, 31, v53
  v_and_b32 v53, v3, v53
  v_subrev_u32 v54, 2, v2
  v_ashrrev_i32 v54, 31, v54
  v_and_b32 v54, v3, v54
  v_subrev_u32 v55, 3, v2
  v_ashrrev_i32 v55, 31, v55
  v_and_b32 v55, v3, v55
  v_subrev_u32 v56, 8, v2
  v_ashrrev_i32 v56, 31, v56
  v_and_b32 v56, v3, v56
  v_subrev_u32 v57, 9, v2
  v_ashrrev_i32 v57, 31, v57
  v_and_b32 v57, v3, v57
  v_subrev_u32 v58, 10, v2
  v_ashrrev_i32 v58, 31, v58
  v_and_b32 v58, v3, v58
  v_subrev_u32 v59, 11, v2
  v_ashrrev_i32 v59, 31, v59
  v_and_b32 v59, v3, v59
  v_subrev_u32 v60, 16, v2
  v_ashrrev_i32 v60, 31, v60
  v_and_b32 v60, v3, v60
  v_subrev_u32 v61, 17, v2
  v_ashrrev_i32 v61, 31, v61
  v_and_b32 v61, v3, v61
  v_subrev_u32 v62, 18, v2
  v_ashrrev_i32 v62, 31, v62
  v_and_b32 v62, v3, v62
  v_subrev_u32 v63, 19, v2
  v_ashrrev_i32 v63, 31, v63
  v_and_b32 v63, v3, v63
  v_subrev_u32 v64, 24, v2
  v_ashrrev_i32 v64, 31, v64
  v_and_b32 v64, v3, v64
  v_subrev_u32 v65, 25, v2
  v_ashrrev_i32 v65, 31, v65
  v_and_b32 v65, v3, v65
  v_subrev_u32 v66, 26, v2
  v_ashrrev_i32 v66, 31, v66
  v_and_b32 v66, v3, v66
  v_subrev_u32 v67, 27, v2
  v_ashrrev_i32 v67, 31, v67
  v_and_b32 v67, v3, v67
  s_lshl_b32 s60, s57, 9
  v_and_b32 v37, 15, v1
  s_add_u32 s61, s60, 12288
  v_lshl_add_u32 v37, v37, 4, s61
  v_bfe_u32 v38, v1, 4, 1
  v_lshl_add_u32 v37, v38, 3, v37
  v_add_u32 v3, 16640, v37
  v_lshrrev_b32 v38, 5, v1
  v_mul_u32_u24 v2, 4160, v38
  v_add_u32 v2, v2, v37
  v_bfe_u32 v37, v1, 2, 2
  v_lshl_add_u32 v37, v38, 2, v37
  s_add_u32 s61, s60, 33088
  v_lshl_add_u32 v36, v37, 4, s61
  v_and_b32 v37, 3, v1
  v_bfe_u32 v38, v1, 4, 1
  v_lshl_add_u32 v37, v38, 2, v37
  v_lshlrev_b32 v37, 2, v37
  s_mov_b32 s61, 0x45543210
  v_lshrrev_b32_e64 v37, v37, s61
  v_and_b32 v37, 7, v37
  v_mul_u32_u24 v37, 4160, v37
  v_add_u32 v36, v36, v37
  s_lshl_b32 s60, s57, 1
  s_add_u32 s60, s60, 2
  s_cmp_eq_u32 s54, 0
  s_cselect_b32 s75, s60, 99
  s_lshl_b32 s60, s54, 12
  s_add_u32 s60, s60, 98304
  s_lshl_b32 s61, s55, 7
  s_add_u32 s61, s61, s60
  v_mov_b32 v37, 0
  v_mov_b32 v38, 1
  s_mov_b64 exec, 1
  s_waitcnt vmcnt(0)
  ds_add_rtn_u32 v38, v37, v38 offset:1280
  s_waitcnt lgkmcnt(0)
  v_readfirstlane_b32 s62, v38
  v_mov_b32 v38, s52
  s_cmp_lg_u32 s62, 3
  s_cbranch_scc1 L_xnosig_13
  buffer_store_dword v38, v37, s[12:15], s61 offen sc1
L_xnosig_13:
  s_mov_b64 exec, -1
  s_cmp_lt_u32 s57, 2
  s_cselect_b32 s63, 1, 0
  s_min_u32 s62, s63, s54
  s_lshl_b32 s61, s62, 12
  s_sub_u32 s61, s60, s61
  s_mul_i32 s62, s62, 983040
  s_sub_u32 s66, s65, s62
  s_cmp_gt_u32 s63, s54
  s_cselect_b32 s66, 2130706432, s66
  v_min_u32 v4, 5, v1
  v_lshrrev_b32 v5, 1, v4
  v_mul_u32_u24 v37, 0xa0, v5
  v_and_b32 v4, 1, v4
  v_lshl_add_u32 v37, v4, 2, v37
  s_mul_i32 s62, s55, 5
  v_add_u32 v37, s62, v37
  v_lshrrev_b32 v37, 5, v37
  v_lshlrev_b32 v37, 7, v37
  s_lshr_b32 s62, s57, 1
  s_mul_i32 s62, s62, 1920
  s_add_u32 s60, s60, s62
  s_and_b32 s62, s57, 1
  s_mul_i32 s63, s62, 1920
  s_add_u32 s61, s61, s63
  v_mov_b32 v4, s61
  v_mov_b32 v38, s60
  v_cmp_eq_u32 vcc, 0, v5
  s_nop 1
  v_cndmask_b32 v4, v4, v38, vcc
  v_add_u32 v37, v37, v4
  s_lshl_b32 s62, s62, 10
  s_add_u32 s66, s66, s62
  s_mul_i32 s62, s55, 10240
  s_add_u32 s65, s65, s62
  s_add_u32 s66, s66, s62
  s_add_u32 s66, s66, 327680
  s_lshl_b32 s67, s57, 10
  s_lshl_b32 s62, s57, 9
  s_add_u32 s65, s65, s62
  s_mov_b32 s74, 0
L_poll_14:
  buffer_load_dword v38, v37, s[12:15], 0 offen sc1
  s_add_u32 s74, s74, 1
  s_cmp_gt_u32 s74, 131072
  s_cbranch_scc1 L_pdone_15
  s_waitcnt vmcnt(0)
  v_cmp_ne_u32 vcc, s52, v38
  s_nop 3
  s_cbranch_vccnz L_poll_14
L_pdone_15:
  s_waitcnt vmcnt(0)
  s_cmp_eq_u32 s59, 0
  s_cbranch_scc1 L_noacq_16
  buffer_inv sc1
  s_waitcnt vmcnt(0)
L_noacq_16:
  s_add_u32 m0, s67, 12288
  s_nop 0
  buffer_load_dwordx4 v0, s[12:15], s66 offen sc1 lds
  s_add_u32 s66, s66, 2048
  s_add_u32 m0, s67, 16448
  s_nop 0
  buffer_load_dwordx4 v0, s[12:15], s66 offen sc1 lds
  s_add_u32 s66, s66, 2048
  s_add_u32 m0, s67, 20608
  s_nop 0
  buffer_load_dwordx4 v0, s[12:15], s66 offen sc1 lds
  s_add_u32 s66, s66, 2048
  s_add_u32 m0, s67, 24768
  s_nop 0
  buffer_load_dwordx4 v0, s[12:15], s66 offen sc1 lds
  s_add_u32 s66, s66, 2048
  s_add_u32 m0, s67, 28928
  s_nop 0
  buffer_load_dwordx4 v0, s[12:15], s66 offen sc1 lds
  s_add_u32 s66, s66, 319488
  s_add_u32 m0, s67, 33088
  s_nop 0
  buffer_load_dwordx4 v0, s[12:15], s66 offen sc1 lds
  s_add_u32 s66, s66, 2048
  s_add_u32 m0, s67, 37248
  s_nop 0
  buffer_load_dwordx4 v0, s[12:15], s66 offen sc1 lds
  s_add_u32 s66, s66, 2048
  s_add_u32 m0, s67, 41408
  s_nop 0
  buffer_load_dwordx4 v0, s[12:15], s66 offen sc1 lds
  s_add_u32 s66, s66, 2048
  s_add_u32 m0, s67, 45568
  s_nop 0
  buffer_load_dwordx4 v0, s[12:15], s66 offen sc1 lds
  s_add_u32 s66, s66, 2048
  s_add_u32 m0, s67, 49728
  s_nop 0
  buffer_load_dwordx4 v0, s[12:15], s66 offen sc1 lds
  s_add_u32 s61, s65, 4096
  s_add_u32 s62, s65, 8192
  buffer_load_dwordx2 v[4:5], v49, s[12:15], s65 offen offset:256 sc1
  buffer_load_dwordx2 v[6:7], v49, s[12:15], s61 offen offset:256 sc1
  buffer_load_dwordx2 v[12:13], v50, s[12:15], s62 offen offset:256 sc1
  buffer_load_dwordx2 v[8:9], v49, s[12:15], s65 offen offset:0 sc1
  buffer_load_dwordx2 v[10:11], v49, s[12:15], s61 offen offset:0 sc1
  buffer_load_dwordx2 v[14:15], v50, s[12:15], s62 offen offset:0 sc1
  s_mul_i32 s62, s57, 40
  s_mul_i32 s63, s78, 5
  s_add_u32 s62, s62, s63
  s_lshl_b32 s62, s62, 7
  s_add_u32 s64, s62, 14336
  v_min_u32 v37, 19, v1
  v_and_b32 v38, 3, v37
  v_lshrrev_b32 v39, 2, v37
  v_lshlrev_b32 v39, 7, v39
  v_lshl_add_u32 v39, v38, 4, v39
  buffer_load_dwordx4 v[32:35], v39, s[12:15], s64 offen sc1
  v_and_b32 v37, 15, v1
  s_lshl_b32 s60, s77, 6
  s_lshl_b32 s61, s57, 4
  s_add_u32 s60, s60, s61
  v_add_u32 v19, s60, v37
  v_mul_u32_u24 v38, 0x500, v19
  v_lshrrev_b32 v30, 4, v1
  s_mul_i32 s61, s78, 160
  v_lshl_add_u32 v37, v30, 3, s61
  v_add_u32 v38, v38, v37
  s_mul_i32 s61, s54, 327680
  buffer_load_dwordx2 v[20:21], v38, s[4:7], s61 offen offset:0
  buffer_load_dwordx2 v[22:23], v38, s[4:7], s61 offen offset:32
  buffer_load_dwordx2 v[24:25], v38, s[4:7], s61 offen offset:64
  buffer_load_dwordx2 v[26:27], v38, s[4:7], s61 offen offset:96
  buffer_load_dwordx2 v[28:29], v38, s[4:7], s61 offen offset:128
  v_lshrrev_b32 v40, 5, v1
  s_mul_i32 s60, s55, 5
  v_bfe_u32 v37, v1, 4, 1
  v_mul_u32_u24 v37, 0x5000, v37
  v_and_b32 v38, 15, v1
  v_lshl_add_u32 v37, v38, 4, v37
  s_add_u32 s61, s60, 0
  v_add_u32 v38, s61, v40
  v_lshrrev_b32 v16, 2, v38
  v_lshl_add_u32 v16, v16, 9, v37
  v_and_b32 v41, 1, v38
  v_lshl_add_u32 v16, v41, 8, v16
  v_bfe_u32 v41, v38, 1, 1
  v_lshl_add_u32 v16, v41, 3, v16
  s_add_u32 s61, s60, 2
  v_add_u32 v38, s61, v40
  v_lshrrev_b32 v17, 2, v38
  v_lshl_add_u32 v17, v17, 9, v37
  v_and_b32 v41, 1, v38
  v_lshl_add_u32 v17, v41, 8, v17
  v_bfe_u32 v41, v38, 1, 1
  v_lshl_add_u32 v17, v41, 3, v17
  s_add_u32 s61, s60, 4
  v_add_u32 v38, s61, v40
  v_lshrrev_b32 v18, 2, v38
  v_lshl_add_u32 v18, v18, 9, v37
  v_and_b32 v41, 1, v38
  v_lshl_add_u32 v18, v41, 8, v18
  v_bfe_u32 v41, v38, 1, 1
  v_lshl_add_u32 v18, v41, 3, v18
  v_mov_b32 v38, 2130706432
  v_cndmask_b32_e64 v18, v18, v38, s[72:73]
  v_lshrrev_b32 v37, 5, v1
  v_bfe_u32 v38, v1, 4, 1
  v_lshlrev_b32 v37, 4, v37
  v_lshl_add_u32 v37, v38, 2, v37
  v_bfe_u32 v38, v1, 2, 2
  v_add_u32 v37, v37, v38
  v_mul_u32_u24 v37, 0xa0, v37
  v_and_b32 v38, 3, v1
  v_lshl_add_u32 v37, v38, 3, v37
  s_and_b32 s60, s57, 1
  s_mul_i32 s60, s60, 51200
  s_add_u32 s60, s60, 58112
  v_add_u32 v31, s60, v37
  s_mul_i32 s65, s54, 327680
  s_cmp_eq_u32 s59, 0
  s_cselect_b32 s61, 11534336, 0
  s_add_u32 s65, s65, s61
  s_add_u32 s65, s65, 3670016
  s_mul_i32 s61, s57, 81920
  s_add_u32 s66, s61, s65
  s_add_u32 s67, s66, 40960
  s_waitcnt vmcnt(6)
  s_barrier
  v_mov_b32 v192, 0xf1800000
  v_mov_b32 v193, 0xf1800000
  s_mov_b32 s76, 0
L_att:
  ds_read_b64 v[180:181], v2 offset:2304
  ds_read_b64 v[182:183], v2 offset:10624
  ds_read_b64 v[184:185], v3 offset:2304
  ds_read_b64 v[48:49], v2 offset:2048
  ds_read_b64 v[50:51], v2 offset:10368
  ds_read_b64 v[188:189], v3 offset:2048
  s_waitcnt lgkmcnt(4)
  v_mfma_f32_32x32x16_bf16 v[68:83], v[180:183], v[4:7], v[52:67]
  s_waitcnt lgkmcnt(3)
  v_mfma_f32_32x32x8bf16_1k v[68:83], v[184:185], v[12:13], v[68:83]
  s_waitcnt lgkmcnt(1)
  v_mfma_f32_32x32x16_bf16 v[100:115], v[48:51], v[8:11], v[52:67]
  s_waitcnt lgkmcnt(0)
  v_mfma_f32_32x32x8bf16_1k v[100:115], v[188:189], v[14:15], v[100:115]
  s_nop 7
  v_max3_f32 v190, v68, v69, v192
  v_max3_f32 v190, v70, v71, v190
  v_max3_f32 v190, v72, v73, v190
  v_max3_f32 v190, v74, v75, v190
  v_max3_f32 v190, v76, v77, v190
  v_max3_f32 v190, v78, v79, v190
  v_max3_f32 v190, v80, v81, v190
  v_max3_f32 v190, v82, v83, v190
  v_mov_b32 v38, v190
  s_nop 1
  v_permlane32_swap_b32 v38, v190
  v_max_f32 v190, v190, v38
  v_sub_f32 v148, 0, v190
  v_sub_f32 v149, 0, v190
  v_sub_f32 v150, 0, v190
  v_sub_f32 v151, 0, v190
  v_sub_f32 v152, 0, v190
  v_sub_f32 v153, 0, v190
  v_sub_f32 v154, 0, v190
  v_sub_f32 v155, 0, v190
  v_sub_f32 v156, 0, v190
  v_sub_f32 v157, 0, v190
  v_sub_f32 v158, 0, v190
  v_sub_f32 v159, 0, v190
  v_sub_f32 v160, 0, v190
  v_sub_f32 v161, 0, v190
  v_sub_f32 v162, 0, v190
  v_sub_f32 v163, 0, v190
  v_sub_f32 v68, v68, v190
  v_sub_f32 v69, v69, v190
  v_sub_f32 v70, v70, v190
  v_sub_f32 v71, v71, v190
  v_sub_f32 v72, v72, v190
  v_sub_f32 v73, v73, v190
  v_sub_f32 v74, v74, v190
  v_sub_f32 v75, v75, v190
  v_sub_f32 v76, v76, v190
  v_sub_f32 v77, v77, v190
  v_sub_f32 v78, v78, v190
  v_sub_f32 v79, v79, v190
  v_sub_f32 v80, v80, v190
  v_sub_f32 v81, v81, v190
  v_sub_f32 v82, v82, v190
  v_sub_f32 v83, v83, v190
  v_max3_f32 v191, v100, v101, v193
  v_max3_f32 v191, v102, v103, v191
  v_max3_f32 v191, v104, v105, v191
  v_max3_f32 v191, v106, v107, v191
  v_max3_f32 v191, v108, v109, v191
  v_max3_f32 v191, v110, v111, v191
  v_max3_f32 v191, v112, v113, v191
  v_max3_f32 v191, v114, v115, v191
  v_mov_b32 v38, v191
  s_nop 1
  v_permlane32_swap_b32 v38, v191
  v_max_f32 v191, v191, v38
  v_sub_f32 v164, 0, v191
  v_sub_f32 v165, 0, v191
  v_sub_f32 v166, 0, v191
  v_sub_f32 v167, 0, v191
  v_sub_f32 v168, 0, v191
  v_sub_f32 v169, 0, v191
  v_sub_f32 v170, 0, v191
  v_sub_f32 v171, 0, v191
  v_sub_f32 v172, 0, v191
  v_sub_f32 v173, 0, v191
  v_sub_f32 v174, 0, v191
  v_sub_f32 v175, 0, v191
  v_sub_f32 v176, 0, v191
  v_sub_f32 v177, 0, v191
  v_sub_f32 v178, 0, v191
  v_sub_f32 v179, 0, v191
  v_sub_f32 v100, v100, v191
  v_sub_f32 v101, v101, v191
  v_sub_f32 v102, v102, v191
  v_sub_f32 v103, v103, v191
  v_sub_f32 v104, v104, v191
  v_sub_f32 v105, v105, v191
  v_sub_f32 v106, v106, v191
  v_sub_f32 v107, v107, v191
  v_sub_f32 v108, v108, v191
  v_sub_f32 v109, v109, v191
  v_sub_f32 v110, v110, v191
  v_sub_f32 v111, v111, v191
  v_sub_f32 v112, v112, v191
  v_sub_f32 v113, v113, v191
  v_sub_f32 v114, v114, v191
  v_sub_f32 v115, v115, v191
  v_mov_b32 v38, 0xf1800000
  v_sub_f32 v52, v38, v52
  v_sub_f32 v53, v38, v53
  v_sub_f32 v54, v38, v54
  v_sub_f32 v55, v38, v55
  v_sub_f32 v56, v38, v56
  v_sub_f32 v57, v38, v57
  v_sub_f32 v58, v38, v58
  v_sub_f32 v59, v38, v59
  v_sub_f32 v60, v38, v60
  v_sub_f32 v61, v38, v61
  v_sub_f32 v62, v38, v62
  v_sub_f32 v63, v38, v63
  v_sub_f32 v64, v38, v64
  v_sub_f32 v65, v38, v65
  v_sub_f32 v66, v38, v66
  v_sub_f32 v67, v38, v67
  ds_read_b64_tr_b16 v[180:181], v36 offset:2304
  ds_read_b64_tr_b16 v[182:183], v36 offset:2432
  ds_read_b64_tr_b16 v[184:185], v36 offset:2312
  ds_read_b64_tr_b16 v[186:187], v36 offset:2440
  v_exp_f32 v68, v68
  v_exp_f32 v69, v69
  v_exp_f32 v70, v70
  v_mfma_f32_32x32x16_bf16 v[84:99], v[48:51], v[4:7], v[148:163]
  v_exp_f32 v71, v71
  v_cvt_pk_bf16_f32 v40, v68, v69
  v_exp_f32 v72, v72
  v_exp_f32 v73, v73
  v_cvt_pk_bf16_f32 v41, v70, v71
  v_mfma_f32_32x32x8bf16_1k v[84:99], v[188:189], v[12:13], v[84:99]
  v_exp_f32 v74, v74
  v_exp_f32 v75, v75
  v_cvt_pk_bf16_f32 v42, v72, v73
  v_exp_f32 v76, v76
  v_exp_f32 v77, v77
  v_cvt_pk_bf16_f32 v43, v74, v75
  v_exp_f32 v78, v78
  v_exp_f32 v79, v79
  s_waitcnt lgkmcnt(2)
  v_mfma_f32_32x32x16_bf16 v[116:131], v[180:183], v[40:43], 0
  v_cvt_pk_bf16_f32 v44, v76, v77
  v_exp_f32 v80, v80
  v_exp_f32 v81, v81
  v_cvt_pk_bf16_f32 v45, v78, v79
  v_exp_f32 v82, v82
  v_exp_f32 v83, v83
  v_cvt_pk_bf16_f32 v46, v80, v81
  v_cvt_pk_bf16_f32 v47, v82, v83
  s_waitcnt lgkmcnt(0)
  s_nop 0
  v_mfma_f32_32x32x16_bf16 v[116:131], v[184:187], v[44:47], v[116:131]
  ds_read_b64_tr_b16 v[180:181], v36 offset:2048
  ds_read_b64_tr_b16 v[182:183], v36 offset:2176
  ds_read_b64_tr_b16 v[184:185], v36 offset:2056
  ds_read_b64_tr_b16 v[186:187], v36 offset:2184
  v_exp_f32 v84, v84
  v_exp_f32 v85, v85
  v_exp_f32 v86, v86
  v_exp_f32 v87, v87
  v_cvt_pk_bf16_f32 v40, v84, v85
  v_exp_f32 v88, v88
  v_exp_f32 v89, v89
  v_cvt_pk_bf16_f32 v41, v86, v87
  v_exp_f32 v90, v90
  v_exp_f32 v91, v91
  ds_read_b64 v[48:49], v2 offset:1792
  ds_read_b64 v[50:51], v2 offset:10112
  ds_read_b64 v[188:189], v3 offset:1792
  v_cvt_pk_bf16_f32 v42, v88, v89
  v_exp_f32 v92, v92
  v_exp_f32 v93, v93
  v_cvt_pk_bf16_f32 v43, v90, v91
  v_exp_f32 v94, v94
  v_exp_f32 v95, v95
  s_waitcnt lgkmcnt(5)
  v_mfma_f32_32x32x16_bf16 v[116:131], v[180:183], v[40:43], v[116:131]
  v_cvt_pk_bf16_f32 v44, v92, v93
  v_exp_f32 v96, v96
  v_exp_f32 v97, v97
  v_cvt_pk_bf16_f32 v45, v94, v95
  v_exp_f32 v98, v98
  v_exp_f32 v99, v99
  v_cvt_pk_bf16_f32 v46, v96, v97
  v_cvt_pk_bf16_f32 v47, v98, v99
  s_waitcnt lgkmcnt(3)
  s_nop 0
  v_mfma_f32_32x32x16_bf16 v[116:131], v[184:187], v[44:47], v[116:131]
  s_cmp_eq_u32 s75, 2
  s_cbranch_scc1 L_hook_2
L_back_2:
  v_exp_f32 v100, v100
  v_exp_f32 v101, v101
  v_exp_f32 v102, v102
  s_waitcnt lgkmcnt(1)
  v_mfma_f32_32x32x16_bf16 v[68:83], v[48:51], v[4:7], v[148:163]
  v_exp_f32 v103, v103
  v_cvt_pk_bf16_f32 v40, v100, v101
  v_exp_f32 v104, v104
  v_exp_f32 v105, v105
  v_cvt_pk_bf16_f32 v41, v102, v103
  s_waitcnt lgkmcnt(0)
  v_mfma_f32_32x32x8bf16_1k v[68:83], v[188:189], v[12:13], v[68:83]
  v_exp_f32 v106, v106
  v_exp_f32 v107, v107
  v_cvt_pk_bf16_f32 v42, v104, v105
  v_exp_f32 v108, v108
  v_exp_f32 v109, v109
  v_cvt_pk_bf16_f32 v43, v106, v107
  v_exp_f32 v110, v110
  v_exp_f32 v111, v111
  v_mfma_f32_32x32x16_bf16 v[132:147], v[180:183], v[40:43], 0
  v_cvt_pk_bf16_f32 v44, v108, v109
  v_exp_f32 v112, v112
  v_exp_f32 v113, v113
  v_cvt_pk_bf16_f32 v45, v110, v111
  v_exp_f32 v114, v114
  v_exp_f32 v115, v115
  v_cvt_pk_bf16_f32 v46, v112, v113
  v_cvt_pk_bf16_f32 v47, v114, v115
  s_nop 1
  v_mfma_f32_32x32x16_bf16 v[132:147], v[184:187], v[44:47], v[132:147]
  ds_read_b64_tr_b16 v[180:181], v36 offset:1792
  ds_read_b64_tr_b16 v[182:183], v36 offset:1920
  ds_read_b64_tr_b16 v[184:185], v36 offset:1800
  ds_read_b64_tr_b16 v[186:187], v36 offset:1928
  v_exp_f32 v68, v68
  v_exp_f32 v69, v69
  v_exp_f32 v70, v70
  v_mfma_f32_32x32x16_bf16 v[84:99], v[48:51], v[8:11], v[164:179]
  v_exp_f32 v71, v71
  v_cvt_pk_bf16_f32 v40, v68, v69
  v_exp_f32 v72, v72
  v_exp_f32 v73, v73
  v_cvt_pk_bf16_f32 v41, v70, v71
  v_mfma_f32_32x32x8bf16_1k v[84:99], v[188:189], v[14:15], v[84:99]
  v_exp_f32 v74, v74
  v_exp_f32 v75, v75
  ds_read_b64 v[48:49], v2 offset:1536
  ds_read_b64 v[50:51], v2 offset:9856
  ds_read_b64 v[188:189], v3 offset:1536
  v_cvt_pk_bf16_f32 v42, v72, v73
  v_exp_f32 v76, v76
  v_exp_f32 v77, v77
  v_cvt_pk_bf16_f32 v43, v74, v75
  v_exp_f32 v78, v78
  v_exp_f32 v79, v79
  s_waitcnt lgkmcnt(5)
  v_mfma_f32_32x32x16_bf16 v[116:131], v[180:183], v[40:43], v[116:131]
  v_cvt_pk_bf16_f32 v44, v76, v77
  v_exp_f32 v80, v80
  v_exp_f32 v81, v81
  v_cvt_pk_bf16_f32 v45, v78, v79
  v_exp_f32 v82, v82
  v_exp_f32 v83, v83
  v_cvt_pk_bf16_f32 v46, v80, v81
  v_cvt_pk_bf16_f32 v47, v82, v83
  s_waitcnt lgkmcnt(3)
  s_nop 0
  v_mfma_f32_32x32x16_bf16 v[116:131], v[184:187], v[44:47], v[116:131]
  v_exp_f32 v84, v84
  v_exp_f32 v85, v85
  v_exp_f32 v86, v86
  s_waitcnt lgkmcnt(1)
  v_mfma_f32_32x32x16_bf16 v[100:115], v[48:51], v[4:7], v[148:163]
  v_exp_f32 v87, v87
  v_cvt_pk_bf16_f32 v40, v84, v85
  v_exp_f32 v88, v88
  v_exp_f32 v89, v89
  v_cvt_pk_bf16_f32 v41, v86, v87
  s_waitcnt lgkmcnt(0)
  v_mfma_f32_32x32x8bf16_1k v[100:115], v[188:189], v[12:13], v[100:115]
  v_exp_f32 v90, v90
  v_exp_f32 v91, v91
  v_cvt_pk_bf16_f32 v42, v88, v89
  v_exp_f32 v92, v92
  v_exp_f32 v93, v93
  v_cvt_pk_bf16_f32 v43, v90, v91
  v_exp_f32 v94, v94
  v_exp_f32 v95, v95
  v_mfma_f32_32x32x16_bf16 v[132:147], v[180:183], v[40:43], v[132:147]
  v_cvt_pk_bf16_f32 v44, v92, v93
  v_exp_f32 v96, v96
  v_exp_f32 v97, v97
  v_cvt_pk_bf16_f32 v45, v94, v95
  v_exp_f32 v98, v98
  v_exp_f32 v99, v99
  v_cvt_pk_bf16_f32 v46, v96, v97
  v_cvt_pk_bf16_f32 v47, v98, v99
  s_nop 1
  v_mfma_f32_32x32x16_bf16 v[132:147], v[184:187], v[44:47], v[132:147]
  ds_read_b64_tr_b16 v[180:181], v36 offset:1536
  ds_read_b64_tr_b16 v[182:183], v36 offset:1664
  ds_read_b64_tr_b16 v[184:185], v36 offset:1544
  ds_read_b64_tr_b16 v[186:187], v36 offset:1672
  v_exp_f32 v100, v100
  v_exp_f32 v101, v101
  v_exp_f32 v102, v102
  v_mfma_f32_32x32x16_bf16 v[68:83], v[48:51], v[8:11], v[164:179]
  v_exp_f32 v103, v103
  v_cvt_pk_bf16_f32 v40, v100, v101
  v_exp_f32 v104, v104
  v_exp_f32 v105, v105
  v_cvt_pk_bf16_f32 v41, v102, v103
  v_mfma_f32_32x32x8bf16_1k v[68:83], v[188:189], v[14:15], v[68:83]
  v_exp_f32 v106, v106
  v_exp_f32 v107, v107
  ds_read_b64 v[48:49], v2 offset:1280
  ds_read_b64 v[50:51], v2 offset:9600
  ds_read_b64 v[188:189], v3 offset:1280
  v_cvt_pk_bf16_f32 v42, v104, v105
  v_exp_f32 v108, v108
  v_exp_f32 v109, v109
  v_cvt_pk_bf16_f32 v43, v106, v107
  v_exp_f32 v110, v110
  v_exp_f32 v111, v111
  s_waitcnt lgkmcnt(5)
  v_mfma_f32_32x32x16_bf16 v[116:131], v[180:183], v[40:43], v[116:131]
  v_cvt_pk_bf16_f32 v44, v108, v109
  v_exp_f32 v112, v112
  v_exp_f32 v113, v113
  v_cvt_pk_bf16_f32 v45, v110, v111
  v_exp_f32 v114, v114
  v_exp_f32 v115, v115
  v_cvt_pk_bf16_f32 v46, v112, v113
  v_cvt_pk_bf16_f32 v47, v114, v115
  s_waitcnt lgkmcnt(3)
  s_nop 0
  v_mfma_f32_32x32x16_bf16 v[116:131], v[184:187], v[44:47], v[116:131]
  s_cmp_eq_u32 s75, 4
  s_cbranch_scc1 L_hook_4
L_back_4:
  v_exp_f32 v68, v68
  v_exp_f32 v69, v69
  v_exp_f32 v70, v70
  s_waitcnt lgkmcnt(1)
  v_mfma_f32_32x32x16_bf16 v[84:99], v[48:51], v[4:7], v[148:163]
  v_exp_f32 v71, v71
  v_cvt_pk_bf16_f32 v40, v68, v69
  v_exp_f32 v72, v72
  v_exp_f32 v73, v73
  v_cvt_pk_bf16_f32 v41, v70, v71
  s_waitcnt lgkmcnt(0)
  v_mfma_f32_32x32x8bf16_1k v[84:99], v[188:189], v[12:13], v[84:99]
  v_exp_f32 v74, v74
  v_exp_f32 v75, v75
  v_cvt_pk_bf16_f32 v42, v72, v73
  v_exp_f32 v76, v76
  v_exp_f32 v77, v77
  v_cvt_pk_bf16_f32 v43, v74, v75
  v_exp_f32 v78, v78
  v_exp_f32 v79, v79
  v_mfma_f32_32x32x16_bf16 v[132:147], v[180:183], v[40:43], v[132:147]
  v_cvt_pk_bf16_f32 v44, v76, v77
  v_exp_f32 v80, v80
  v_exp_f32 v81, v81
  v_cvt_pk_bf16_f32 v45, v78, v79
  v_exp_f32 v82, v82
  v_exp_f32 v83, v83
  v_cvt_pk_bf16_f32 v46, v80, v81
  v_cvt_pk_bf16_f32 v47, v82, v83
  s_nop 1
  v_mfma_f32_32x32x16_bf16 v[132:147], v[184:187], v[44:47], v[132:147]
  ds_read_b64_tr_b16 v[180:181], v36 offset:1280
  ds_read_b64_tr_b16 v[182:183], v36 offset:1408
  ds_read_b64_tr_b16 v[184:185], v36 offset:1288
  ds_read_b64_tr_b16 v[186:187], v36 offset:1416
  v_exp_f32 v84, v84
  v_exp_f32 v85, v85
  v_exp_f32 v86, v86
  v_mfma_f32_32x32x16_bf16 v[100:115], v[48:51], v[8:11], v[164:179]
  v_exp_f32 v87, v87
  v_cvt_pk_bf16_f32 v40, v84, v85
  v_exp_f32 v88, v88
  v_exp_f32 v89, v89
  v_cvt_pk_bf16_f32 v41, v86, v87
  v_mfma_f32_32x32x8bf16_1k v[100:115], v[188:189], v[14:15], v[100:115]
  v_exp_f32 v90, v90
  v_exp_f32 v91, v91
  ds_read_b64 v[48:49], v2 offset:1024
  ds_read_b64 v[50:51], v2 offset:9344
  ds_read_b64 v[188:189], v3 offset:1024
  v_cvt_pk_bf16_f32 v42, v88, v89
  v_exp_f32 v92, v92
  v_exp_f32 v93, v93
  v_cvt_pk_bf16_f32 v43, v90, v91
  v_exp_f32 v94, v94
  v_exp_f32 v95, v95
  s_waitcnt lgkmcnt(5)
  v_mfma_f32_32x32x16_bf16 v[116:131], v[180:183], v[40:43], v[116:131]
  v_cvt_pk_bf16_f32 v44, v92, v93
  v_exp_f32 v96, v96
  v_exp_f32 v97, v97
  v_cvt_pk_bf16_f32 v45, v94, v95
  v_exp_f32 v98, v98
  v_exp_f32 v99, v99
  v_cvt_pk_bf16_f32 v46, v96, v97
  v_cvt_pk_bf16_f32 v47, v98, v99
  s_waitcnt lgkmcnt(3)
  s_nop 0
  v_mfma_f32_32x32x16_bf16 v[116:131], v[184:187], v[44:47], v[116:131]
  v_exp_f32 v100, v100
  v_exp_f32 v101, v101
  v_exp_f32 v102, v102
  s_waitcnt lgkmcnt(1)
  v_mfma_f32_32x32x16_bf16 v[68:83], v[48:51], v[4:7], v[148:163]
  v_exp_f32 v103, v103
  v_cvt_pk_bf16_f32 v40, v100, v101
  v_exp_f32 v104, v104
  v_exp_f32 v105, v105
  v_cvt_pk_bf16_f32 v41, v102, v103
  s_waitcnt lgkmcnt(0)
  v_mfma_f32_32x32x8bf16_1k v[68:83], v[188:189], v[12:13], v[68:83]
  v_exp_f32 v106, v106
  v_exp_f32 v107, v107
  v_cvt_pk_bf16_f32 v42, v104, v105
  v_exp_f32 v108, v108
  v_exp_f32 v109, v109
  v_cvt_pk_bf16_f32 v43, v106, v107
  v_exp_f32 v110, v110
  v_exp_f32 v111, v111
  v_mfma_f32_32x32x16_bf16 v[132:147], v[180:183], v[40:43], v[132:147]
  v_cvt_pk_bf16_f32 v44, v108, v109
  v_exp_f32 v112, v112
  v_exp_f32 v113, v113
  v_cvt_pk_bf16_f32 v45, v110, v111
  v_exp_f32 v114, v114
  v_exp_f32 v115, v115
  v_cvt_pk_bf16_f32 v46, v112, v113
  v_cvt_pk_bf16_f32 v47, v114, v115
  s_nop 1
  v_mfma_f32_32x32x16_bf16 v[132:147], v[184:187], v[44:47], v[132:147]
  ds_read_b64_tr_b16 v[180:181], v36 offset:1024
  ds_read_b64_tr_b16 v[182:183], v36 offset:1152
  ds_read_b64_tr_b16 v[184:185], v36 offset:1032
  ds_read_b64_tr_b16 v[186:187], v36 offset:1160
  v_exp_f32 v68, v68
  v_exp_f32 v69, v69
  v_exp_f32 v70, v70
  v_mfma_f32_32x32x16_bf16 v[84:99], v[48:51], v[8:11], v[164:179]
  v_exp_f32 v71, v71
  v_cvt_pk_bf16_f32 v40, v68, v69
  v_exp_f32 v72, v72
  v_exp_f32 v73, v73
  v_cvt_pk_bf16_f32 v41, v70, v71
  v_mfma_f32_32x32x8bf16_1k v[84:99], v[188:189], v[14:15], v[84:99]
  v_exp_f32 v74, v74
  v_exp_f32 v75, v75
  ds_read_b64 v[48:49], v2 offset:768
  ds_read_b64 v[50:51], v2 offset:9088
  ds_read_b64 v[188:189], v3 offset:768
  v_cvt_pk_bf16_f32 v42, v72, v73
  v_exp_f32 v76, v76
  v_exp_f32 v77, v77
  v_cvt_pk_bf16_f32 v43, v74, v75
  v_exp_f32 v78, v78
  v_exp_f32 v79, v79
  s_waitcnt lgkmcnt(5)
  v_mfma_f32_32x32x16_bf16 v[116:131], v[180:183], v[40:43], v[116:131]
  v_cvt_pk_bf16_f32 v44, v76, v77
  v_exp_f32 v80, v80
  v_exp_f32 v81, v81
  v_cvt_pk_bf16_f32 v45, v78, v79
  v_exp_f32 v82, v82
  v_exp_f32 v83, v83
  v_cvt_pk_bf16_f32 v46, v80, v81
  v_cvt_pk_bf16_f32 v47, v82, v83
  s_waitcnt lgkmcnt(3)
  s_nop 0
  v_mfma_f32_32x32x16_bf16 v[116:131], v[184:187], v[44:47], v[116:131]
  s_cmp_eq_u32 s75, 6
  s_cbranch_scc1 L_hook_6
L_back_6:
  v_exp_f32 v84, v84
  v_exp_f32 v85, v85
  v_exp_f32 v86, v86
  s_waitcnt lgkmcnt(1)
  v_mfma_f32_32x32x16_bf16 v[100:115], v[48:51], v[4:7], v[148:163]
  v_exp_f32 v87, v87
  v_cvt_pk_bf16_f32 v40, v84, v85
  v_exp_f32 v88, v88
  v_exp_f32 v89, v89
  v_cvt_pk_bf16_f32 v41, v86, v87
  s_waitcnt lgkmcnt(0)
  v_mfma_f32_32x32x8bf16_1k v[100:115], v[188:189], v[12:13], v[100:115]
  v_exp_f32 v90, v90
  v_exp_f32 v91, v91
  v_cvt_pk_bf16_f32 v42, v88, v89
  v_exp_f32 v92, v92
  v_exp_f32 v93, v93
  v_cvt_pk_bf16_f32 v43, v90, v91
  v_exp_f32 v94, v94
  v_exp_f32 v95, v95
  v_mfma_f32_32x32x16_bf16 v[132:147], v[180:183], v[40:43], v[132:147]
  v_cvt_pk_bf16_f32 v44, v92, v93
  v_exp_f32 v96, v96
  v_exp_f32 v97, v97
  v_cvt_pk_bf16_f32 v45, v94, v95
  v_exp_f32 v98, v98
  v_exp_f32 v99, v99
  v_cvt_pk_bf16_f32 v46, v96, v97
  v_cvt_pk_bf16_f32 v47, v98, v99
  s_nop 1
  v_mfma_f32_32x32x16_bf16 v[132:147], v[184:187], v[44:47], v[132:147]
  ds_read_b64_tr_b16 v[180:181], v36 offset:768
  ds_read_b64_tr_b16 v[182:183], v36 offset:896
  ds_read_b64_tr_b16 v[184:185], v36 offset:776
  ds_read_b64_tr_b16 v[186:187], v36 offset:904
  v_exp_f32 v100, v100
  v_exp_f32 v101, v101
  v_exp_f32 v102, v102
  v_mfma_f32_32x32x16_bf16 v[68:83], v[48:51], v[8:11], v[164:179]
  v_exp_f32 v103, v103
  v_cvt_pk_bf16_f32 v40, v100, v101
  v_exp_f32 v104, v104
  v_exp_f32 v105, v105
  v_cvt_pk_bf16_f32 v41, v102, v103
  v_mfma_f32_32x32x8bf16_1k v[68:83], v[188:189], v[14:15], v[68:83]
  v_exp_f32 v106, v106
  v_exp_f32 v107, v107
  ds_read_b64 v[48:49], v2 offset:512
  ds_read_b64 v[50:51], v2 offset:8832
  ds_read_b64 v[188:189], v3 offset:512
  v_cvt_pk_bf16_f32 v42, v104, v105
  v_exp_f32 v108, v108
  v_exp_f32 v109, v109
  v_cvt_pk_bf16_f32 v43, v106, v107
  v_exp_f32 v110, v110
  v_exp_f32 v111, v111
  s_waitcnt lgkmcnt(5)
  v_mfma_f32_32x32x16_bf16 v[116:131], v[180:183], v[40:43], v[116:131]
  v_cvt_pk_bf16_f32 v44, v108, v109
  v_exp_f32 v112, v112
  v_exp_f32 v113, v113
  v_cvt_pk_bf16_f32 v45, v110, v111
  v_exp_f32 v114, v114
  v_exp_f32 v115, v115
  v_cvt_pk_bf16_f32 v46, v112, v113
  v_cvt_pk_bf16_f32 v47, v114, v115
  s_waitcnt lgkmcnt(3)
  s_nop 0
  v_mfma_f32_32x32x16_bf16 v[116:131], v[184:187], v[44:47], v[116:131]
  v_exp_f32 v68, v68
  v_exp_f32 v69, v69
  v_exp_f32 v70, v70
  s_waitcnt lgkmcnt(1)
  v_mfma_f32_32x32x16_bf16 v[84:99], v[48:51], v[4:7], v[148:163]
  v_exp_f32 v71, v71
  v_cvt_pk_bf16_f32 v40, v68, v69
  v_exp_f32 v72, v72
  v_exp_f32 v73, v73
  v_cvt_pk_bf16_f32 v41, v70, v71
  s_waitcnt lgkmcnt(0)
  v_mfma_f32_32x32x8bf16_1k v[84:99], v[188:189], v[12:13], v[84:99]
  v_exp_f32 v74, v74
  v_exp_f32 v75, v75
  v_cvt_pk_bf16_f32 v42, v72, v73
  v_exp_f32 v76, v76
  v_exp_f32 v77, v77
  v_cvt_pk_bf16_f32 v43, v74, v75
  v_exp_f32 v78, v78
  v_exp_f32 v79, v79
  v_mfma_f32_32x32x16_bf16 v[132:147], v[180:183], v[40:43], v[132:147]
  v_cvt_pk_bf16_f32 v44, v76, v77
  v_exp_f32 v80, v80
  v_exp_f32 v81, v81
  v_cvt_pk_bf16_f32 v45, v78, v79
  v_exp_f32 v82, v82
  v_exp_f32 v83, v83
  v_cvt_pk_bf16_f32 v46, v80, v81
  v_cvt_pk_bf16_f32 v47, v82, v83
  s_nop 1
  v_mfma_f32_32x32x16_bf16 v[132:147], v[184:187], v[44:47], v[132:147]
  ds_read_b64_tr_b16 v[180:181], v36 offset:512
  ds_read_b64_tr_b16 v[182:183], v36 offset:640
  ds_read_b64_tr_b16 v[184:185], v36 offset:520
  ds_read_b64_tr_b16 v[186:187], v36 offset:648
  v_exp_f32 v84, v84
  v_exp_f32 v85, v85
  v_exp_f32 v86, v86
  v_mfma_f32_32x32x16_bf16 v[100:115], v[48:51], v[8:11], v[164:179]
  v_exp_f32 v87, v87
  v_cvt_pk_bf16_f32 v40, v84, v85
  v_exp_f32 v88, v88
  v_exp_f32 v89, v89
  v_cvt_pk_bf16_f32 v41, v86, v87
  v_mfma_f32_32x32x8bf16_1k v[100:115], v[188:189], v[14:15], v[100:115]
  v_exp_f32 v90, v90
  v_exp_f32 v91, v91
  ds_read_b64 v[48:49], v2 offset:256
  ds_read_b64 v[50:51], v2 offset:8576
  ds_read_b64 v[188:189], v3 offset:256
  v_cvt_pk_bf16_f32 v42, v88, v89
  v_exp_f32 v92, v92
  v_exp_f32 v93, v93
  v_cvt_pk_bf16_f32 v43, v90, v91
  v_exp_f32 v94, v94
  v_exp_f32 v95, v95
  s_waitcnt lgkmcnt(5)
  v_mfma_f32_32x32x16_bf16 v[116:131], v[180:183], v[40:43], v[116:131]
  v_cvt_pk_bf16_f32 v44, v92, v93
  v_exp_f32 v96, v96
  v_exp_f32 v97, v97
  v_cvt_pk_bf16_f32 v45, v94, v95
  v_exp_f32 v98, v98
  v_exp_f32 v99, v99
  v_cvt_pk_bf16_f32 v46, v96, v97
  v_cvt_pk_bf16_f32 v47, v98, v99
  s_waitcnt lgkmcnt(3)
  s_nop 0
  v_mfma_f32_32x32x16_bf16 v[116:131], v[184:187], v[44:47], v[116:131]
  s_cmp_eq_u32 s75, 8
  s_cbranch_scc1 L_hook_8
L_back_8:
  v_sub_f32 v148, v52, v190
  v_sub_f32 v149, v53, v190
  v_sub_f32 v150, v54, v190
  v_sub_f32 v151, v55, v190
  v_sub_f32 v152, v56, v190
  v_sub_f32 v153, v57, v190
  v_sub_f32 v154, v58, v190
  v_sub_f32 v155, v59, v190
  v_sub_f32 v156, v60, v190
  v_sub_f32 v157, v61, v190
  v_sub_f32 v158, v62, v190
  v_sub_f32 v159, v63, v190
  v_sub_f32 v160, v64, v190
  v_sub_f32 v161, v65, v190
  v_sub_f32 v162, v66, v190
  v_sub_f32 v163, v67, v190
  v_exp_f32 v100, v100
  v_exp_f32 v101, v101
  v_exp_f32 v102, v102
  s_waitcnt lgkmcnt(1)
  v_mfma_f32_32x32x16_bf16 v[68:83], v[48:51], v[4:7], v[148:163]
  v_exp_f32 v103, v103
  v_cvt_pk_bf16_f32 v40, v100, v101
  v_exp_f32 v104, v104
  v_exp_f32 v105, v105
  v_cvt_pk_bf16_f32 v41, v102, v103
  s_waitcnt lgkmcnt(0)
  v_mfma_f32_32x32x8bf16_1k v[68:83], v[188:189], v[12:13], v[68:83]
  v_exp_f32 v106, v106
  v_exp_f32 v107, v107
  v_cvt_pk_bf16_f32 v42, v104, v105
  v_exp_f32 v108, v108
  v_exp_f32 v109, v109
  v_cvt_pk_bf16_f32 v43, v106, v107
  v_exp_f32 v110, v110
  v_exp_f32 v111, v111
  v_mfma_f32_32x32x16_bf16 v[132:147], v[180:183], v[40:43], v[132:147]
  v_cvt_pk_bf16_f32 v44, v108, v109
  v_exp_f32 v112, v112
  v_exp_f32 v113, v113
  v_cvt_pk_bf16_f32 v45, v110, v111
  v_exp_f32 v114, v114
  v_exp_f32 v115, v115
  v_cvt_pk_bf16_f32 v46, v112, v113
  v_cvt_pk_bf16_f32 v47, v114, v115
  s_nop 1
  v_mfma_f32_32x32x16_bf16 v[132:147], v[184:187], v[44:47], v[132:147]
  ds_read_b64_tr_b16 v[180:181], v36 offset:256
  ds_read_b64_tr_b16 v[182:183], v36 offset:384
  ds_read_b64_tr_b16 v[184:185], v36 offset:264
  ds_read_b64_tr_b16 v[186:187], v36 offset:392
  v_exp_f32 v68, v68
  v_exp_f32 v69, v69
  v_exp_f32 v70, v70
  v_mfma_f32_32x32x16_bf16 v[84:99], v[48:51], v[8:11], v[164:179]
  v_exp_f32 v71, v71
  v_cvt_pk_bf16_f32 v40, v68, v69
  v_exp_f32 v72, v72
  v_exp_f32 v73, v73
  v_cvt_pk_bf16_f32 v41, v70, v71
  v_mfma_f32_32x32x8bf16_1k v[84:99], v[188:189], v[14:15], v[84:99]
  v_exp_f32 v74, v74
  v_exp_f32 v75, v75
  ds_read_b64 v[48:49], v2 offset:0
  ds_read_b64 v[50:51], v2 offset:8320
  ds_read_b64 v[188:189], v3 offset:0
  v_cvt_pk_bf16_f32 v42, v72, v73
  v_exp_f32 v76, v76
  v_exp_f32 v77, v77
  v_cvt_pk_bf16_f32 v43, v74, v75
  v_exp_f32 v78, v78
  v_exp_f32 v79, v79
  s_waitcnt lgkmcnt(5)
  v_mfma_f32_32x32x16_bf16 v[116:131], v[180:183], v[40:43], v[116:131]
  v_cvt_pk_bf16_f32 v44, v76, v77
  v_exp_f32 v80, v80
  v_exp_f32 v81, v81
  v_cvt_pk_bf16_f32 v45, v78, v79
  v_exp_f32 v82, v82
  v_exp_f32 v83, v83
  v_cvt_pk_bf16_f32 v46, v80, v81
  v_cvt_pk_bf16_f32 v47, v82, v83
  s_waitcnt lgkmcnt(3)
  s_nop 0
  v_mfma_f32_32x32x16_bf16 v[116:131], v[184:187], v[44:47], v[116:131]
  v_sub_f32 v164, v52, v191
  v_sub_f32 v165, v53, v191
  v_sub_f32 v166, v54, v191
  v_sub_f32 v167, v55, v191
  v_sub_f32 v168, v56, v191
  v_sub_f32 v169, v57, v191
  v_sub_f32 v170, v58, v191
  v_sub_f32 v171, v59, v191
  v_sub_f32 v172, v60, v191
  v_sub_f32 v173, v61, v191
  v_sub_f32 v174, v62, v191
  v_sub_f32 v175, v63, v191
  v_sub_f32 v176, v64, v191
  v_sub_f32 v177, v65, v191
  v_sub_f32 v178, v66, v191
  v_sub_f32 v179, v67, v191
  v_exp_f32 v84, v84
  v_exp_f32 v85, v85
  v_exp_f32 v86, v86
  s_waitcnt lgkmcnt(1)
  v_mfma_f32_32x32x16_bf16 v[100:115], v[48:51], v[8:11], v[164:179]
  v_exp_f32 v87, v87
  v_cvt_pk_bf16_f32 v40, v84, v85
  v_exp_f32 v88, v88
  v_exp_f32 v89, v89
  v_cvt_pk_bf16_f32 v41, v86, v87
  s_waitcnt lgkmcnt(0)
  v_mfma_f32_32x32x8bf16_1k v[100:115], v[188:189], v[14:15], v[100:115]
  v_exp_f32 v90, v90
  v_exp_f32 v91, v91
  v_cvt_pk_bf16_f32 v42, v88, v89
  v_exp_f32 v92, v92
  v_exp_f32 v93, v93
  v_cvt_pk_bf16_f32 v43, v90, v91
  v_exp_f32 v94, v94
  v_exp_f32 v95, v95
  v_mfma_f32_32x32x16_bf16 v[132:147], v[180:183], v[40:43], v[132:147]
  v_cvt_pk_bf16_f32 v44, v92, v93
  v_exp_f32 v96, v96
  v_exp_f32 v97, v97
  v_cvt_pk_bf16_f32 v45, v94, v95
  v_exp_f32 v98, v98
  v_exp_f32 v99, v99
  v_cvt_pk_bf16_f32 v46, v96, v97
  v_cvt_pk_bf16_f32 v47, v98, v99
  s_nop 1
  v_mfma_f32_32x32x16_bf16 v[132:147], v[184:187], v[44:47], v[132:147]
  ds_read_b64_tr_b16 v[180:181], v36 offset:0
  ds_read_b64_tr_b16 v[182:183], v36 offset:128
  ds_read_b64_tr_b16 v[184:185], v36 offset:8
  ds_read_b64_tr_b16 v[186:187], v36 offset:136
  v_exp_f32 v100, v100
  v_exp_f32 v101, v101
  v_exp_f32 v102, v102
  v_exp_f32 v103, v103
  v_cvt_pk_bf16_f32 v40, v100, v101
  v_exp_f32 v104, v104
  v_exp_f32 v105, v105
  v_cvt_pk_bf16_f32 v41, v102, v103
  v_exp_f32 v106, v106
  v_exp_f32 v107, v107
  v_cvt_pk_bf16_f32 v42, v104, v105
  v_exp_f32 v108, v108
  v_exp_f32 v109, v109
  v_cvt_pk_bf16_f32 v43, v106, v107
  v_exp_f32 v110, v110
  v_exp_f32 v111, v111
  s_waitcnt lgkmcnt(2)
  v_mfma_f32_32x32x16_bf16 v[132:147], v[180:183], v[40:43], v[132:147]
  v_cvt_pk_bf16_f32 v44, v108, v109
  v_exp_f32 v112, v112
  v_exp_f32 v113, v113
  v_cvt_pk_bf16_f32 v45, v110, v111
  v_exp_f32 v114, v114
  v_exp_f32 v115, v115
  v_cvt_pk_bf16_f32 v46, v112, v113
  v_cvt_pk_bf16_f32 v47, v114, v115
  s_waitcnt lgkmcnt(0)
  s_nop 0
  v_mfma_f32_32x32x16_bf16 v[132:147], v[184:187], v[44:47], v[132:147]
  s_mov_b32 s60, 0x53800000
  v_cndmask_b32_e64 v190, v128, v124, s[72:73]
  s_nop 9
  v_cndmask_b32_e64 v191, v144, v140, s[72:73]
  v_cmp_nge_f32 vcc, s60, v190
  v_cmp_nge_f32 s[68:69], s60, v191
  s_nop 0
  s_or_b64 vcc, vcc, s[68:69]
  s_cmp_eq_u32 s76, 0
  s_cselect_b64 vcc, vcc, 0
  s_cbranch_vccnz L_fb
  v_rcp_f32 v190, v190
  v_rcp_f32 v191, v191
  v_mul_f32 v116, v116, v190
  v_mul_f32 v117, v117, v190
  v_mul_f32 v118, v118, v190
  v_mul_f32 v119, v119, v190
  v_mul_f32 v120, v120, v190
  v_mul_f32 v121, v121, v190
  v_mul_f32 v122, v122, v190
  v_mul_f32 v123, v123, v190
  v_mul_f32 v124, v124, v190
  v_mul_f32 v125, v125, v190
  v_mul_f32 v126, v126, v190
  v_mul_f32 v127, v127, v190
  v_cvt_pk_bf16_f32 v68, v116, v117
  v_cvt_pk_bf16_f32 v69, v118, v119
  v_cvt_pk_bf16_f32 v70, v120, v121
  v_cvt_pk_bf16_f32 v71, v122, v123
  v_cvt_pk_bf16_f32 v72, v124, v125
  v_cvt_pk_bf16_f32 v73, v126, v127
  buffer_store_dwordx2 v[68:69], v16, s[12:15], s67 offen
  buffer_store_dwordx2 v[70:71], v17, s[12:15], s67 offen
  buffer_store_dwordx2 v[72:73], v18, s[12:15], s67 offen
  v_mul_f32 v132, v132, v191
  v_mul_f32 v133, v133, v191
  v_mul_f32 v134, v134, v191
  v_mul_f32 v135, v135, v191
  v_mul_f32 v136, v136, v191
  v_mul_f32 v137, v137, v191
  v_mul_f32 v138, v138, v191
  v_mul_f32 v139, v139, v191
  v_mul_f32 v140, v140, v191
  v_mul_f32 v141, v141, v191
  v_mul_f32 v142, v142, v191
  v_mul_f32 v143, v143, v191
  v_cvt_pk_bf16_f32 v74, v132, v133
  v_cvt_pk_bf16_f32 v75, v134, v135
  v_cvt_pk_bf16_f32 v76, v136, v137
  v_cvt_pk_bf16_f32 v77, v138, v139
  v_cvt_pk_bf16_f32 v78, v140, v141
  v_cvt_pk_bf16_f32 v79, v142, v143
  buffer_store_dwordx2 v[74:75], v16, s[12:15], s66 offen
  buffer_store_dwordx2 v[76:77], v17, s[12:15], s66 offen
  buffer_store_dwordx2 v[78:79], v18, s[12:15], s66 offen
  s_lshl_b32 s60, s54, 12
  s_lshl_b32 s61, s55, 2
  s_add_u32 s60, s60, s61
  s_lshl_b32 s61, s57, 7
  s_add_u32 s60, s60, s61
  s_add_u32 s60, s60, 66048
  v_mov_b32 v2, 0
  v_mov_b32 v3, s52
  s_mov_b64 exec, 1
  s_cmp_lg_u32 s59, 0
  s_waitcnt vmcnt(0)
  s_cbranch_scc1 L_sigslow_17
  buffer_store_dword v3, v2, s[12:15], s60 offen
L_sigdone_18:
  s_mov_b64 exec, -1
  v_cmp_ne_u64 vcc, s[52:53], v[34:35]
  s_nop 3
  s_cbranch_vccnz L_modagain_19
L_modhave_20:
  s_cmp_eq_u32 s57, 2
  s_cselect_b32 s63, 1.0, 0
  v_lshlrev_b32 v34, 16, v33
  v_and_b32 v35, 0xffff0000, v33
  v_and_b32 v33, 0xffff0000, v32
  v_lshlrev_b32 v32, 16, v32
  v_add_f32 v32, s63, v32
  v_add_f32 v33, s63, v33
  v_add_f32 v34, s63, v34
  v_add_f32 v35, s63, v35
  s_mul_i32 s62, s57, 320
  v_min_u32 v39, 19, v1
  v_lshl_add_u32 v39, v39, 4, s62
  ds_write_b128 v39, v[32:35] offset:0
  v_lshlrev_b32 v40, 16, v20
  v_and_b32 v41, 0xffff0000, v20
  v_lshlrev_b32 v42, 16, v21
  v_and_b32 v43, 0xffff0000, v21
  v_lshlrev_b32 v44, 16, v22
  v_and_b32 v45, 0xffff0000, v22
  v_lshlrev_b32 v46, 16, v23
  v_and_b32 v47, 0xffff0000, v23
  v_lshlrev_b32 v48, 16, v24
  v_and_b32 v49, 0xffff0000, v24
  v_lshlrev_b32 v50, 16, v25
  v_and_b32 v51, 0xffff0000, v25
  v_lshlrev_b32 v52, 16, v26
  v_and_b32 v53, 0xffff0000, v26
  v_lshlrev_b32 v54, 16, v27
  v_and_b32 v55, 0xffff0000, v27
  v_lshlrev_b32 v56, 16, v28
  v_and_b32 v57, 0xffff0000, v28
  v_lshlrev_b32 v58, 16, v29
  v_and_b32 v59, 0xffff0000, v29
  s_mul_i32 s60, s54, 327680
  s_and_b32 s61, s57, 1
  s_mul_i32 s61, s61, 10240
  s_add_u32 s60, s60, s61
  s_cmp_eq_u32 s59, 0
  s_cselect_b32 s61, 11534336, 0
  s_add_u32 s60, s60, s61
  s_add_u32 s60, s60, 3670016
  s_lshl_b32 s61, s77, 2
  s_add_u32 s62, s61, s57
  s_mul_i32 s66, s62, 20480
  s_add_u32 s66, s66, s60
  s_xor_b32 s62, s62, 1
  s_mul_i32 s67, s62, 20480
  s_add_u32 s67, s67, s60
  s_lshl_b32 s61, s77, 7
  s_add_u32 s62, s61, 64
  s_lshl_b32 s60, s54, 12
  s_add_u32 s60, s60, 66048
  v_and_b32 v3, 15, v1
  v_lshl_add_u32 v3, v3, 2, s61
  s_sub_u32 s62, s62, s61
  v_add_u32 v4, s62, v3
  v_cndmask_b32_e64 v3, v3, v4, s[72:73]
  s_mov_b32 s74, 0
L_poll_21:
  buffer_load_dword v4, v3, s[12:15], s60 offen sc1
  s_add_u32 s74, s74, 1
  s_cmp_gt_u32 s74, 131072
  s_cbranch_scc1 L_pdone_22
  s_waitcnt vmcnt(0)
  v_cmp_ne_u32 vcc, s52, v4
  s_nop 3
  s_cbranch_vccnz L_poll_21
L_pdone_22:
  s_waitcnt vmcnt(0)
  s_cmp_eq_u32 s59, 0
  s_cbranch_scc1 L_noacq_23
  buffer_inv sc1
  s_waitcnt vmcnt(0)
L_noacq_23:
  s_waitcnt lgkmcnt(0)
  buffer_load_dwordx4 v[4:7], v0, s[12:15], s66 offen offset:0 sc1
  buffer_load_dwordx4 v[8:11], v0, s[12:15], s67 offen offset:0 sc1
  buffer_load_dwordx4 v[12:15], v0, s[12:15], s66 offen offset:1024 sc1
  buffer_load_dwordx4 v[20:23], v0, s[12:15], s67 offen offset:1024 sc1
  buffer_load_dwordx4 v[24:27], v0, s[12:15], s66 offen offset:2048 sc1
  buffer_load_dwordx4 v[32:35], v0, s[12:15], s67 offen offset:2048 sc1
  s_barrier
  ds_read_b64_tr_b16 v[116:117], v31 offset:0
  ds_read_b64_tr_b16 v[118:119], v31 offset:1280
  ds_read_b64_tr_b16 v[120:121], v31 offset:32
  ds_read_b64_tr_b16 v[122:123], v31 offset:1312
  ds_read_b64_tr_b16 v[124:125], v31 offset:64
  ds_read_b64_tr_b16 v[126:127], v31 offset:1344
  ds_read_b64_tr_b16 v[128:129], v31 offset:96
  ds_read_b64_tr_b16 v[130:131], v31 offset:1376
  ds_read_b64_tr_b16 v[132:133], v31 offset:128
  ds_read_b64_tr_b16 v[134:135], v31 offset:1408
  s_waitcnt vmcnt(5) lgkmcnt(8)
  v_mfma_f32_16x16x32_bf16 v[156:159], v[116:119], v[4:7], 0
  ds_read_b64_tr_b16 v[136:137], v31 offset:5120
  s_waitcnt vmcnt(4)
  v_mfma_f32_16x16x32_bf16 v[176:179], v[116:119], v[8:11], 0
  ds_read_b64_tr_b16 v[138:139], v31 offset:6400
  buffer_load_dwordx4 v[60:63], v0, s[12:15], s66 offen offset:3072 sc1
  s_waitcnt lgkmcnt(8)
  v_mfma_f32_16x16x32_bf16 v[160:163], v[120:123], v[4:7], 0
  ds_read_b64_tr_b16 v[140:141], v31 offset:5152
  v_mfma_f32_16x16x32_bf16 v[180:183], v[120:123], v[8:11], 0
  ds_read_b64_tr_b16 v[142:143], v31 offset:6432
  buffer_load_dwordx4 v[64:67], v0, s[12:15], s67 offen offset:3072 sc1
  s_add_u32 s66, s66, 4096
  s_add_u32 s67, s67, 4096
  s_waitcnt lgkmcnt(8)
  v_mfma_f32_16x16x32_bf16 v[164:167], v[124:127], v[4:7], 0
  ds_read_b64_tr_b16 v[144:145], v31 offset:5184
  v_mfma_f32_16x16x32_bf16 v[184:187], v[124:127], v[8:11], 0
  ds_read_b64_tr_b16 v[146:147], v31 offset:6464
  buffer_load_dwordx4 v[68:71], v0, s[12:15], s66 offen offset:0 sc1
  s_waitcnt lgkmcnt(8)
  v_mfma_f32_16x16x32_bf16 v[168:171], v[128:131], v[4:7], 0
  ds_read_b64_tr_b16 v[148:149], v31 offset:5216
  v_mfma_f32_16x16x32_bf16 v[188:191], v[128:131], v[8:11], 0
  ds_read_b64_tr_b16 v[150:151], v31 offset:6496
  buffer_load_dwordx4 v[72:75], v0, s[12:15], s67 offen offset:0 sc1
  s_waitcnt lgkmcnt(8)
  v_mfma_f32_16x16x32_bf16 v[172:175], v[132:135], v[4:7], 0
  ds_read_b64_tr_b16 v[152:153], v31 offset:5248
  v_mfma_f32_16x16x32_bf16 v[192:195], v[132:135], v[8:11], 0
  ds_read_b64_tr_b16 v[154:155], v31 offset:6528
  s_waitcnt vmcnt(7) lgkmcnt(8)
  v_mfma_f32_16x16x32_bf16 v[156:159], v[136:139], v[12:15], v[156:159]
  ds_read_b64_tr_b16 v[116:117], v31 offset:10240
  s_waitcnt vmcnt(6)
  v_mfma_f32_16x16x32_bf16 v[176:179], v[136:139], v[20:23], v[176:179]
  ds_read_b64_tr_b16 v[118:119], v31 offset:11520
  buffer_load_dwordx4 v[76:79], v0, s[12:15], s66 offen offset:1024 sc1
  s_waitcnt lgkmcnt(8)
  v_mfma_f32_16x16x32_bf16 v[160:163], v[140:143], v[12:15], v[160:163]
  ds_read_b64_tr_b16 v[120:121], v31 offset:10272
  v_mfma_f32_16x16x32_bf16 v[180:183], v[140:143], v[20:23], v[180:183]
  ds_read_b64_tr_b16 v[122:123], v31 offset:11552
  buffer_load_dwordx4 v[80:83], v0, s[12:15], s67 offen offset:1024 sc1
  s_waitcnt lgkmcnt(8)
  v_mfma_f32_16x16x32_bf16 v[164:167], v[144:147], v[12:15], v[164:167]
  ds_read_b64_tr_b16 v[124:125], v31 offset:10304
  v_mfma_f32_16x16x32_bf16 v[184:187], v[144:147], v[20:23], v[184:187]
  ds_read_b64_tr_b16 v[126:127], v31 offset:11584
  buffer_load_dwordx4 v[84:87], v0, s[12:15], s66 offen offset:2048 sc1
  s_waitcnt lgkmcnt(8)
  v_mfma_f32_16x16x32_bf16 v[168:171], v[148:151], v[12:15], v[168:171]
  ds_read_b64_tr_b16 v[128:129], v31 offset:10336
  v_mfma_f32_16x16x32_bf16 v[188:191], v[148:151], v[20:23], v[188:191]
  ds_read_b64_tr_b16 v[130:131], v31 offset:11616
  buffer_load_dwordx4 v[88:91], v0, s[12:15], s67 offen offset:2048 sc1
  s_waitcnt lgkmcnt(8)
  v_mfma_f32_16x16x32_bf16 v[172:175], v[152:155], v[12:15], v[172:175]
  ds_read_b64_tr_b16 v[132:133], v31 offset:10368
  v_mfma_f32_16x16x32_bf16 v[192:195], v[152:155], v[20:23], v[192:195]
  ds_read_b64_tr_b16 v[134:135], v31 offset:11648
  s_waitcnt vmcnt(9) lgkmcnt(8)
  v_mfma_f32_16x16x32_bf16 v[156:159], v[116:119], v[24:27], v[156:159]
  ds_read_b64_tr_b16 v[136:137], v31 offset:15360
  s_waitcnt vmcnt(8)
  v_mfma_f32_16x16x32_bf16 v[176:179], v[116:119], v[32:35], v[176:179]
  ds_read_b64_tr_b16 v[138:139], v31 offset:16640
  buffer_load_dwordx4 v[92:95], v0, s[12:15], s66 offen offset:3072 sc1
  s_waitcnt lgkmcnt(8)
  v_mfma_f32_16x16x32_bf16 v[160:163], v[120:123], v[24:27], v[160:163]
  ds_read_b64_tr_b16 v[140:141], v31 offset:15392
  v_mfma_f32_16x16x32_bf16 v[180:183], v[120:123], v[32:35], v[180:183]
  ds_read_b64_tr_b16 v[142:143], v31 offset:16672
  buffer_load_dwordx4 v[96:99], v0, s[12:15], s67 offen offset:3072 sc1
  s_add_u32 s66, s66, 4096
  s_add_u32 s67, s67, 4096
  s_waitcnt lgkmcnt(8)
  v_mfma_f32_16x16x32_bf16 v[164:167], v[124:127], v[24:27], v[164:167]
  ds_read_b64_tr_b16 v[144:145], v31 offset:15424
  v_mfma_f32_16x16x32_bf16 v[184:187], v[124:127], v[32:35], v[184:187]
  ds_read_b64_tr_b16 v[146:147], v31 offset:16704
  buffer_load_dwordx4 v[100:103], v0, s[12:15], s66 offen offset:0 sc1
  s_waitcnt lgkmcnt(8)
  v_mfma_f32_16x16x32_bf16 v[168:171], v[128:131], v[24:27], v[168:171]
  ds_read_b64_tr_b16 v[148:149], v31 offset:15456
  v_mfma_f32_16x16x32_bf16 v[188:191], v[128:131], v[32:35], v[188:191]
  ds_read_b64_tr_b16 v[150:151], v31 offset:16736
  buffer_load_dwordx4 v[104:107], v0, s[12:15], s67 offen offset:0 sc1
  s_waitcnt lgkmcnt(8)
  v_mfma_f32_16x16x32_bf16 v[172:175], v[132:135], v[24:27], v[172:175]
  ds_read_b64_tr_b16 v[152:153], v31 offset:15488
  v_mfma_f32_16x16x32_bf16 v[192:195], v[132:135], v[32:35], v[192:195]
  ds_read_b64_tr_b16 v[154:155], v31 offset:16768
  s_waitcnt vmcnt(11) lgkmcnt(8)
  v_mfma_f32_16x16x32_bf16 v[156:159], v[136:139], v[60:63], v[156:159]
  ds_read_b64_tr_b16 v[116:117], v31 offset:20480
  s_waitcnt vmcnt(10)
  v_mfma_f32_16x16x32_bf16 v[176:179], v[136:139], v[64:67], v[176:179]
  ds_read_b64_tr_b16 v[118:119], v31 offset:21760
  s_waitcnt lgkmcnt(8)
  v_mfma_f32_16x16x32_bf16 v[160:163], v[140:143], v[60:63], v[160:163]
  ds_read_b64_tr_b16 v[120:121], v31 offset:20512
  v_mfma_f32_16x16x32_bf16 v[180:183], v[140:143], v[64:67], v[180:183]
  ds_read_b64_tr_b16 v[122:123], v31 offset:21792
  buffer_load_dwordx4 v[108:111], v0, s[12:15], s66 offen offset:1024 sc1
  s_waitcnt lgkmcnt(8)
  v_mfma_f32_16x16x32_bf16 v[164:167], v[144:147], v[60:63], v[164:167]
  ds_read_b64_tr_b16 v[124:125], v31 offset:20544
  v_mfma_f32_16x16x32_bf16 v[184:187], v[144:147], v[64:67], v[184:187]
  ds_read_b64_tr_b16 v[126:127], v31 offset:21824
  s_waitcnt lgkmcnt(8)
  v_mfma_f32_16x16x32_bf16 v[168:171], v[148:151], v[60:63], v[168:171]
  ds_read_b64_tr_b16 v[128:129], v31 offset:20576
  v_mfma_f32_16x16x32_bf16 v[188:191], v[148:151], v[64:67], v[188:191]
  ds_read_b64_tr_b16 v[130:131], v31 offset:21856
  buffer_load_dwordx4 v[112:115], v0, s[12:15], s67 offen offset:1024 sc1
  s_waitcnt lgkmcnt(8)
  v_mfma_f32_16x16x32_bf16 v[172:175], v[152:155], v[60:63], v[172:175]
  ds_read_b64_tr_b16 v[132:133], v31 offset:20608
  v_mfma_f32_16x16x32_bf16 v[192:195], v[152:155], v[64:67], v[192:195]
  ds_read_b64_tr_b16 v[134:135], v31 offset:21888
  s_barrier
  s_waitcnt vmcnt(11) lgkmcnt(8)
  v_mfma_f32_16x16x32_bf16 v[156:159], v[116:119], v[68:71], v[156:159]
  ds_read_b64_tr_b16 v[136:137], v31 offset:25600
  s_waitcnt vmcnt(10)
  v_mfma_f32_16x16x32_bf16 v[176:179], v[116:119], v[72:75], v[176:179]
  ds_read_b64_tr_b16 v[138:139], v31 offset:26880
  s_waitcnt lgkmcnt(8)
  v_mfma_f32_16x16x32_bf16 v[160:163], v[120:123], v[68:71], v[160:163]
  ds_read_b64_tr_b16 v[140:141], v31 offset:25632
  v_mfma_f32_16x16x32_bf16 v[180:183], v[120:123], v[72:75], v[180:183]
  ds_read_b64_tr_b16 v[142:143], v31 offset:26912
  s_waitcnt lgkmcnt(8)
  v_mfma_f32_16x16x32_bf16 v[164:167], v[124:127], v[68:71], v[164:167]
  ds_read_b64_tr_b16 v[144:145], v31 offset:25664
  v_mfma_f32_16x16x32_bf16 v[184:187], v[124:127], v[72:75], v[184:187]
  ds_read_b64_tr_b16 v[146:147], v31 offset:26944
  s_waitcnt lgkmcnt(8)
  v_mfma_f32_16x16x32_bf16 v[168:171], v[128:131], v[68:71], v[168:171]
  ds_read_b64_tr_b16 v[148:149], v31 offset:25696
  v_mfma_f32_16x16x32_bf16 v[188:191], v[128:131], v[72:75], v[188:191]
  ds_read_b64_tr_b16 v[150:151], v31 offset:26976
  s_waitcnt lgkmcnt(8)
  v_mfma_f32_16x16x32_bf16 v[172:175], v[132:135], v[68:71], v[172:175]
  ds_read_b64_tr_b16 v[152:153], v31 offset:25728
  v_mfma_f32_16x16x32_bf16 v[192:195], v[132:135], v[72:75], v[192:195]
  ds_read_b64_tr_b16 v[154:155], v31 offset:27008
  s_waitcnt vmcnt(9) lgkmcnt(8)
  v_mfma_f32_16x16x32_bf16 v[156:159], v[136:139], v[76:79], v[156:159]
  ds_read_b64_tr_b16 v[116:117], v31 offset:30720
  s_waitcnt vmcnt(8)
  v_mfma_f32_16x16x32_bf16 v[176:179], v[136:139], v[80:83], v[176:179]
  ds_read_b64_tr_b16 v[118:119], v31 offset:32000
  s_waitcnt lgkmcnt(8)
  v_mfma_f32_16x16x32_bf16 v[160:163], v[140:143], v[76:79], v[160:163]
  ds_read_b64_tr_b16 v[120:121], v31 offset:30752
  v_mfma_f32_16x16x32_bf16 v[180:183], v[140:143], v[80:83], v[180:183]
  ds_read_b64_tr_b16 v[122:123], v31 offset:32032
  s_waitcnt lgkmcnt(8)
  v_mfma_f32_16x16x32_bf16 v[164:167], v[144:147], v[76:79], v[164:167]
  ds_read_b64_tr_b16 v[124:125], v31 offset:30784
  v_mfma_f32_16x16x32_bf16 v[184:187], v[144:147], v[80:83], v[184:187]
  ds_read_b64_tr_b16 v[126:127], v31 offset:32064
  s_waitcnt lgkmcnt(8)
  v_mfma_f32_16x16x32_bf16 v[168:171], v[148:151], v[76:79], v[168:171]
  ds_read_b64_tr_b16 v[128:129], v31 offset:30816
  v_mfma_f32_16x16x32_bf16 v[188:191], v[148:151], v[80:83], v[188:191]
  ds_read_b64_tr_b16 v[130:131], v31 offset:32096
  s_waitcnt lgkmcnt(8)
  v_mfma_f32_16x16x32_bf16 v[172:175], v[152:155], v[76:79], v[172:175]
  ds_read_b64_tr_b16 v[132:133], v31 offset:30848
  v_mfma_f32_16x16x32_bf16 v[192:195], v[152:155], v[80:83], v[192:195]
  ds_read_b64_tr_b16 v[134:135], v31 offset:32128
  s_waitcnt vmcnt(7) lgkmcnt(8)
  v_mfma_f32_16x16x32_bf16 v[156:159], v[116:119], v[84:87], v[156:159]
  ds_read_b64_tr_b16 v[136:137], v31 offset:35840
  s_waitcnt vmcnt(6)
  v_mfma_f32_16x16x32_bf16 v[176:179], v[116:119], v[88:91], v[176:179]
  ds_read_b64_tr_b16 v[138:139], v31 offset:37120
  s_waitcnt lgkmcnt(8)
  v_mfma_f32_16x16x32_bf16 v[160:163], v[120:123], v[84:87], v[160:163]
  ds_read_b64_tr_b16 v[140:141], v31 offset:35872
  v_mfma_f32_16x16x32_bf16 v[180:183], v[120:123], v[88:91], v[180:183]
  ds_read_b64_tr_b16 v[142:143], v31 offset:37152
  s_waitcnt lgkmcnt(8)
  v_mfma_f32_16x16x32_bf16 v[164:167], v[124:127], v[84:87], v[164:167]
  ds_read_b64_tr_b16 v[144:145], v31 offset:35904
  v_mfma_f32_16x16x32_bf16 v[184:187], v[124:127], v[88:91], v[184:187]
  ds_read_b64_tr_b16 v[146:147], v31 offset:37184
  s_waitcnt lgkmcnt(8)
  v_mfma_f32_16x16x32_bf16 v[168:171], v[128:131], v[84:87], v[168:171]
  ds_read_b64_tr_b16 v[148:149], v31 offset:35936
  v_mfma_f32_16x16x32_bf16 v[188:191], v[128:131], v[88:91], v[188:191]
  ds_read_b64_tr_b16 v[150:151], v31 offset:37216
  s_waitcnt lgkmcnt(8)
  v_mfma_f32_16x16x32_bf16 v[172:175], v[132:135], v[84:87], v[172:175]
  ds_read_b64_tr_b16 v[152:153], v31 offset:35968
  v_mfma_f32_16x16x32_bf16 v[192:195], v[132:135], v[88:91], v[192:195]
  ds_read_b64_tr_b16 v[154:155], v31 offset:37248
  s_waitcnt vmcnt(5) lgkmcnt(8)
  v_mfma_f32_16x16x32_bf16 v[156:159], v[136:139], v[92:95], v[156:159]
  ds_read_b64_tr_b16 v[116:117], v31 offset:40960
  s_waitcnt vmcnt(4)
  v_mfma_f32_16x16x32_bf16 v[176:179], v[136:139], v[96:99], v[176:179]
  ds_read_b64_tr_b16 v[118:119], v31 offset:42240
  s_waitcnt lgkmcnt(8)
  v_mfma_f32_16x16x32_bf16 v[160:163], v[140:143], v[92:95], v[160:163]
  ds_read_b64_tr_b16 v[120:121], v31 offset:40992
  v_mfma_f32_16x16x32_bf16 v[180:183], v[140:143], v[96:99], v[180:183]
  ds_read_b64_tr_b16 v[122:123], v31 offset:42272
  s_waitcnt lgkmcnt(8)
  v_mfma_f32_16x16x32_bf16 v[164:167], v[144:147], v[92:95], v[164:167]
  ds_read_b64_tr_b16 v[124:125], v31 offset:41024
  v_mfma_f32_16x16x32_bf16 v[184:187], v[144:147], v[96:99], v[184:187]
  ds_read_b64_tr_b16 v[126:127], v31 offset:42304
  s_waitcnt lgkmcnt(8)
  v_mfma_f32_16x16x32_bf16 v[168:171], v[148:151], v[92:95], v[168:171]
  ds_read_b64_tr_b16 v[128:129], v31 offset:41056
  v_mfma_f32_16x16x32_bf16 v[188:191], v[148:151], v[96:99], v[188:191]
  ds_read_b64_tr_b16 v[130:131], v31 offset:42336
  s_waitcnt lgkmcnt(8)
  v_mfma_f32_16x16x32_bf16 v[172:175], v[152:155], v[92:95], v[172:175]
  ds_read_b64_tr_b16 v[132:133], v31 offset:41088
  v_mfma_f32_16x16x32_bf16 v[192:195], v[152:155], v[96:99], v[192:195]
  ds_read_b64_tr_b16 v[134:135], v31 offset:42368
  s_waitcnt vmcnt(3) lgkmcnt(8)
  v_mfma_f32_16x16x32_bf16 v[156:159], v[116:119], v[100:103], v[156:159]
  ds_read_b64_tr_b16 v[136:137], v31 offset:46080
  s_waitcnt vmcnt(2)
  v_mfma_f32_16x16x32_bf16 v[176:179], v[116:119], v[104:107], v[176:179]
  ds_read_b64_tr_b16 v[138:139], v31 offset:47360
  s_waitcnt lgkmcnt(8)
  v_mfma_f32_16x16x32_bf16 v[160:163], v[120:123], v[100:103], v[160:163]
  ds_read_b64_tr_b16 v[140:141], v31 offset:46112
  v_mfma_f32_16x16x32_bf16 v[180:183], v[120:123], v[104:107], v[180:183]
  ds_read_b64_tr_b16 v[142:143], v31 offset:47392
  s_waitcnt lgkmcnt(8)
  v_mfma_f32_16x16x32_bf16 v[164:167], v[124:127], v[100:103], v[164:167]
  ds_read_b64_tr_b16 v[144:145], v31 offset:46144
  v_mfma_f32_16x16x32_bf16 v[184:187], v[124:127], v[104:107], v[184:187]
  ds_read_b64_tr_b16 v[146:147], v31 offset:47424
  s_waitcnt lgkmcnt(8)
  v_mfma_f32_16x16x32_bf16 v[168:171], v[128:131], v[100:103], v[168:171]
  ds_read_b64_tr_b16 v[148:149], v31 offset:46176
  v_mfma_f32_16x16x32_bf16 v[188:191], v[128:131], v[104:107], v[188:191]
  ds_read_b64_tr_b16 v[150:151], v31 offset:47456
  s_waitcnt lgkmcnt(8)
  v_mfma_f32_16x16x32_bf16 v[172:175], v[132:135], v[100:103], v[172:175]
  ds_read_b64_tr_b16 v[152:153], v31 offset:46208
  v_mfma_f32_16x16x32_bf16 v[192:195], v[132:135], v[104:107], v[192:195]
  ds_read_b64_tr_b16 v[154:155], v31 offset:47488
  s_waitcnt vmcnt(1) lgkmcnt(8)
  v_mfma_f32_16x16x32_bf16 v[156:159], v[136:139], v[108:111], v[156:159]
  s_waitcnt vmcnt(0)
  v_mfma_f32_16x16x32_bf16 v[176:179], v[136:139], v[112:115], v[176:179]
  s_waitcnt lgkmcnt(6)
  v_mfma_f32_16x16x32_bf16 v[160:163], v[140:143], v[108:111], v[160:163]
  v_mfma_f32_16x16x32_bf16 v[180:183], v[140:143], v[112:115], v[180:183]
  s_waitcnt lgkmcnt(4)
  v_mfma_f32_16x16x32_bf16 v[164:167], v[144:147], v[108:111], v[164:167]
  v_mfma_f32_16x16x32_bf16 v[184:187], v[144:147], v[112:115], v[184:187]
  s_waitcnt lgkmcnt(2)
  v_mfma_f32_16x16x32_bf16 v[168:171], v[148:151], v[108:111], v[168:171]
  v_mfma_f32_16x16x32_bf16 v[188:191], v[148:151], v[112:115], v[188:191]
  s_waitcnt lgkmcnt(0)
  v_mfma_f32_16x16x32_bf16 v[172:175], v[152:155], v[108:111], v[172:175]
  v_mfma_f32_16x16x32_bf16 v[192:195], v[152:155], v[112:115], v[192:195]
  v_lshlrev_b32 v2, 4, v30
  ds_read_b128 v[60:63], v2 offset:0
  ds_read_b128 v[64:67], v2 offset:64
  ds_read_b128 v[68:71], v2 offset:128
  ds_read_b128 v[72:75], v2 offset:192
  ds_read_b128 v[76:79], v2 offset:256
  s_mul_i32 s60, s57, 5120
  s_add_u32 s60, s60, 35840
  v_add_u32 v3, s60, v0
  ds_write_b128 v3, v[176:179] offset:0
  ds_write_b128 v3, v[180:183] offset:1024
  ds_write_b128 v3, v[184:187] offset:2048
  ds_write_b128 v3, v[188:191] offset:3072
  ds_write_b128 v3, v[192:195] offset:4096
  s_xor_b32 s60, s57, 1
  s_mul_i32 s60, s60, 5120
  s_add_u32 s60, s60, 35840
  v_add_u32 v3, s60, v0
  s_waitcnt lgkmcnt(0)
  s_barrier
  ds_read_b128 v[176:179], v3 offset:0
  ds_read_b128 v[180:183], v3 offset:1024
  ds_read_b128 v[184:187], v3 offset:2048
  ds_read_b128 v[188:191], v3 offset:3072
  ds_read_b128 v[192:195], v3 offset:4096
  s_waitcnt lgkmcnt(4)
  v_add_f32 v156, v156, v176
  v_add_f32 v157, v157, v177
  v_add_f32 v158, v158, v178
  v_add_f32 v159, v159, v179
  s_waitcnt lgkmcnt(3)
  v_add_f32 v160, v160, v180
  v_add_f32 v161, v161, v181
  v_add_f32 v162, v162, v182
  v_add_f32 v163, v163, v183
  s_waitcnt lgkmcnt(2)
  v_add_f32 v164, v164, v184
  v_add_f32 v165, v165, v185
  v_add_f32 v166, v166, v186
  v_add_f32 v167, v167, v187
  s_waitcnt lgkmcnt(1)
  v_add_f32 v168, v168, v188
  v_add_f32 v169, v169, v189
  v_add_f32 v170, v170, v190
  v_add_f32 v171, v171, v191
  s_waitcnt lgkmcnt(0)
  v_add_f32 v172, v172, v192
  v_add_f32 v173, v173, v193
  v_add_f32 v174, v174, v194
  v_add_f32 v175, v175, v195
  v_pk_fma_f32 v[40:41], v[156:157], v[60:61], v[40:41]
  v_pk_fma_f32 v[42:43], v[158:159], v[62:63], v[42:43]
  v_pk_fma_f32 v[44:45], v[160:161], v[64:65], v[44:45]
  v_pk_fma_f32 v[46:47], v[162:163], v[66:67], v[46:47]
  v_pk_fma_f32 v[48:49], v[164:165], v[68:69], v[48:49]
  v_pk_fma_f32 v[50:51], v[166:167], v[70:71], v[50:51]
  v_pk_fma_f32 v[52:53], v[168:169], v[72:73], v[52:53]
  v_pk_fma_f32 v[54:55], v[170:171], v[74:75], v[54:55]
  v_pk_fma_f32 v[56:57], v[172:173], v[76:77], v[56:57]
  v_pk_fma_f32 v[58:59], v[174:175], v[78:79], v[58:59]
  v_pk_add_f32 v[4:5], v[40:41], v[42:43]
  v_pk_add_f32 v[4:5], v[4:5], v[44:45]
  v_pk_add_f32 v[4:5], v[4:5], v[46:47]
  v_pk_add_f32 v[4:5], v[4:5], v[48:49]
  v_pk_add_f32 v[4:5], v[4:5], v[50:51]
  v_pk_add_f32 v[4:5], v[4:5], v[52:53]
  v_pk_add_f32 v[4:5], v[4:5], v[54:55]
  v_pk_add_f32 v[4:5], v[4:5], v[56:57]
  v_pk_add_f32 v[4:5], v[4:5], v[58:59]
  v_add_f32 v8, v4, v5
  v_mov_b32 v3, v8
  s_nop 1
  v_permlane16_swap_b32 v3, v8
  v_add_f32 v8, v8, v3
  v_mov_b32 v3, v8
  s_nop 1
  v_permlane32_swap_b32 v3, v8
  v_add_f32 v8, v8, v3
  v_mul_f32 v8, 0x3c4ccccd, v8
  v_pk_add_f32 v[156:157], v[40:41], v[8:9] op_sel_hi:[1,0] neg_lo:[0,1] neg_hi:[0,1]
  v_pk_add_f32 v[158:159], v[42:43], v[8:9] op_sel_hi:[1,0] neg_lo:[0,1] neg_hi:[0,1]
  v_pk_add_f32 v[160:161], v[44:45], v[8:9] op_sel_hi:[1,0] neg_lo:[0,1] neg_hi:[0,1]
  v_pk_add_f32 v[162:163], v[46:47], v[8:9] op_sel_hi:[1,0] neg_lo:[0,1] neg_hi:[0,1]
  v_pk_add_f32 v[164:165], v[48:49], v[8:9] op_sel_hi:[1,0] neg_lo:[0,1] neg_hi:[0,1]
  v_pk_add_f32 v[166:167], v[50:51], v[8:9] op_sel_hi:[1,0] neg_lo:[0,1] neg_hi:[0,1]
  v_pk_add_f32 v[168:169], v[52:53], v[8:9] op_sel_hi:[1,0] neg_lo:[0,1] neg_hi:[0,1]
  v_pk_add_f32 v[170:171], v[54:55], v[8:9] op_sel_hi:[1,0] neg_lo:[0,1] neg_hi:[0,1]
  v_pk_add_f32 v[172:173], v[56:57], v[8:9] op_sel_hi:[1,0] neg_lo:[0,1] neg_hi:[0,1]
  v_pk_add_f32 v[174:175], v[58:59], v[8:9] op_sel_hi:[1,0] neg_lo:[0,1] neg_hi:[0,1]
  v_pk_mul_f32 v[4:5], v[156:157], v[156:157]
  v_pk_fma_f32 v[4:5], v[158:159], v[158:159], v[4:5]
  v_pk_fma_f32 v[4:5], v[160:161], v[160:161], v[4:5]
  v_pk_fma_f32 v[4:5], v[162:163], v[162:163], v[4:5]
  v_pk_fma_f32 v[4:5], v[164:165], v[164:165], v[4:5]
  v_pk_fma_f32 v[4:5], v[166:167], v[166:167], v[4:5]
  v_pk_fma_f32 v[4:5], v[168:169], v[168:169], v[4:5]
  v_pk_fma_f32 v[4:5], v[170:171], v[170:171], v[4:5]
  v_pk_fma_f32 v[4:5], v[172:173], v[172:173], v[4:5]
  v_pk_fma_f32 v[4:5], v[174:175], v[174:175], v[4:5]
  v_add_f32 v9, v4, v5
  v_mov_b32 v3, v9
  s_nop 1
  v_permlane16_swap_b32 v3, v9
  v_add_f32 v9, v9, v3
  v_mov_b32 v3, v9
  s_nop 1
  v_permlane32_swap_b32 v3, v9
  v_add_f32 v9, v9, v3
  v_mov_b32 v10, s52
  v_mov_b32 v11, s53
  v_lshlrev_b32 v37, 7, v19
  s_lshl_b32 s60, s54, 15
  s_add_u32 s60, s60, 131072
  s_lshl_b32 s61, s78, 4
  s_add_u32 s61, s61, s60
  s_mov_b64 exec, 0xffff
  s_cmp_lg_u32 s59, 0
  s_cbranch_scc1 L_stslow_24
  buffer_store_dwordx4 v[8:11], v37, s[12:15], s61 offen
L_stdone_25:
  s_mov_b64 exec, -1
  ds_read_b128 v[80:83], v2 offset:960
  ds_read_b128 v[84:87], v2 offset:1024
  ds_read_b128 v[88:91], v2 offset:1088
  ds_read_b128 v[92:95], v2 offset:1152
  ds_read_b128 v[96:99], v2 offset:1216
  ds_read_b128 v[60:63], v2 offset:640
  ds_read_b128 v[156:159], v2 offset:320
  ds_read_b128 v[64:67], v2 offset:704
  ds_read_b128 v[160:163], v2 offset:384
  ds_read_b128 v[68:71], v2 offset:768
  ds_read_b128 v[164:167], v2 offset:448
  ds_read_b128 v[72:75], v2 offset:832
  ds_read_b128 v[168:171], v2 offset:512
  ds_read_b128 v[76:79], v2 offset:896
  ds_read_b128 v[172:175], v2 offset:576
  v_lshl_add_u32 v16, v30, 5, v37
  v_lshrrev_b32 v17, 5, v19
  v_mul_u32_u24 v17, 0xa000, v17
  v_and_b32 v3, 31, v19
  v_lshl_add_u32 v17, v3, 4, v17
  v_lshrrev_b32 v3, 1, v30
  v_lshl_add_u32 v17, v3, 9, v17
  v_and_b32 v3, 1, v30
  v_lshl_add_u32 v17, v3, 3, v17
  s_mul_i32 s65, s54, 327680
  s_cmp_eq_u32 s59, 0
  s_cselect_b32 s63, 8912896, 0
  s_add_u32 s65, s65, s63
  s_add_u32 s65, s65, 6291456
  s_mul_i32 s63, s78, 5120
  s_add_u32 s63, s63, s65
  s_add_u32 s62, s63, 4096
  s_mov_b32 s74, 0
L_poll_26:
  buffer_load_dwordx4 v[4:7], v16, s[12:15], s60 offen sc1
  buffer_load_dwordx4 v[12:15], v16, s[12:15], s60 offen offset:16 sc1
  s_add_u32 s74, s74, 1
  s_cmp_gt_u32 s74, 131072
  s_cbranch_scc1 L_pdone_27
  s_waitcnt vmcnt(0)
  v_cmp_ne_u64 vcc, s[52:53], v[6:7]
  v_cmp_ne_u64 s[68:69], s[52:53], v[14:15]
  s_nop 0
  s_or_b64 vcc, vcc, s[68:69]
  s_nop 1
  s_cbranch_vccnz L_poll_26
L_pdone_27:
  s_waitcnt vmcnt(0)
  v_mov_b32 v18, 0
  v_mov_b32 v20, 1
  s_mov_b64 exec, 1
  ds_add_u32 v18, v20 offset:1292
  s_mov_b64 exec, -1
  v_add_f32 v8, v4, v12
  v_mov_b32 v3, v8
  s_nop 1
  v_permlane16_swap_b32 v3, v8
  v_add_f32 v8, v8, v3
  v_mov_b32 v3, v8
  s_nop 1
  v_permlane32_swap_b32 v3, v8
  v_add_f32 v8, v8, v3
  v_mul_f32 v8, 0x3e000000, v8
  v_sub_f32 v4, v4, v8
  v_sub_f32 v12, v12, v8
  v_mul_f32 v4, v4, v4
  v_fmac_f32 v4, v12, v12
  v_add_f32 v9, v5, v13
  v_fmac_f32 v9, 0x42a00000, v4
  v_mov_b32 v3, v9
  s_nop 1
  v_permlane16_swap_b32 v3, v9
  v_add_f32 v9, v9, v3
  v_mov_b32 v3, v9
  s_nop 1
  v_permlane32_swap_b32 v3, v9
  v_add_f32 v9, v9, v3
  v_mul_f32 v9, 0x3acccccd, v9
  v_add_f32 v9, 0x3727c5ac, v9
  v_rsq_f32 v9, v9
  s_nop 0
  v_pk_add_f32 v[100:101], v[40:41], v[8:9] op_sel_hi:[1,0] neg_lo:[0,1] neg_hi:[0,1]
  v_pk_add_f32 v[102:103], v[42:43], v[8:9] op_sel_hi:[1,0] neg_lo:[0,1] neg_hi:[0,1]
  v_pk_add_f32 v[104:105], v[44:45], v[8:9] op_sel_hi:[1,0] neg_lo:[0,1] neg_hi:[0,1]
  v_pk_add_f32 v[106:107], v[46:47], v[8:9] op_sel_hi:[1,0] neg_lo:[0,1] neg_hi:[0,1]
  v_pk_add_f32 v[108:109], v[48:49], v[8:9] op_sel_hi:[1,0] neg_lo:[0,1] neg_hi:[0,1]
  v_pk_add_f32 v[110:111], v[50:51], v[8:9] op_sel_hi:[1,0] neg_lo:[0,1] neg_hi:[0,1]
  v_pk_add_f32 v[112:113], v[52:53], v[8:9] op_sel_hi:[1,0] neg_lo:[0,1] neg_hi:[0,1]
  v_pk_add_f32 v[114:115], v[54:55], v[8:9] op_sel_hi:[1,0] neg_lo:[0,1] neg_hi:[0,1]
  v_pk_add_f32 v[116:117], v[56:57], v[8:9] op_sel_hi:[1,0] neg_lo:[0,1] neg_hi:[0,1]
  v_pk_add_f32 v[118:119], v[58:59], v[8:9] op_sel_hi:[1,0] neg_lo:[0,1] neg_hi:[0,1]
  v_pk_mul_f32 v[100:101], v[100:101], v[8:9] op_sel:[0,1] op_sel_hi:[1,1]
  s_waitcnt lgkmcnt(9)
  v_pk_fma_f32 v[100:101], v[100:101], v[60:61], v[156:157]
  v_cvt_pk_bf16_f32 v20, v100, v101
  v_pk_mul_f32 v[102:103], v[102:103], v[8:9] op_sel:[0,1] op_sel_hi:[1,1]
  v_pk_fma_f32 v[102:103], v[102:103], v[62:63], v[158:159]
  v_cvt_pk_bf16_f32 v21, v102, v103
  buffer_store_dwordx2 v[20:21], v17, s[12:15], s63 offen offset:0
  v_pk_mul_f32 v[104:105], v[104:105], v[8:9] op_sel:[0,1] op_sel_hi:[1,1]
  s_waitcnt lgkmcnt(7)
  v_pk_fma_f32 v[104:105], v[104:105], v[64:65], v[160:161]
  v_cvt_pk_bf16_f32 v22, v104, v105
  v_pk_mul_f32 v[106:107], v[106:107], v[8:9] op_sel:[0,1] op_sel_hi:[1,1]
  v_pk_fma_f32 v[106:107], v[106:107], v[66:67], v[162:163]
  v_cvt_pk_bf16_f32 v23, v106, v107
  buffer_store_dwordx2 v[22:23], v17, s[12:15], s63 offen offset:1024
  v_pk_mul_f32 v[108:109], v[108:109], v[8:9] op_sel:[0,1] op_sel_hi:[1,1]
  s_waitcnt lgkmcnt(5)
  v_pk_fma_f32 v[108:109], v[108:109], v[68:69], v[164:165]
  v_cvt_pk_bf16_f32 v24, v108, v109
  v_pk_mul_f32 v[110:111], v[110:111], v[8:9] op_sel:[0,1] op_sel_hi:[1,1]
  v_pk_fma_f32 v[110:111], v[110:111], v[70:71], v[166:167]
  v_cvt_pk_bf16_f32 v25, v110, v111
  buffer_store_dwordx2 v[24:25], v17, s[12:15], s63 offen offset:2048
  v_pk_mul_f32 v[112:113], v[112:113], v[8:9] op_sel:[0,1] op_sel_hi:[1,1]
  s_waitcnt lgkmcnt(3)
  v_pk_fma_f32 v[112:113], v[112:113], v[72:73], v[168:169]
  v_cvt_pk_bf16_f32 v26, v112, v113
  v_pk_mul_f32 v[114:115], v[114:115], v[8:9] op_sel:[0,1] op_sel_hi:[1,1]
  v_pk_fma_f32 v[114:115], v[114:115], v[74:75], v[170:171]
  v_cvt_pk_bf16_f32 v27, v114, v115
  buffer_store_dwordx2 v[26:27], v17, s[12:15], s63 offen offset:3072
  v_pk_mul_f32 v[116:117], v[116:117], v[8:9] op_sel:[0,1] op_sel_hi:[1,1]
  s_waitcnt lgkmcnt(1)
  v_pk_fma_f32 v[116:117], v[116:117], v[76:77], v[172:173]
  v_cvt_pk_bf16_f32 v28, v116, v117
  v_pk_mul_f32 v[118:119], v[118:119], v[8:9] op_sel:[0,1] op_sel_hi:[1,1]
  v_pk_fma_f32 v[118:119], v[118:119], v[78:79], v[174:175]
  v_cvt_pk_bf16_f32 v29, v118, v119
  buffer_store_dwordx2 v[28:29], v17, s[12:15], s62 offen offset:0
  s_lshl_b32 s60, s54, 12
  s_lshl_b32 s61, s55, 4
  s_add_u32 s60, s60, s61
  s_lshl_b32 s61, s57, 2
  s_add_u32 s60, s60, s61
  s_add_u32 s60, s60, 66560
  v_mov_b32 v18, 0
  v_mov_b32 v31, s52
  s_mov_b64 exec, 1
  s_cmp_lg_u32 s59, 0
  s_waitcnt vmcnt(0)
  s_cbranch_scc1 L_sigslow_28
  buffer_store_dword v31, v18, s[12:15], s60 offen
L_sigdone_29:
  s_mov_b64 exec, -1
  v_lshrrev_b32 v37, 5, v1
  v_bfe_u32 v30, v1, 2, 2
  v_lshl_add_u32 v37, v37, 3, v30
  v_mul_u32_u24 v37, 0xc0, v37
  v_bfe_u32 v30, v1, 4, 1
  v_mul_u32_u24 v30, 79904, v30
  v_add_u32 v37, v37, v30
  v_and_b32 v30, 3, v1
  v_lshl_add_u32 v2, v30, 3, v37
  v_add_u32 v2, 2048, v2
  v_add_u32 v3, 61440, v2
  v_bfe_u32 v37, v1, 4, 1
  v_mul_u32_u24 v37, 0xc000, v37
  v_and_b32 v30, 15, v1
  v_lshl_add_u32 v37, v30, 4, v37
  v_lshrrev_b32 v30, 5, v1
  v_lshl_add_u32 v4, v30, 8, v37
  s_lshr_b32 s63, s55, 4
  s_lshl_b32 s64, s63, 2
  s_add_u32 s64, s64, s57
  s_mul_i32 s66, s64, 40960
  s_add_u32 s66, s66, s65
  s_mul_i32 s60, s63, 20480
  s_add_u32 s66, s66, s60
  s_mul_i32 s65, s63, 40960
  s_sub_u32 s65, 4096, s65
  s_mul_i32 s67, s54, 786432
  s_mul_i32 s60, s64, 98304
  s_add_u32 s67, s67, s60
  s_and_b32 s60, s55, 15
  s_mul_i32 s60, s60, 3072
  s_add_u32 s67, s67, s60
  s_cmp_eq_u32 s59, 0
  s_cselect_b32 s60, 8912896, 0
  s_add_u32 s67, s67, s60
  s_add_u32 s67, s67, 8912896
  s_lshr_b32 s61, s64, 1
  s_lshl_b32 s61, s61, 7
  s_add_u32 s62, s61, 64
  s_lshl_b32 s60, s54, 12
  s_add_u32 s60, s60, 66560
  v_and_b32 v5, 15, v1
  v_lshl_add_u32 v5, v5, 2, s61
  s_sub_u32 s62, s62, s61
  v_add_u32 v6, s62, v5
  v_cndmask_b32_e64 v5, v5, v6, s[72:73]
  s_mov_b32 s74, 0
L_poll_30:
  buffer_load_dword v6, v5, s[12:15], s60 offen sc1
  s_add_u32 s74, s74, 1
  s_cmp_gt_u32 s74, 131072
  s_cbranch_scc1 L_pdone_31
  s_waitcnt vmcnt(0)
  v_cmp_ne_u32 vcc, s52, v6
  s_nop 3
  s_cbranch_vccnz L_poll_30
L_pdone_31:
  s_waitcnt vmcnt(0)
  s_cmp_eq_u32 s59, 0
  s_cbranch_scc1 L_noacq_32
  buffer_inv sc1
  s_waitcnt vmcnt(0)
L_noacq_32:
  buffer_load_dwordx4 v[8:11], v0, s[12:15], s66 offen offset:0 sc1
  buffer_load_dwordx4 v[12:15], v0, s[12:15], s66 offen offset:1024 sc1
  buffer_load_dwordx4 v[16:19], v0, s[12:15], s66 offen offset:2048 sc1
  buffer_load_dwordx4 v[20:23], v0, s[12:15], s66 offen offset:3072 sc1
  s_add_u32 s66, s66, 4096
  s_barrier
  ds_read_b64_tr_b16 v[100:101], v2 offset:0
  ds_read_b64_tr_b16 v[102:103], v2 offset:768
  ds_read_b64_tr_b16 v[104:105], v2 offset:32
  ds_read_b64_tr_b16 v[106:107], v2 offset:800
  ds_read_b64_tr_b16 v[108:109], v2 offset:64
  ds_read_b64_tr_b16 v[110:111], v2 offset:832
  ds_read_b64_tr_b16 v[112:113], v2 offset:96
  ds_read_b64_tr_b16 v[114:115], v2 offset:864
  ds_read_b64_tr_b16 v[116:117], v2 offset:128
  ds_read_b64_tr_b16 v[118:119], v2 offset:896
  ds_read_b64_tr_b16 v[120:121], v2 offset:160
  ds_read_b64_tr_b16 v[122:123], v2 offset:928
  s_waitcnt vmcnt(3) lgkmcnt(10)
  v_mfma_f32_32x32x16_bf16 v[148:163], v[100:103], v[8:11], 0
  ds_read_b64_tr_b16 v[124:125], v2 offset:3072
  ds_read_b64_tr_b16 v[126:127], v2 offset:3840
  buffer_load_dwordx4 v[24:27], v0, s[12:15], s66 offen offset:0 sc1
  s_waitcnt lgkmcnt(10)
  v_mfma_f32_32x32x16_bf16 v[164:179], v[104:107], v[8:11], 0
  ds_read_b64_tr_b16 v[128:129], v2 offset:3104
  ds_read_b64_tr_b16 v[130:131], v2 offset:3872
  s_waitcnt lgkmcnt(10)
  v_mfma_f32_32x32x16_bf16 v[180:195], v[108:111], v[8:11], 0
  ds_read_b64_tr_b16 v[132:133], v2 offset:3136
  ds_read_b64_tr_b16 v[134:135], v2 offset:3904
  buffer_load_dwordx4 v[28:31], v0, s[12:15], s66 offen offset:1024 sc1
  s_waitcnt lgkmcnt(10)
  v_mfma_f32_32x32x16_bf16 v[196:211], v[112:115], v[8:11], 0
  ds_read_b64_tr_b16 v[136:137], v2 offset:3168
  ds_read_b64_tr_b16 v[138:139], v2 offset:3936
  s_waitcnt lgkmcnt(10)
  v_mfma_f32_32x32x16_bf16 v[212:227], v[116:119], v[8:11], 0
  ds_read_b64_tr_b16 v[140:141], v2 offset:3200
  ds_read_b64_tr_b16 v[142:143], v2 offset:3968
  s_waitcnt lgkmcnt(10)
  v_mfma_f32_32x32x16_bf16 v[228:243], v[120:123], v[8:11], 0
  ds_read_b64_tr_b16 v[144:145], v2 offset:3232
  ds_read_b64_tr_b16 v[146:147], v2 offset:4000
  s_waitcnt vmcnt(4) lgkmcnt(10)
  v_mfma_f32_32x32x16_bf16 v[148:163], v[124:127], v[12:15], v[148:163]
  ds_read_b64_tr_b16 v[100:101], v2 offset:6144
  ds_read_b64_tr_b16 v[102:103], v2 offset:6912
  buffer_load_dwordx4 v[32:35], v0, s[12:15], s66 offen offset:2048 sc1
  s_waitcnt lgkmcnt(10)
  v_mfma_f32_32x32x16_bf16 v[164:179], v[128:131], v[12:15], v[164:179]
  ds_read_b64_tr_b16 v[104:105], v2 offset:6176
  ds_read_b64_tr_b16 v[106:107], v2 offset:6944
  s_waitcnt lgkmcnt(10)
  v_mfma_f32_32x32x16_bf16 v[180:195], v[132:135], v[12:15], v[180:195]
  ds_read_b64_tr_b16 v[108:109], v2 offset:6208
  ds_read_b64_tr_b16 v[110:111], v2 offset:6976
  buffer_load_dwordx4 v[36:39], v0, s[12:15], s66 offen offset:3072 sc1
  s_add_u32 s66, s66, 4096
  s_waitcnt lgkmcnt(10)
  v_mfma_f32_32x32x16_bf16 v[196:211], v[136:139], v[12:15], v[196:211]
  ds_read_b64_tr_b16 v[112:113], v2 offset:6240
  ds_read_b64_tr_b16 v[114:115], v2 offset:7008
  s_waitcnt lgkmcnt(10)
  v_mfma_f32_32x32x16_bf16 v[212:227], v[140:143], v[12:15], v[212:227]
  ds_read_b64_tr_b16 v[116:117], v2 offset:6272
  ds_read_b64_tr_b16 v[118:119], v2 offset:7040
  s_waitcnt lgkmcnt(10)
  v_mfma_f32_32x32x16_bf16 v[228:243], v[144:147], v[12:15], v[228:243]
  ds_read_b64_tr_b16 v[120:121], v2 offset:6304
  ds_read_b64_tr_b16 v[122:123], v2 offset:7072
  s_waitcnt vmcnt(5) lgkmcnt(10)
  v_mfma_f32_32x32x16_bf16 v[148:163], v[100:103], v[16:19], v[148:163]
  ds_read_b64_tr_b16 v[124:125], v2 offset:9216
  ds_read_b64_tr_b16 v[126:127], v2 offset:9984
  buffer_load_dwordx4 v[60:63], v0, s[12:15], s66 offen offset:0 sc1
  s_waitcnt lgkmcnt(10)
  v_mfma_f32_32x32x16_bf16 v[164:179], v[104:107], v[16:19], v[164:179]
  ds_read_b64_tr_b16 v[128:129], v2 offset:9248
  ds_read_b64_tr_b16 v[130:131], v2 offset:10016
  s_waitcnt lgkmcnt(10)
  v_mfma_f32_32x32x16_bf16 v[180:195], v[108:111], v[16:19], v[180:195]
  ds_read_b64_tr_b16 v[132:133], v2 offset:9280
  ds_read_b64_tr_b16 v[134:135], v2 offset:10048
  buffer_load_dwordx4 v[64:67], v0, s[12:15], s66 offen offset:1024 sc1
  s_waitcnt lgkmcnt(10)
  v_mfma_f32_32x32x16_bf16 v[196:211], v[112:115], v[16:19], v[196:211]
  ds_read_b64_tr_b16 v[136:137], v2 offset:9312
  ds_read_b64_tr_b16 v[138:139], v2 offset:10080
  s_waitcnt lgkmcnt(10)
  v_mfma_f32_32x32x16_bf16 v[212:227], v[116:119], v[16:19], v[212:227]
  ds_read_b64_tr_b16 v[140:141], v2 offset:9344
  ds_read_b64_tr_b16 v[142:143], v2 offset:10112
  s_waitcnt lgkmcnt(10)
  v_mfma_f32_32x32x16_bf16 v[228:243], v[120:123], v[16:19], v[228:243]
  ds_read_b64_tr_b16 v[144:145], v2 offset:9376
  ds_read_b64_tr_b16 v[146:147], v2 offset:10144
  s_waitcnt vmcnt(6) lgkmcnt(10)
  v_mfma_f32_32x32x16_bf16 v[148:163], v[124:127], v[20:23], v[148:163]
  ds_read_b64_tr_b16 v[100:101], v2 offset:12288
  ds_read_b64_tr_b16 v[102:103], v2 offset:13056
  buffer_load_dwordx4 v[68:71], v0, s[12:15], s66 offen offset:2048 sc1
  s_waitcnt lgkmcnt(10)
  v_mfma_f32_32x32x16_bf16 v[164:179], v[128:131], v[20:23], v[164:179]
  ds_read_b64_tr_b16 v[104:105], v2 offset:12320
  ds_read_b64_tr_b16 v[106:107], v2 offset:13088
  s_waitcnt lgkmcnt(10)
  v_mfma_f32_32x32x16_bf16 v[180:195], v[132:135], v[20:23], v[180:195]
  ds_read_b64_tr_b16 v[108:109], v2 offset:12352
  ds_read_b64_tr_b16 v[110:111], v2 offset:13120
  buffer_load_dwordx4 v[72:75], v0, s[12:15], s66 offen offset:3072 sc1
  s_add_u32 s66, s66, 4096
  s_waitcnt lgkmcnt(10)
  v_mfma_f32_32x32x16_bf16 v[196:211], v[136:139], v[20:23], v[196:211]
  ds_read_b64_tr_b16 v[112:113], v2 offset:12384
  ds_read_b64_tr_b16 v[114:115], v2 offset:13152
  s_waitcnt lgkmcnt(10)
  v_mfma_f32_32x32x16_bf16 v[212:227], v[140:143], v[20:23], v[212:227]
  ds_read_b64_tr_b16 v[116:117], v2 offset:12416
  ds_read_b64_tr_b16 v[118:119], v2 offset:13184
  s_waitcnt lgkmcnt(10)
  v_mfma_f32_32x32x16_bf16 v[228:243], v[144:147], v[20:23], v[228:243]
  ds_read_b64_tr_b16 v[120:121], v2 offset:12448
  ds_read_b64_tr_b16 v[122:123], v2 offset:13216
  s_waitcnt vmcnt(7) lgkmcnt(10)
  v_mfma_f32_32x32x16_bf16 v[148:163], v[100:103], v[24:27], v[148:163]
  ds_read_b64_tr_b16 v[124:125], v2 offset:15360
  ds_read_b64_tr_b16 v[126:127], v2 offset:16128
  buffer_load_dwordx4 v[8:11], v0, s[12:15], s66 offen offset:0 sc1
  s_waitcnt lgkmcnt(10)
  v_mfma_f32_32x32x16_bf16 v[164:179], v[104:107], v[24:27], v[164:179]
  ds_read_b64_tr_b16 v[128:129], v2 offset:15392
  ds_read_b64_tr_b16 v[130:131], v2 offset:16160
  s_waitcnt lgkmcnt(10)
  v_mfma_f32_32x32x16_bf16 v[180:195], v[108:111], v[24:27], v[180:195]
  ds_read_b64_tr_b16 v[132:133], v2 offset:15424
  ds_read_b64_tr_b16 v[134:135], v2 offset:16192
  buffer_load_dwordx4 v[12:15], v0, s[12:15], s66 offen offset:1024 sc1
  s_waitcnt lgkmcnt(10)
  v_mfma_f32_32x32x16_bf16 v[196:211], v[112:115], v[24:27], v[196:211]
  ds_read_b64_tr_b16 v[136:137], v2 offset:15456
  ds_read_b64_tr_b16 v[138:139], v2 offset:16224
  s_waitcnt lgkmcnt(10)
  v_mfma_f32_32x32x16_bf16 v[212:227], v[116:119], v[24:27], v[212:227]
  ds_read_b64_tr_b16 v[140:141], v2 offset:15488
  ds_read_b64_tr_b16 v[142:143], v2 offset:16256
  s_waitcnt lgkmcnt(10)
  v_mfma_f32_32x32x16_bf16 v[228:243], v[120:123], v[24:27], v[228:243]
  ds_read_b64_tr_b16 v[144:145], v2 offset:15520
  ds_read_b64_tr_b16 v[146:147], v2 offset:16288
  s_waitcnt vmcnt(8) lgkmcnt(10)
  v_mfma_f32_32x32x16_bf16 v[148:163], v[124:127], v[28:31], v[148:163]
  ds_read_b64_tr_b16 v[100:101], v2 offset:18432
  ds_read_b64_tr_b16 v[102:103], v2 offset:19200
  buffer_load_dwordx4 v[16:19], v0, s[12:15], s66 offen offset:2048 sc1
  s_waitcnt lgkmcnt(10)
  v_mfma_f32_32x32x16_bf16 v[164:179], v[128:131], v[28:31], v[164:179]
  ds_read_b64_tr_b16 v[104:105], v2 offset:18464
  ds_read_b64_tr_b16 v[106:107], v2 offset:19232
  s_waitcnt lgkmcnt(10)
  v_mfma_f32_32x32x16_bf16 v[180:195], v[132:135], v[28:31], v[180:195]
  ds_read_b64_tr_b16 v[108:109], v2 offset:18496
  ds_read_b64_tr_b16 v[110:111], v2 offset:19264
  buffer_load_dwordx4 v[20:23], v0, s[12:15], s66 offen offset:3072 sc1
  s_add_u32 s66, s66, 4096
  s_waitcnt lgkmcnt(10)
  v_mfma_f32_32x32x16_bf16 v[196:211], v[136:139], v[28:31], v[196:211]
  ds_read_b64_tr_b16 v[112:113], v2 offset:18528
  ds_read_b64_tr_b16 v[114:115], v2 offset:19296
  s_waitcnt lgkmcnt(10)
  v_mfma_f32_32x32x16_bf16 v[212:227], v[140:143], v[28:31], v[212:227]
  ds_read_b64_tr_b16 v[116:117], v2 offset:18560
  ds_read_b64_tr_b16 v[118:119], v2 offset:19328
  s_waitcnt lgkmcnt(10)
  v_mfma_f32_32x32x16_bf16 v[228:243], v[144:147], v[28:31], v[228:243]
  ds_read_b64_tr_b16 v[120:121], v2 offset:18592
  ds_read_b64_tr_b16 v[122:123], v2 offset:19360
  s_waitcnt vmcnt(9) lgkmcnt(10)
  v_mfma_f32_32x32x16_bf16 v[148:163], v[100:103], v[32:35], v[148:163]
  ds_read_b64_tr_b16 v[124:125], v2 offset:21504
  ds_read_b64_tr_b16 v[126:127], v2 offset:22272
  buffer_load_dwordx4 v[24:27], v0, s[12:15], s66 offen offset:0 sc1
  s_waitcnt lgkmcnt(10)
  v_mfma_f32_32x32x16_bf16 v[164:179], v[104:107], v[32:35], v[164:179]
  ds_read_b64_tr_b16 v[128:129], v2 offset:21536
  ds_read_b64_tr_b16 v[130:131], v2 offset:22304
  s_waitcnt lgkmcnt(10)
  v_mfma_f32_32x32x16_bf16 v[180:195], v[108:111], v[32:35], v[180:195]
  ds_read_b64_tr_b16 v[132:133], v2 offset:21568
  ds_read_b64_tr_b16 v[134:135], v2 offset:22336
  buffer_load_dwordx4 v[28:31], v0, s[12:15], s66 offen offset:1024 sc1
  s_waitcnt lgkmcnt(10)
  v_mfma_f32_32x32x16_bf16 v[196:211], v[112:115], v[32:35], v[196:211]
  ds_read_b64_tr_b16 v[136:137], v2 offset:21600
  ds_read_b64_tr_b16 v[138:139], v2 offset:22368
  s_waitcnt lgkmcnt(10)
  v_mfma_f32_32x32x16_bf16 v[212:227], v[116:119], v[32:35], v[212:227]
  ds_read_b64_tr_b16 v[140:141], v2 offset:21632
  ds_read_b64_tr_b16 v[142:143], v2 offset:22400
  s_waitcnt lgkmcnt(10)
  v_mfma_f32_32x32x16_bf16 v[228:243], v[120:123], v[32:35], v[228:243]
  ds_read_b64_tr_b16 v[144:145], v2 offset:21664
  ds_read_b64_tr_b16 v[146:147], v2 offset:22432
  s_waitcnt lgkmcnt(0)
  s_barrier
  s_waitcnt vmcnt(10)
  v_mfma_f32_32x32x16_bf16 v[148:163], v[124:127], v[36:39], v[148:163]
  ds_read_b64_tr_b16 v[100:101], v2 offset:24576
  ds_read_b64_tr_b16 v[102:103], v2 offset:25344
  buffer_load_dwordx4 v[32:35], v0, s[12:15], s66 offen offset:2048 sc1
  v_mfma_f32_32x32x16_bf16 v[164:179], v[128:131], v[36:39], v[164:179]
  ds_read_b64_tr_b16 v[104:105], v2 offset:24608
  ds_read_b64_tr_b16 v[106:107], v2 offset:25376
  v_mfma_f32_32x32x16_bf16 v[180:195], v[132:135], v[36:39], v[180:195]
  ds_read_b64_tr_b16 v[108:109], v2 offset:24640
  ds_read_b64_tr_b16 v[110:111], v2 offset:25408
  v_mfma_f32_32x32x16_bf16 v[196:211], v[136:139], v[36:39], v[196:211]
  ds_read_b64_tr_b16 v[112:113], v2 offset:24672
  ds_read_b64_tr_b16 v[114:115], v2 offset:25440
  v_mfma_f32_32x32x16_bf16 v[212:227], v[140:143], v[36:39], v[212:227]
  ds_read_b64_tr_b16 v[116:117], v2 offset:24704
  ds_read_b64_tr_b16 v[118:119], v2 offset:25472
  v_mfma_f32_32x32x16_bf16 v[228:243], v[144:147], v[36:39], v[228:243]
  ds_read_b64_tr_b16 v[120:121], v2 offset:24736
  ds_read_b64_tr_b16 v[122:123], v2 offset:25504
  s_waitcnt vmcnt(10) lgkmcnt(10)
  v_mfma_f32_32x32x16_bf16 v[148:163], v[100:103], v[60:63], v[148:163]
  ds_read_b64_tr_b16 v[124:125], v2 offset:27648
  ds_read_b64_tr_b16 v[126:127], v2 offset:28416
  buffer_load_dwordx4 v[36:39], v0, s[12:15], s66 offen offset:3072 sc1
  s_add_u32 s66, s66, s65
  s_waitcnt lgkmcnt(10)
  v_mfma_f32_32x32x16_bf16 v[164:179], v[104:107], v[60:63], v[164:179]
  ds_read_b64_tr_b16 v[128:129], v2 offset:27680
  ds_read_b64_tr_b16 v[130:131], v2 offset:28448
  s_waitcnt lgkmcnt(10)
  v_mfma_f32_32x32x16_bf16 v[180:195], v[108:111], v[60:63], v[180:195]
  ds_read_b64_tr_b16 v[132:133], v2 offset:27712
  ds_read_b64_tr_b16 v[134:135], v2 offset:28480
  s_waitcnt lgkmcnt(10)
  v_mfma_f32_32x32x16_bf16 v[196:211], v[112:115], v[60:63], v[196:211]
  ds_read_b64_tr_b16 v[136:137], v2 offset:27744
  ds_read_b64_tr_b16 v[138:139], v2 offset:28512
  s_waitcnt lgkmcnt(10)
  v_mfma_f32_32x32x16_bf16 v[212:227], v[116:119], v[60:63], v[212:227]
  ds_read_b64_tr_b16 v[140:141], v2 offset:27776
  ds_read_b64_tr_b16 v[142:143], v2 offset:28544
  s_waitcnt lgkmcnt(10)
  v_mfma_f32_32x32x16_bf16 v[228:243], v[120:123], v[60:63], v[228:243]
  ds_read_b64_tr_b16 v[144:145], v2 offset:27808
  ds_read_b64_tr_b16 v[146:147], v2 offset:28576
  s_waitcnt vmcnt(10) lgkmcnt(10)
  v_mfma_f32_32x32x16_bf16 v[148:163], v[124:127], v[64:67], v[148:163]
  ds_read_b64_tr_b16 v[100:101], v2 offset:30720
  ds_read_b64_tr_b16 v[102:103], v2 offset:31488
  buffer_load_dwordx4 v[60:63], v0, s[12:15], s66 offen offset:0 sc1
  s_waitcnt lgkmcnt(10)
  v_mfma_f32_32x32x16_bf16 v[164:179], v[128:131], v[64:67], v[164:179]
  ds_read_b64_tr_b16 v[104:105], v2 offset:30752
  ds_read_b64_tr_b16 v[106:107], v2 offset:31520
  s_waitcnt lgkmcnt(10)
  v_mfma_f32_32x32x16_bf16 v[180:195], v[132:135], v[64:67], v[180:195]
  ds_read_b64_tr_b16 v[108:109], v2 offset:30784
  ds_read_b64_tr_b16 v[110:111], v2 offset:31552
  s_waitcnt lgkmcnt(10)
  v_mfma_f32_32x32x16_bf16 v[196:211], v[136:139], v[64:67], v[196:211]
  ds_read_b64_tr_b16 v[112:113], v2 offset:30816
  ds_read_b64_tr_b16 v[114:115], v2 offset:31584
  s_waitcnt lgkmcnt(10)
  v_mfma_f32_32x32x16_bf16 v[212:227], v[140:143], v[64:67], v[212:227]
  ds_read_b64_tr_b16 v[116:117], v2 offset:30848
  ds_read_b64_tr_b16 v[118:119], v2 offset:31616
  s_waitcnt lgkmcnt(10)
  v_mfma_f32_32x32x16_bf16 v[228:243], v[144:147], v[64:67], v[228:243]
  ds_read_b64_tr_b16 v[120:121], v2 offset:30880
  ds_read_b64_tr_b16 v[122:123], v2 offset:31648
  s_waitcnt vmcnt(10) lgkmcnt(10)
  v_mfma_f32_32x32x16_bf16 v[148:163], v[100:103], v[68:71], v[148:163]
  ds_read_b64_tr_b16 v[124:125], v2 offset:33792
  ds_read_b64_tr_b16 v[126:127], v2 offset:34560
  buffer_load_dwordx4 v[64:67], v0, s[12:15], s66 offen offset:1024 sc1
  s_waitcnt lgkmcnt(10)
  v_mfma_f32_32x32x16_bf16 v[164:179], v[104:107], v[68:71], v[164:179]
  ds_read_b64_tr_b16 v[128:129], v2 offset:33824
  ds_read_b64_tr_b16 v[130:131], v2 offset:34592
  s_waitcnt lgkmcnt(10)
  v_mfma_f32_32x32x16_bf16 v[180:195], v[108:111], v[68:71], v[180:195]
  ds_read_b64_tr_b16 v[132:133], v2 offset:33856
  ds_read_b64_tr_b16 v[134:135], v2 offset:34624
  s_waitcnt lgkmcnt(10)
  v_mfma_f32_32x32x16_bf16 v[196:211], v[112:115], v[68:71], v[196:211]
  ds_read_b64_tr_b16 v[136:137], v2 offset:33888
  ds_read_b64_tr_b16 v[138:139], v2 offset:34656
  s_waitcnt lgkmcnt(10)
  v_mfma_f32_32x32x16_bf16 v[212:227], v[116:119], v[68:71], v[212:227]
  ds_read_b64_tr_b16 v[140:141], v2 offset:33920
  ds_read_b64_tr_b16 v[142:143], v2 offset:34688
  s_waitcnt lgkmcnt(10)
  v_mfma_f32_32x32x16_bf16 v[228:243], v[120:123], v[68:71], v[228:243]
  ds_read_b64_tr_b16 v[144:145], v2 offset:33952
  ds_read_b64_tr_b16 v[146:147], v2 offset:34720
  s_waitcnt vmcnt(10) lgkmcnt(10)
  v_mfma_f32_32x32x16_bf16 v[148:163], v[124:127], v[72:75], v[148:163]
  ds_read_b64_tr_b16 v[100:101], v2 offset:36864
  ds_read_b64_tr_b16 v[102:103], v2 offset:37632
  buffer_load_dwordx4 v[68:71], v0, s[12:15], s66 offen offset:2048 sc1
  s_waitcnt lgkmcnt(10)
  v_mfma_f32_32x32x16_bf16 v[164:179], v[128:131], v[72:75], v[164:179]
  ds_read_b64_tr_b16 v[104:105], v2 offset:36896
  ds_read_b64_tr_b16 v[106:107], v2 offset:37664
  s_waitcnt lgkmcnt(10)
  v_mfma_f32_32x32x16_bf16 v[180:195], v[132:135], v[72:75], v[180:195]
  ds_read_b64_tr_b16 v[108:109], v2 offset:36928
  ds_read_b64_tr_b16 v[110:111], v2 offset:37696
  s_waitcnt lgkmcnt(10)
  v_mfma_f32_32x32x16_bf16 v[196:211], v[136:139], v[72:75], v[196:211]
  ds_read_b64_tr_b16 v[112:113], v2 offset:36960
  ds_read_b64_tr_b16 v[114:115], v2 offset:37728
  s_waitcnt lgkmcnt(10)
  v_mfma_f32_32x32x16_bf16 v[212:227], v[140:143], v[72:75], v[212:227]
  ds_read_b64_tr_b16 v[116:117], v2 offset:36992
  ds_read_b64_tr_b16 v[118:119], v2 offset:37760
  s_waitcnt lgkmcnt(10)
  v_mfma_f32_32x32x16_bf16 v[228:243], v[144:147], v[72:75], v[228:243]
  ds_read_b64_tr_b16 v[120:121], v2 offset:37024
  ds_read_b64_tr_b16 v[122:123], v2 offset:37792
  s_waitcnt vmcnt(10) lgkmcnt(10)
  v_mfma_f32_32x32x16_bf16 v[148:163], v[100:103], v[8:11], v[148:163]
  ds_read_b64_tr_b16 v[124:125], v2 offset:39936
  ds_read_b64_tr_b16 v[126:127], v2 offset:40704
  buffer_load_dwordx4 v[72:75], v0, s[12:15], s66 offen offset:3072 sc1
  s_add_u32 s66, s66, 4096
  s_waitcnt lgkmcnt(10)
  v_mfma_f32_32x32x16_bf16 v[164:179], v[104:107], v[8:11], v[164:179]
  ds_read_b64_tr_b16 v[128:129], v2 offset:39968
  ds_read_b64_tr_b16 v[130:131], v2 offset:40736
  s_waitcnt lgkmcnt(10)
  v_mfma_f32_32x32x16_bf16 v[180:195], v[108:111], v[8:11], v[180:195]
  ds_read_b64_tr_b16 v[132:133], v2 offset:40000
  ds_read_b64_tr_b16 v[134:135], v2 offset:40768
  s_waitcnt lgkmcnt(10)
  v_mfma_f32_32x32x16_bf16 v[196:211], v[112:115], v[8:11], v[196:211]
  ds_read_b64_tr_b16 v[136:137], v2 offset:40032
  ds_read_b64_tr_b16 v[138:139], v2 offset:40800
  s_waitcnt lgkmcnt(10)
  v_mfma_f32_32x32x16_bf16 v[212:227], v[116:119], v[8:11], v[212:227]
  ds_read_b64_tr_b16 v[140:141], v2 offset:40064
  ds_read_b64_tr_b16 v[142:143], v2 offset:40832
  s_waitcnt lgkmcnt(10)
  v_mfma_f32_32x32x16_bf16 v[228:243], v[120:123], v[8:11], v[228:243]
  ds_read_b64_tr_b16 v[144:145], v2 offset:40096
  ds_read_b64_tr_b16 v[146:147], v2 offset:40864
  s_waitcnt vmcnt(10) lgkmcnt(10)
  v_mfma_f32_32x32x16_bf16 v[148:163], v[124:127], v[12:15], v[148:163]
  ds_read_b64_tr_b16 v[100:101], v2 offset:43008
  ds_read_b64_tr_b16 v[102:103], v2 offset:43776
  buffer_load_dwordx4 v[8:11], v0, s[12:15], s66 offen offset:0 sc1
  s_waitcnt lgkmcnt(10)
  v_mfma_f32_32x32x16_bf16 v[164:179], v[128:131], v[12:15], v[164:179]
  ds_read_b64_tr_b16 v[104:105], v2 offset:43040
  ds_read_b64_tr_b16 v[106:107], v2 offset:43808
  s_waitcnt lgkmcnt(10)
  v_mfma_f32_32x32x16_bf16 v[180:195], v[132:135], v[12:15], v[180:195]
  ds_read_b64_tr_b16 v[108:109], v2 offset:43072
  ds_read_b64_tr_b16 v[110:111], v2 offset:43840
  s_waitcnt lgkmcnt(10)
  v_mfma_f32_32x32x16_bf16 v[196:211], v[136:139], v[12:15], v[196:211]
  ds_read_b64_tr_b16 v[112:113], v2 offset:43104
  ds_read_b64_tr_b16 v[114:115], v2 offset:43872
  s_waitcnt lgkmcnt(10)
  v_mfma_f32_32x32x16_bf16 v[212:227], v[140:143], v[12:15], v[212:227]
  ds_read_b64_tr_b16 v[116:117], v2 offset:43136
  ds_read_b64_tr_b16 v[118:119], v2 offset:43904
  s_waitcnt lgkmcnt(10)
  v_mfma_f32_32x32x16_bf16 v[228:243], v[144:147], v[12:15], v[228:243]
  ds_read_b64_tr_b16 v[120:121], v2 offset:43168
  ds_read_b64_tr_b16 v[122:123], v2 offset:43936
  s_waitcnt vmcnt(10) lgkmcnt(10)
  v_mfma_f32_32x32x16_bf16 v[148:163], v[100:103], v[16:19], v[148:163]
  ds_read_b64_tr_b16 v[124:125], v2 offset:46080
  ds_read_b64_tr_b16 v[126:127], v2 offset:46848
  buffer_load_dwordx4 v[12:15], v0, s[12:15], s66 offen offset:1024 sc1
  s_waitcnt lgkmcnt(10)
  v_mfma_f32_32x32x16_bf16 v[164:179], v[104:107], v[16:19], v[164:179]
  ds_read_b64_tr_b16 v[128:129], v2 offset:46112
  ds_read_b64_tr_b16 v[130:131], v2 offset:46880
  s_waitcnt lgkmcnt(10)
  v_mfma_f32_32x32x16_bf16 v[180:195], v[108:111], v[16:19], v[180:195]
  ds_read_b64_tr_b16 v[132:133], v2 offset:46144
  ds_read_b64_tr_b16 v[134:135], v2 offset:46912
  s_waitcnt lgkmcnt(10)
  v_mfma_f32_32x32x16_bf16 v[196:211], v[112:115], v[16:19], v[196:211]
  ds_read_b64_tr_b16 v[136:137], v2 offset:46176
  ds_read_b64_tr_b16 v[138:139], v2 offset:46944
  s_waitcnt lgkmcnt(10)
  v_mfma_f32_32x32x16_bf16 v[212:227], v[116:119], v[16:19], v[212:227]
  ds_read_b64_tr_b16 v[140:141], v2 offset:46208
  ds_read_b64_tr_b16 v[142:143], v2 offset:46976
  s_waitcnt lgkmcnt(10)
  v_mfma_f32_32x32x16_bf16 v[228:243], v[120:123], v[16:19], v[228:243]
  ds_read_b64_tr_b16 v[144:145], v2 offset:46240
  ds_read_b64_tr_b16 v[146:147], v2 offset:47008
  s_waitcnt lgkmcnt(0)
  s_barrier
  s_waitcnt vmcnt(10)
  v_mfma_f32_32x32x16_bf16 v[148:163], v[124:127], v[20:23], v[148:163]
  ds_read_b64_tr_b16 v[100:101], v2 offset:49152
  ds_read_b64_tr_b16 v[102:103], v2 offset:49920
  buffer_load_dwordx4 v[16:19], v0, s[12:15], s66 offen offset:2048 sc1
  v_mfma_f32_32x32x16_bf16 v[164:179], v[128:131], v[20:23], v[164:179]
  ds_read_b64_tr_b16 v[104:105], v2 offset:49184
  ds_read_b64_tr_b16 v[106:107], v2 offset:49952
  v_mfma_f32_32x32x16_bf16 v[180:195], v[132:135], v[20:23], v[180:195]
  ds_read_b64_tr_b16 v[108:109], v2 offset:49216
  ds_read_b64_tr_b16 v[110:111], v2 offset:49984
  v_mfma_f32_32x32x16_bf16 v[196:211], v[136:139], v[20:23], v[196:211]
  ds_read_b64_tr_b16 v[112:113], v2 offset:49248
  ds_read_b64_tr_b16 v[114:115], v2 offset:50016
  v_mfma_f32_32x32x16_bf16 v[212:227], v[140:143], v[20:23], v[212:227]
  ds_read_b64_tr_b16 v[116:117], v2 offset:49280
  ds_read_b64_tr_b16 v[118:119], v2 offset:50048
  v_mfma_f32_32x32x16_bf16 v[228:243], v[144:147], v[20:23], v[228:243]
  ds_read_b64_tr_b16 v[120:121], v2 offset:49312
  ds_read_b64_tr_b16 v[122:123], v2 offset:50080
  s_waitcnt vmcnt(10) lgkmcnt(10)
  v_mfma_f32_32x32x16_bf16 v[148:163], v[100:103], v[24:27], v[148:163]
  ds_read_b64_tr_b16 v[124:125], v2 offset:52224
  ds_read_b64_tr_b16 v[126:127], v2 offset:52992
  buffer_load_dwordx4 v[20:23], v0, s[12:15], s66 offen offset:3072 sc1
  s_add_u32 s66, s66, 4096
  s_waitcnt lgkmcnt(10)
  v_mfma_f32_32x32x16_bf16 v[164:179], v[104:107], v[24:27], v[164:179]
  ds_read_b64_tr_b16 v[128:129], v2 offset:52256
  ds_read_b64_tr_b16 v[130:131], v2 offset:53024
  s_waitcnt lgkmcnt(10)
  v_mfma_f32_32x32x16_bf16 v[180:195], v[108:111], v[24:27], v[180:195]
  ds_read_b64_tr_b16 v[132:133], v2 offset:52288
  ds_read_b64_tr_b16 v[134:135], v2 offset:53056
  s_waitcnt lgkmcnt(10)
  v_mfma_f32_32x32x16_bf16 v[196:211], v[112:115], v[24:27], v[196:211]
  ds_read_b64_tr_b16 v[136:137], v2 offset:52320
  ds_read_b64_tr_b16 v[138:139], v2 offset:53088
  s_waitcnt lgkmcnt(10)
  v_mfma_f32_32x32x16_bf16 v[212:227], v[116:119], v[24:27], v[212:227]
  ds_read_b64_tr_b16 v[140:141], v2 offset:52352
  ds_read_b64_tr_b16 v[142:143], v2 offset:53120
  s_waitcnt lgkmcnt(10)
  v_mfma_f32_32x32x16_bf16 v[228:243], v[120:123], v[24:27], v[228:243]
  ds_read_b64_tr_b16 v[144:145], v2 offset:52384
  ds_read_b64_tr_b16 v[146:147], v2 offset:53152
  s_waitcnt vmcnt(10) lgkmcnt(10)
  v_mfma_f32_32x32x16_bf16 v[148:163], v[124:127], v[28:31], v[148:163]
  ds_read_b64_tr_b16 v[100:101], v2 offset:55296
  ds_read_b64_tr_b16 v[102:103], v2 offset:56064
  buffer_load_dwordx4 v[24:27], v0, s[12:15], s66 offen offset:0 sc1
  s_waitcnt lgkmcnt(10)
  v_mfma_f32_32x32x16_bf16 v[164:179], v[128:131], v[28:31], v[164:179]
  ds_read_b64_tr_b16 v[104:105], v2 offset:55328
  ds_read_b64_tr_b16 v[106:107], v2 offset:56096
  s_waitcnt lgkmcnt(10)
  v_mfma_f32_32x32x16_bf16 v[180:195], v[132:135], v[28:31], v[180:195]
  ds_read_b64_tr_b16 v[108:109], v2 offset:55360
  ds_read_b64_tr_b16 v[110:111], v2 offset:56128
  s_waitcnt lgkmcnt(10)
  v_mfma_f32_32x32x16_bf16 v[196:211], v[136:139], v[28:31], v[196:211]
  ds_read_b64_tr_b16 v[112:113], v2 offset:55392
  ds_read_b64_tr_b16 v[114:115], v2 offset:56160
  s_waitcnt lgkmcnt(10)
  v_mfma_f32_32x32x16_bf16 v[212:227], v[140:143], v[28:31], v[212:227]
  ds_read_b64_tr_b16 v[116:117], v2 offset:55424
  ds_read_b64_tr_b16 v[118:119], v2 offset:56192
  s_waitcnt lgkmcnt(10)
  v_mfma_f32_32x32x16_bf16 v[228:243], v[144:147], v[28:31], v[228:243]
  ds_read_b64_tr_b16 v[120:121], v2 offset:55456
  ds_read_b64_tr_b16 v[122:123], v2 offset:56224
  s_waitcnt vmcnt(10) lgkmcnt(10)
  v_mfma_f32_32x32x16_bf16 v[148:163], v[100:103], v[32:35], v[148:163]
  ds_read_b64_tr_b16 v[124:125], v2 offset:58368
  ds_read_b64_tr_b16 v[126:127], v2 offset:59136
  buffer_load_dwordx4 v[28:31], v0, s[12:15], s66 offen offset:1024 sc1
  s_waitcnt lgkmcnt(10)
  v_mfma_f32_32x32x16_bf16 v[164:179], v[104:107], v[32:35], v[164:179]
  ds_read_b64_tr_b16 v[128:129], v2 offset:58400
  ds_read_b64_tr_b16 v[130:131], v2 offset:59168
  s_waitcnt lgkmcnt(10)
  v_mfma_f32_32x32x16_bf16 v[180:195], v[108:111], v[32:35], v[180:195]
  ds_read_b64_tr_b16 v[132:133], v2 offset:58432
  ds_read_b64_tr_b16 v[134:135], v2 offset:59200
  s_waitcnt lgkmcnt(10)
  v_mfma_f32_32x32x16_bf16 v[196:211], v[112:115], v[32:35], v[196:211]
  ds_read_b64_tr_b16 v[136:137], v2 offset:58464
  ds_read_b64_tr_b16 v[138:139], v2 offset:59232
  s_waitcnt lgkmcnt(10)
  v_mfma_f32_32x32x16_bf16 v[212:227], v[116:119], v[32:35], v[212:227]
  ds_read_b64_tr_b16 v[140:141], v2 offset:58496
  ds_read_b64_tr_b16 v[142:143], v2 offset:59264
  s_waitcnt lgkmcnt(10)
  v_mfma_f32_32x32x16_bf16 v[228:243], v[120:123], v[32:35], v[228:243]
  ds_read_b64_tr_b16 v[144:145], v2 offset:58528
  ds_read_b64_tr_b16 v[146:147], v2 offset:59296
  s_waitcnt vmcnt(10) lgkmcnt(10)
  v_mfma_f32_32x32x16_bf16 v[148:163], v[124:127], v[36:39], v[148:163]
  ds_read_b64_tr_b16 v[100:101], v3 offset:0
  ds_read_b64_tr_b16 v[102:103], v3 offset:768
  buffer_load_dwordx4 v[32:35], v0, s[12:15], s66 offen offset:2048 sc1
  s_waitcnt lgkmcnt(10)
  v_mfma_f32_32x32x16_bf16 v[164:179], v[128:131], v[36:39], v[164:179]
  ds_read_b64_tr_b16 v[104:105], v3 offset:32
  ds_read_b64_tr_b16 v[106:107], v3 offset:800
  s_waitcnt lgkmcnt(10)
  v_mfma_f32_32x32x16_bf16 v[180:195], v[132:135], v[36:39], v[180:195]
  ds_read_b64_tr_b16 v[108:109], v3 offset:64
  ds_read_b64_tr_b16 v[110:111], v3 offset:832
  s_waitcnt lgkmcnt(10)
  v_mfma_f32_32x32x16_bf16 v[196:211], v[136:139], v[36:39], v[196:211]
  ds_read_b64_tr_b16 v[112:113], v3 offset:96
  ds_read_b64_tr_b16 v[114:115], v3 offset:864
  s_waitcnt lgkmcnt(10)
  v_mfma_f32_32x32x16_bf16 v[212:227], v[140:143], v[36:39], v[212:227]
  ds_read_b64_tr_b16 v[116:117], v3 offset:128
  ds_read_b64_tr_b16 v[118:119], v3 offset:896
  s_waitcnt lgkmcnt(10)
  v_mfma_f32_32x32x16_bf16 v[228:243], v[144:147], v[36:39], v[228:243]
  ds_read_b64_tr_b16 v[120:121], v3 offset:160
  ds_read_b64_tr_b16 v[122:123], v3 offset:928
  s_waitcnt vmcnt(10) lgkmcnt(10)
  v_mfma_f32_32x32x16_bf16 v[148:163], v[100:103], v[60:63], v[148:163]
  ds_read_b64_tr_b16 v[124:125], v3 offset:3072
  ds_read_b64_tr_b16 v[126:127], v3 offset:3840
  buffer_load_dwordx4 v[36:39], v0, s[12:15], s66 offen offset:3072 sc1
  s_add_u32 s66, s66, 4096
  s_waitcnt lgkmcnt(10)
  v_mfma_f32_32x32x16_bf16 v[164:179], v[104:107], v[60:63], v[164:179]
  ds_read_b64_tr_b16 v[128:129], v3 offset:3104
  ds_read_b64_tr_b16 v[130:131], v3 offset:3872
  s_waitcnt lgkmcnt(10)
  v_mfma_f32_32x32x16_bf16 v[180:195], v[108:111], v[60:63], v[180:195]
  ds_read_b64_tr_b16 v[132:133], v3 offset:3136
  ds_read_b64_tr_b16 v[134:135], v3 offset:3904
  s_waitcnt lgkmcnt(10)
  v_mfma_f32_32x32x16_bf16 v[196:211], v[112:115], v[60:63], v[196:211]
  ds_read_b64_tr_b16 v[136:137], v3 offset:3168
  ds_read_b64_tr_b16 v[138:139], v3 offset:3936
  s_waitcnt lgkmcnt(10)
  v_mfma_f32_32x32x16_bf16 v[212:227], v[116:119], v[60:63], v[212:227]
  ds_read_b64_tr_b16 v[140:141], v3 offset:3200
  ds_read_b64_tr_b16 v[142:143], v3 offset:3968
  s_waitcnt lgkmcnt(10)
  v_mfma_f32_32x32x16_bf16 v[228:243], v[120:123], v[60:63], v[228:243]
  ds_read_b64_tr_b16 v[144:145], v3 offset:3232
  ds_read_b64_tr_b16 v[146:147], v3 offset:4000
  s_barrier
  s_waitcnt vmcnt(10) lgkmcnt(10)
  v_mfma_f32_32x32x16_bf16 v[148:163], v[124:127], v[64:67], v[148:163]
  ds_read_b64_tr_b16 v[100:101], v3 offset:6144
  ds_read_b64_tr_b16 v[102:103], v3 offset:6912
  buffer_load_dwordx4 v[60:63], v0, s[12:15], s66 offen offset:0 sc1
  s_waitcnt lgkmcnt(10)
  v_mfma_f32_32x32x16_bf16 v[164:179], v[128:131], v[64:67], v[164:179]
  ds_read_b64_tr_b16 v[104:105], v3 offset:6176
  ds_read_b64_tr_b16 v[106:107], v3 offset:6944
  s_waitcnt lgkmcnt(10)
  v_mfma_f32_32x32x16_bf16 v[180:195], v[132:135], v[64:67], v[180:195]
  ds_read_b64_tr_b16 v[108:109], v3 offset:6208
  ds_read_b64_tr_b16 v[110:111], v3 offset:6976
  s_waitcnt lgkmcnt(10)
  v_mfma_f32_32x32x16_bf16 v[196:211], v[136:139], v[64:67], v[196:211]
  ds_read_b64_tr_b16 v[112:113], v3 offset:6240
  ds_read_b64_tr_b16 v[114:115], v3 offset:7008
  s_waitcnt lgkmcnt(10)
  v_mfma_f32_32x32x16_bf16 v[212:227], v[140:143], v[64:67], v[212:227]
  ds_read_b64_tr_b16 v[116:117], v3 offset:6272
  ds_read_b64_tr_b16 v[118:119], v3 offset:7040
  s_waitcnt lgkmcnt(10)
  v_mfma_f32_32x32x16_bf16 v[228:243], v[144:147], v[64:67], v[228:243]
  ds_read_b64_tr_b16 v[120:121], v3 offset:6304
  ds_read_b64_tr_b16 v[122:123], v3 offset:7072
  s_waitcnt vmcnt(10) lgkmcnt(10)
  v_mfma_f32_32x32x16_bf16 v[148:163], v[100:103], v[68:71], v[148:163]
  ds_read_b64_tr_b16 v[124:125], v3 offset:9216
  ds_read_b64_tr_b16 v[126:127], v3 offset:9984
  buffer_load_dwordx4 v[64:67], v0, s[12:15], s66 offen offset:1024 sc1
  s_waitcnt lgkmcnt(10)
  v_mfma_f32_32x32x16_bf16 v[164:179], v[104:107], v[68:71], v[164:179]
  ds_read_b64_tr_b16 v[128:129], v3 offset:9248
  ds_read_b64_tr_b16 v[130:131], v3 offset:10016
  s_waitcnt lgkmcnt(10)
  v_mfma_f32_32x32x16_bf16 v[180:195], v[108:111], v[68:71], v[180:195]
  ds_read_b64_tr_b16 v[132:133], v3 offset:9280
  ds_read_b64_tr_b16 v[134:135], v3 offset:10048
  s_waitcnt lgkmcnt(10)
  v_mfma_f32_32x32x16_bf16 v[196:211], v[112:115], v[68:71], v[196:211]
  ds_read_b64_tr_b16 v[136:137], v3 offset:9312
  ds_read_b64_tr_b16 v[138:139], v3 offset:10080
  s_waitcnt lgkmcnt(10)
  v_mfma_f32_32x32x16_bf16 v[212:227], v[116:119], v[68:71], v[212:227]
  ds_read_b64_tr_b16 v[140:141], v3 offset:9344
  ds_read_b64_tr_b16 v[142:143], v3 offset:10112
  s_waitcnt lgkmcnt(10)
  v_mfma_f32_32x32x16_bf16 v[228:243], v[120:123], v[68:71], v[228:243]
  ds_read_b64_tr_b16 v[144:145], v3 offset:9376
  ds_read_b64_tr_b16 v[146:147], v3 offset:10144
  s_waitcnt vmcnt(10) lgkmcnt(10)
  v_mfma_f32_32x32x16_bf16 v[148:163], v[124:127], v[72:75], v[148:163]
  ds_read_b64_tr_b16 v[100:101], v3 offset:12288
  ds_read_b64_tr_b16 v[102:103], v3 offset:13056
  buffer_load_dwordx4 v[68:71], v0, s[12:15], s66 offen offset:2048 sc1
  s_waitcnt lgkmcnt(10)
  v_mfma_f32_32x32x16_bf16 v[164:179], v[128:131], v[72:75], v[164:179]
  ds_read_b64_tr_b16 v[104:105], v3 offset:12320
  ds_read_b64_tr_b16 v[106:107], v3 offset:13088
  s_waitcnt lgkmcnt(10)
  v_mfma_f32_32x32x16_bf16 v[180:195], v[132:135], v[72:75], v[180:195]
  ds_read_b64_tr_b16 v[108:109], v3 offset:12352
  ds_read_b64_tr_b16 v[110:111], v3 offset:13120
  s_waitcnt lgkmcnt(10)
  v_mfma_f32_32x32x16_bf16 v[196:211], v[136:139], v[72:75], v[196:211]
  ds_read_b64_tr_b16 v[112:113], v3 offset:12384
  ds_read_b64_tr_b16 v[114:115], v3 offset:13152
  s_waitcnt lgkmcnt(10)
  v_mfma_f32_32x32x16_bf16 v[212:227], v[140:143], v[72:75], v[212:227]
  ds_read_b64_tr_b16 v[116:117], v3 offset:12416
  ds_read_b64_tr_b16 v[118:119], v3 offset:13184
  s_waitcnt lgkmcnt(10)
  v_mfma_f32_32x32x16_bf16 v[228:243], v[144:147], v[72:75], v[228:243]
  ds_read_b64_tr_b16 v[120:121], v3 offset:12448
  ds_read_b64_tr_b16 v[122:123], v3 offset:13216
  s_waitcnt vmcnt(10) lgkmcnt(10)
  v_mfma_f32_32x32x16_bf16 v[148:163], v[100:103], v[8:11], v[148:163]
  ds_read_b64_tr_b16 v[124:125], v3 offset:15360
  ds_read_b64_tr_b16 v[126:127], v3 offset:16128
  buffer_load_dwordx4 v[72:75], v0, s[12:15], s66 offen offset:3072 sc1
  s_add_u32 s66, s66, 4096
  s_waitcnt lgkmcnt(10)
  v_mfma_f32_32x32x16_bf16 v[164:179], v[104:107], v[8:11], v[164:179]
  ds_read_b64_tr_b16 v[128:129], v3 offset:15392
  ds_read_b64_tr_b16 v[130:131], v3 offset:16160
  s_waitcnt lgkmcnt(10)
  v_mfma_f32_32x32x16_bf16 v[180:195], v[108:111], v[8:11], v[180:195]
  ds_read_b64_tr_b16 v[132:133], v3 offset:15424
  ds_read_b64_tr_b16 v[134:135], v3 offset:16192
  s_waitcnt lgkmcnt(10)
  v_mfma_f32_32x32x16_bf16 v[196:211], v[112:115], v[8:11], v[196:211]
  ds_read_b64_tr_b16 v[136:137], v3 offset:15456
  ds_read_b64_tr_b16 v[138:139], v3 offset:16224
  s_waitcnt lgkmcnt(10)
  v_mfma_f32_32x32x16_bf16 v[212:227], v[116:119], v[8:11], v[212:227]
  ds_read_b64_tr_b16 v[140:141], v3 offset:15488
  ds_read_b64_tr_b16 v[142:143], v3 offset:16256
  s_waitcnt lgkmcnt(10)
  v_mfma_f32_32x32x16_bf16 v[228:243], v[120:123], v[8:11], v[228:243]
  ds_read_b64_tr_b16 v[144:145], v3 offset:15520
  ds_read_b64_tr_b16 v[146:147], v3 offset:16288
  s_waitcnt vmcnt(10) lgkmcnt(10)
  v_mfma_f32_32x32x16_bf16 v[148:163], v[124:127], v[12:15], v[148:163]
  ds_read_b64_tr_b16 v[100:101], v2 offset:0
  ds_read_b64_tr_b16 v[102:103], v2 offset:768
  buffer_load_dwordx4 v[8:11], v0, s[12:15], s66 offen offset:0 sc1
  s_waitcnt lgkmcnt(10)
  v_mfma_f32_32x32x16_bf16 v[164:179], v[128:131], v[12:15], v[164:179]
  ds_read_b64_tr_b16 v[104:105], v2 offset:32
  ds_read_b64_tr_b16 v[106:107], v2 offset:800
  s_waitcnt lgkmcnt(10)
  v_mfma_f32_32x32x16_bf16 v[180:195], v[132:135], v[12:15], v[180:195]
  ds_read_b64_tr_b16 v[108:109], v2 offset:64
  ds_read_b64_tr_b16 v[110:111], v2 offset:832
  s_waitcnt lgkmcnt(10)
  v_mfma_f32_32x32x16_bf16 v[196:211], v[136:139], v[12:15], v[196:211]
  ds_read_b64_tr_b16 v[112:113], v2 offset:96
  ds_read_b64_tr_b16 v[114:115], v2 offset:864
  s_waitcnt lgkmcnt(10)
  v_mfma_f32_32x32x16_bf16 v[212:227], v[140:143], v[12:15], v[212:227]
  ds_read_b64_tr_b16 v[116:117], v2 offset:128
  ds_read_b64_tr_b16 v[118:119], v2 offset:896
  s_waitcnt lgkmcnt(10)
  v_mfma_f32_32x32x16_bf16 v[228:243], v[144:147], v[12:15], v[228:243]
  ds_read_b64_tr_b16 v[120:121], v2 offset:160
  ds_read_b64_tr_b16 v[122:123], v2 offset:928
  s_barrier
  s_waitcnt vmcnt(10) lgkmcnt(10)
  v_mfma_f32_32x32x16_bf16 v[148:163], v[100:103], v[16:19], v[148:163]
  ds_read_b64_tr_b16 v[124:125], v2 offset:3072
  ds_read_b64_tr_b16 v[126:127], v2 offset:3840
  buffer_load_dwordx4 v[12:15], v0, s[12:15], s66 offen offset:1024 sc1
  s_waitcnt lgkmcnt(10)
  v_mfma_f32_32x32x16_bf16 v[164:179], v[104:107], v[16:19], v[164:179]
  ds_read_b64_tr_b16 v[128:129], v2 offset:3104
  ds_read_b64_tr_b16 v[130:131], v2 offset:3872
  s_waitcnt lgkmcnt(10)
  v_mfma_f32_32x32x16_bf16 v[180:195], v[108:111], v[16:19], v[180:195]
  ds_read_b64_tr_b16 v[132:133], v2 offset:3136
  ds_read_b64_tr_b16 v[134:135], v2 offset:3904
  s_waitcnt lgkmcnt(10)
  v_mfma_f32_32x32x16_bf16 v[196:211], v[112:115], v[16:19], v[196:211]
  ds_read_b64_tr_b16 v[136:137], v2 offset:3168
  ds_read_b64_tr_b16 v[138:139], v2 offset:3936
  s_waitcnt lgkmcnt(10)
  v_mfma_f32_32x32x16_bf16 v[212:227], v[116:119], v[16:19], v[212:227]
  ds_read_b64_tr_b16 v[140:141], v2 offset:3200
  ds_read_b64_tr_b16 v[142:143], v2 offset:3968
  s_waitcnt lgkmcnt(10)
  v_mfma_f32_32x32x16_bf16 v[228:243], v[120:123], v[16:19], v[228:243]
  ds_read_b64_tr_b16 v[144:145], v2 offset:3232
  ds_read_b64_tr_b16 v[146:147], v2 offset:4000
  s_waitcnt vmcnt(10) lgkmcnt(10)
  v_mfma_f32_32x32x16_bf16 v[148:163], v[124:127], v[20:23], v[148:163]
  ds_read_b64_tr_b16 v[100:101], v2 offset:6144
  ds_read_b64_tr_b16 v[102:103], v2 offset:6912
  buffer_load_dwordx4 v[16:19], v0, s[12:15], s66 offen offset:2048 sc1
  s_waitcnt lgkmcnt(10)
  v_mfma_f32_32x32x16_bf16 v[164:179], v[128:131], v[20:23], v[164:179]
  ds_read_b64_tr_b16 v[104:105], v2 offset:6176
  ds_read_b64_tr_b16 v[106:107], v2 offset:6944
  s_waitcnt lgkmcnt(10)
  v_mfma_f32_32x32x16_bf16 v[180:195], v[132:135], v[20:23], v[180:195]
  ds_read_b64_tr_b16 v[108:109], v2 offset:6208
  ds_read_b64_tr_b16 v[110:111], v2 offset:6976
  s_waitcnt lgkmcnt(10)
  v_mfma_f32_32x32x16_bf16 v[196:211], v[136:139], v[20:23], v[196:211]
  ds_read_b64_tr_b16 v[112:113], v2 offset:6240
  ds_read_b64_tr_b16 v[114:115], v2 offset:7008
  s_waitcnt lgkmcnt(10)
  v_mfma_f32_32x32x16_bf16 v[212:227], v[140:143], v[20:23], v[212:227]
  ds_read_b64_tr_b16 v[116:117], v2 offset:6272
  ds_read_b64_tr_b16 v[118:119], v2 offset:7040
  s_waitcnt lgkmcnt(10)
  v_mfma_f32_32x32x16_bf16 v[228:243], v[144:147], v[20:23], v[228:243]
  ds_read_b64_tr_b16 v[120:121], v2 offset:6304
  ds_read_b64_tr_b16 v[122:123], v2 offset:7072
  s_waitcnt vmcnt(10) lgkmcnt(10)
  v_mfma_f32_32x32x16_bf16 v[148:163], v[100:103], v[24:27], v[148:163]
  ds_read_b64_tr_b16 v[124:125], v2 offset:9216
  ds_read_b64_tr_b16 v[126:127], v2 offset:9984
  buffer_load_dwordx4 v[20:23], v0, s[12:15], s66 offen offset:3072 sc1
  s_waitcnt lgkmcnt(10)
  v_mfma_f32_32x32x16_bf16 v[164:179], v[104:107], v[24:27], v[164:179]
  ds_read_b64_tr_b16 v[128:129], v2 offset:9248
  ds_read_b64_tr_b16 v[130:131], v2 offset:10016
  s_waitcnt lgkmcnt(10)
  v_mfma_f32_32x32x16_bf16 v[180:195], v[108:111], v[24:27], v[180:195]
  ds_read_b64_tr_b16 v[132:133], v2 offset:9280
  ds_read_b64_tr_b16 v[134:135], v2 offset:10048
  s_waitcnt lgkmcnt(10)
  v_mfma_f32_32x32x16_bf16 v[196:211], v[112:115], v[24:27], v[196:211]
  ds_read_b64_tr_b16 v[136:137], v2 offset:9312
  ds_read_b64_tr_b16 v[138:139], v2 offset:10080
  s_waitcnt lgkmcnt(10)
  v_mfma_f32_32x32x16_bf16 v[212:227], v[116:119], v[24:27], v[212:227]
  ds_read_b64_tr_b16 v[140:141], v2 offset:9344
  ds_read_b64_tr_b16 v[142:143], v2 offset:10112
  s_waitcnt lgkmcnt(10)
  v_mfma_f32_32x32x16_bf16 v[228:243], v[120:123], v[24:27], v[228:243]
  ds_read_b64_tr_b16 v[144:145], v2 offset:9376
  ds_read_b64_tr_b16 v[146:147], v2 offset:10144
  s_waitcnt vmcnt(10) lgkmcnt(10)
  v_mfma_f32_32x32x16_bf16 v[148:163], v[124:127], v[28:31], v[148:163]
  ds_read_b64_tr_b16 v[100:101], v2 offset:12288
  ds_read_b64_tr_b16 v[102:103], v2 offset:13056
  s_waitcnt lgkmcnt(10)
  v_mfma_f32_32x32x16_bf16 v[164:179], v[128:131], v[28:31], v[164:179]
  ds_read_b64_tr_b16 v[104:105], v2 offset:12320
  ds_read_b64_tr_b16 v[106:107], v2 offset:13088
  s_waitcnt lgkmcnt(10)
  v_mfma_f32_32x32x16_bf16 v[180:195], v[132:135], v[28:31], v[180:195]
  ds_read_b64_tr_b16 v[108:109], v2 offset:12352
  ds_read_b64_tr_b16 v[110:111], v2 offset:13120
  s_waitcnt lgkmcnt(10)
  v_mfma_f32_32x32x16_bf16 v[196:211], v[136:139], v[28:31], v[196:211]
  ds_read_b64_tr_b16 v[112:113], v2 offset:12384
  ds_read_b64_tr_b16 v[114:115], v2 offset:13152
  s_waitcnt lgkmcnt(10)
  v_mfma_f32_32x32x16_bf16 v[212:227], v[140:143], v[28:31], v[212:227]
  ds_read_b64_tr_b16 v[116:117], v2 offset:12416
  ds_read_b64_tr_b16 v[118:119], v2 offset:13184
  s_waitcnt lgkmcnt(10)
  v_mfma_f32_32x32x16_bf16 v[228:243], v[144:147], v[28:31], v[228:243]
  ds_read_b64_tr_b16 v[120:121], v2 offset:12448
  ds_read_b64_tr_b16 v[122:123], v2 offset:13216
  s_waitcnt vmcnt(9) lgkmcnt(10)
  v_mfma_f32_32x32x16_bf16 v[148:163], v[100:103], v[32:35], v[148:163]
  ds_read_b64_tr_b16 v[124:125], v2 offset:15360
  ds_read_b64_tr_b16 v[126:127], v2 offset:16128
  s_waitcnt lgkmcnt(10)
  v_mfma_f32_32x32x16_bf16 v[164:179], v[104:107], v[32:35], v[164:179]
  ds_read_b64_tr_b16 v[128:129], v2 offset:15392
  ds_read_b64_tr_b16 v[130:131], v2 offset:16160
  s_waitcnt lgkmcnt(10)
  v_mfma_f32_32x32x16_bf16 v[180:195], v[108:111], v[32:35], v[180:195]
  ds_read_b64_tr_b16 v[132:133], v2 offset:15424
  ds_read_b64_tr_b16 v[134:135], v2 offset:16192
  s_waitcnt lgkmcnt(10)
  v_mfma_f32_32x32x16_bf16 v[196:211], v[112:115], v[32:35], v[196:211]
  ds_read_b64_tr_b16 v[136:137], v2 offset:15456
  ds_read_b64_tr_b16 v[138:139], v2 offset:16224
  s_waitcnt lgkmcnt(10)
  v_mfma_f32_32x32x16_bf16 v[212:227], v[116:119], v[32:35], v[212:227]
  ds_read_b64_tr_b16 v[140:141], v2 offset:15488
  ds_read_b64_tr_b16 v[142:143], v2 offset:16256
  s_waitcnt lgkmcnt(10)
  v_mfma_f32_32x32x16_bf16 v[228:243], v[120:123], v[32:35], v[228:243]
  ds_read_b64_tr_b16 v[144:145], v2 offset:15520
  ds_read_b64_tr_b16 v[146:147], v2 offset:16288
  s_barrier
  s_waitcnt vmcnt(8) lgkmcnt(10)
  v_mfma_f32_32x32x16_bf16 v[148:163], v[124:127], v[36:39], v[148:163]
  ds_read_b64_tr_b16 v[100:101], v2 offset:18432
  ds_read_b64_tr_b16 v[102:103], v2 offset:19200
  s_waitcnt lgkmcnt(10)
  v_mfma_f32_32x32x16_bf16 v[164:179], v[128:131], v[36:39], v[164:179]
  ds_read_b64_tr_b16 v[104:105], v2 offset:18464
  ds_read_b64_tr_b16 v[106:107], v2 offset:19232
  s_waitcnt lgkmcnt(10)
  v_mfma_f32_32x32x16_bf16 v[180:195], v[132:135], v[36:39], v[180:195]
  ds_read_b64_tr_b16 v[108:109], v2 offset:18496
  ds_read_b64_tr_b16 v[110:111], v2 offset:19264
  s_waitcnt lgkmcnt(10)
  v_mfma_f32_32x32x16_bf16 v[196:211], v[136:139], v[36:39], v[196:211]
  s_waitcnt lgkmcnt(8)
  v_mfma_f32_32x32x16_bf16 v[212:227], v[140:143], v[36:39], v[212:227]
  s_waitcnt lgkmcnt(6)
  v_mfma_f32_32x32x16_bf16 v[228:243], v[144:147], v[36:39], v[228:243]
  s_waitcnt vmcnt(7) lgkmcnt(4)
  v_mfma_f32_32x32x16_bf16 v[148:163], v[100:103], v[60:63], v[148:163]
  ds_read_b64_tr_b16 v[124:125], v2 offset:21504
  ds_read_b64_tr_b16 v[126:127], v2 offset:22272
  s_waitcnt lgkmcnt(4)
  v_mfma_f32_32x32x16_bf16 v[164:179], v[104:107], v[60:63], v[164:179]
  ds_read_b64_tr_b16 v[128:129], v2 offset:21536
  ds_read_b64_tr_b16 v[130:131], v2 offset:22304
  s_waitcnt lgkmcnt(4)
  v_mfma_f32_32x32x16_bf16 v[180:195], v[108:111], v[60:63], v[180:195]
  ds_read_b64_tr_b16 v[132:133], v2 offset:21568
  ds_read_b64_tr_b16 v[134:135], v2 offset:22336
  s_waitcnt vmcnt(6) lgkmcnt(4)
  v_mfma_f32_32x32x16_bf16 v[148:163], v[124:127], v[64:67], v[148:163]
  ds_read_b64_tr_b16 v[100:101], v2 offset:24576
  ds_read_b64_tr_b16 v[102:103], v2 offset:25344
  s_waitcnt lgkmcnt(4)
  v_mfma_f32_32x32x16_bf16 v[164:179], v[128:131], v[64:67], v[164:179]
  ds_read_b64_tr_b16 v[104:105], v2 offset:24608
  ds_read_b64_tr_b16 v[106:107], v2 offset:25376
  s_waitcnt lgkmcnt(4)
  v_mfma_f32_32x32x16_bf16 v[180:195], v[132:135], v[64:67], v[180:195]
  ds_read_b64_tr_b16 v[108:109], v2 offset:24640
  ds_read_b64_tr_b16 v[110:111], v2 offset:25408
  s_waitcnt vmcnt(5) lgkmcnt(4)
  v_mfma_f32_32x32x16_bf16 v[148:163], v[100:103], v[68:71], v[148:163]
  ds_read_b64_tr_b16 v[124:125], v2 offset:27648
  ds_read_b64_tr_b16 v[126:127], v2 offset:28416
  s_waitcnt lgkmcnt(4)
  v_mfma_f32_32x32x16_bf16 v[164:179], v[104:107], v[68:71], v[164:179]
  ds_read_b64_tr_b16 v[128:129], v2 offset:27680
  ds_read_b64_tr_b16 v[130:131], v2 offset:28448
  s_waitcnt lgkmcnt(4)
  v_mfma_f32_32x32x16_bf16 v[180:195], v[108:111], v[68:71], v[180:195]
  ds_read_b64_tr_b16 v[132:133], v2 offset:27712
  ds_read_b64_tr_b16 v[134:135], v2 offset:28480
  s_waitcnt vmcnt(4) lgkmcnt(4)
  v_mfma_f32_32x32x16_bf16 v[148:163], v[124:127], v[72:75], v[148:163]
  ds_read_b64_tr_b16 v[100:101], v2 offset:30720
  ds_read_b64_tr_b16 v[102:103], v2 offset:31488
  s_waitcnt lgkmcnt(4)
  v_mfma_f32_32x32x16_bf16 v[164:179], v[128:131], v[72:75], v[164:179]
  ds_read_b64_tr_b16 v[104:105], v2 offset:30752
  ds_read_b64_tr_b16 v[106:107], v2 offset:31520
  s_waitcnt lgkmcnt(4)
  v_mfma_f32_32x32x16_bf16 v[180:195], v[132:135], v[72:75], v[180:195]
  ds_read_b64_tr_b16 v[108:109], v2 offset:30784
  ds_read_b64_tr_b16 v[110:111], v2 offset:31552
  s_waitcnt vmcnt(3) lgkmcnt(4)
  v_mfma_f32_32x32x16_bf16 v[148:163], v[100:103], v[8:11], v[148:163]
  ds_read_b64_tr_b16 v[124:125], v2 offset:33792
  ds_read_b64_tr_b16 v[126:127], v2 offset:34560
  s_waitcnt lgkmcnt(4)
  v_mfma_f32_32x32x16_bf16 v[164:179], v[104:107], v[8:11], v[164:179]
  ds_read_b64_tr_b16 v[128:129], v2 offset:33824
  ds_read_b64_tr_b16 v[130:131], v2 offset:34592
  s_waitcnt lgkmcnt(4)
  v_mfma_f32_32x32x16_bf16 v[180:195], v[108:111], v[8:11], v[180:195]
  ds_read_b64_tr_b16 v[132:133], v2 offset:33856
  ds_read_b64_tr_b16 v[134:135], v2 offset:34624
  s_waitcnt vmcnt(2) lgkmcnt(4)
  v_mfma_f32_32x32x16_bf16 v[148:163], v[124:127], v[12:15], v[148:163]
  ds_read_b64_tr_b16 v[100:101], v2 offset:36864
  ds_read_b64_tr_b16 v[102:103], v2 offset:37632
  s_waitcnt lgkmcnt(4)
  v_mfma_f32_32x32x16_bf16 v[164:179], v[128:131], v[12:15], v[164:179]
  ds_read_b64_tr_b16 v[104:105], v2 offset:36896
  ds_read_b64_tr_b16 v[106:107], v2 offset:37664
  s_waitcnt lgkmcnt(4)
  v_mfma_f32_32x32x16_bf16 v[180:195], v[132:135], v[12:15], v[180:195]
  ds_read_b64_tr_b16 v[108:109], v2 offset:36928
  ds_read_b64_tr_b16 v[110:111], v2 offset:37696
  s_waitcnt vmcnt(1) lgkmcnt(4)
  v_mfma_f32_32x32x16_bf16 v[148:163], v[100:103], v[16:19], v[148:163]
  ds_read_b64_tr_b16 v[124:125], v2 offset:39936
  ds_read_b64_tr_b16 v[126:127], v2 offset:40704
  s_waitcnt lgkmcnt(4)
  v_mfma_f32_32x32x16_bf16 v[164:179], v[104:107], v[16:19], v[164:179]
  ds_read_b64_tr_b16 v[128:129], v2 offset:39968
  ds_read_b64_tr_b16 v[130:131], v2 offset:40736
  s_waitcnt lgkmcnt(4)
  v_mfma_f32_32x32x16_bf16 v[180:195], v[108:111], v[16:19], v[180:195]
  ds_read_b64_tr_b16 v[132:133], v2 offset:40000
  ds_read_b64_tr_b16 v[134:135], v2 offset:40768
  s_waitcnt vmcnt(0) lgkmcnt(4)
  v_mfma_f32_32x32x16_bf16 v[148:163], v[124:127], v[20:23], v[148:163]
  ds_read_b64_tr_b16 v[112:113], v2 offset:18528
  ds_read_b64_tr_b16 v[114:115], v2 offset:19296
  s_waitcnt lgkmcnt(4)
  v_mfma_f32_32x32x16_bf16 v[164:179], v[128:131], v[20:23], v[164:179]
  ds_read_b64_tr_b16 v[116:117], v2 offset:18560
  ds_read_b64_tr_b16 v[118:119], v2 offset:19328
  s_waitcnt lgkmcnt(4)
  v_mfma_f32_32x32x16_bf16 v[180:195], v[132:135], v[20:23], v[180:195]
  ds_read_b64_tr_b16 v[120:121], v2 offset:18592
  ds_read_b64_tr_b16 v[122:123], v2 offset:19360
  s_waitcnt lgkmcnt(4)
  v_mfma_f32_32x32x16_bf16 v[196:211], v[112:115], v[60:63], v[196:211]
  ds_read_b64_tr_b16 v[136:137], v2 offset:21600
  ds_read_b64_tr_b16 v[138:139], v2 offset:22368
  s_waitcnt lgkmcnt(4)
  v_mfma_f32_32x32x16_bf16 v[212:227], v[116:119], v[60:63], v[212:227]
  ds_read_b64_tr_b16 v[140:141], v2 offset:21632
  ds_read_b64_tr_b16 v[142:143], v2 offset:22400
  s_waitcnt lgkmcnt(4)
  v_mfma_f32_32x32x16_bf16 v[228:243], v[120:123], v[60:63], v[228:243]
  ds_read_b64_tr_b16 v[144:145], v2 offset:21664
  ds_read_b64_tr_b16 v[146:147], v2 offset:22432
  s_waitcnt lgkmcnt(4)
  v_mfma_f32_32x32x16_bf16 v[196:211], v[136:139], v[64:67], v[196:211]
  ds_read_b64_tr_b16 v[112:113], v2 offset:24672
  ds_read_b64_tr_b16 v[114:115], v2 offset:25440
  v_mul_f32 v244, 0xbfb8aa3b, v148
  v_mul_f32 v245, 0xbfb8aa3b, v149
  v_mul_f32 v246, 0xbfb8aa3b, v150
  v_mul_f32 v247, 0xbfb8aa3b, v151
  v_mul_f32 v248, 0xbfb8aa3b, v152
  v_mul_f32 v249, 0xbfb8aa3b, v153
  v_mul_f32 v250, 0xbfb8aa3b, v154
  s_waitcnt lgkmcnt(4)
  v_mfma_f32_32x32x16_bf16 v[212:227], v[140:143], v[64:67], v[212:227]
  ds_read_b64_tr_b16 v[116:117], v2 offset:24704
  ds_read_b64_tr_b16 v[118:119], v2 offset:25472
  v_mul_f32 v251, 0xbfb8aa3b, v155
  v_exp_f32 v244, v244
  v_exp_f32 v245, v245
  v_exp_f32 v246, v246
  v_exp_f32 v247, v247
  v_exp_f32 v248, v248
  v_exp_f32 v249, v249
  s_waitcnt lgkmcnt(4)
  v_mfma_f32_32x32x16_bf16 v[228:243], v[144:147], v[64:67], v[228:243]
  ds_read_b64_tr_b16 v[120:121], v2 offset:24736
  ds_read_b64_tr_b16 v[122:123], v2 offset:25504
  v_exp_f32 v250, v250
  v_exp_f32 v251, v251
  v_add_f32 v244, 1.0, v244
  v_add_f32 v245, 1.0, v245
  v_add_f32 v246, 1.0, v246
  v_add_f32 v247, 1.0, v247
  v_add_f32 v248, 1.0, v248
  s_waitcnt lgkmcnt(4)
  v_mfma_f32_32x32x16_bf16 v[196:211], v[112:115], v[68:71], v[196:211]
  ds_read_b64_tr_b16 v[136:137], v2 offset:27744
  ds_read_b64_tr_b16 v[138:139], v2 offset:28512
  v_add_f32 v249, 1.0, v249
  v_add_f32 v250, 1.0, v250
  v_add_f32 v251, 1.0, v251
  v_rcp_f32 v244, v244
  v_rcp_f32 v245, v245
  v_rcp_f32 v246, v246
  v_rcp_f32 v247, v247
  s_waitcnt lgkmcnt(4)
  v_mfma_f32_32x32x16_bf16 v[212:227], v[116:119], v[68:71], v[212:227]
  ds_read_b64_tr_b16 v[140:141], v2 offset:27776
  ds_read_b64_tr_b16 v[142:143], v2 offset:28544
  v_rcp_f32 v248, v248
  v_rcp_f32 v249, v249
  v_rcp_f32 v250, v250
  v_rcp_f32 v251, v251
  v_mul_f32 v244, v244, v156
  v_mul_f32 v245, v245, v157
  v_mul_f32 v246, v246, v158
  s_waitcnt lgkmcnt(4)
  v_mfma_f32_32x32x16_bf16 v[228:243], v[120:123], v[68:71], v[228:243]
  ds_read_b64_tr_b16 v[144:145], v2 offset:27808
  ds_read_b64_tr_b16 v[146:147], v2 offset:28576
  v_mul_f32 v247, v247, v159
  v_mul_f32 v248, v248, v160
  v_mul_f32 v249, v249, v161
  v_mul_f32 v250, v250, v162
  v_mul_f32 v251, v251, v163
  v_cvt_pk_bf16_f32 v76, v244, v245
  v_cvt_pk_bf16_f32 v77, v246, v247
  s_waitcnt lgkmcnt(4)
  v_mfma_f32_32x32x16_bf16 v[196:211], v[136:139], v[72:75], v[196:211]
  ds_read_b64_tr_b16 v[112:113], v2 offset:30816
  ds_read_b64_tr_b16 v[114:115], v2 offset:31584
  v_cvt_pk_bf16_f32 v78, v248, v249
  v_cvt_pk_bf16_f32 v79, v250, v251
  buffer_store_dwordx4 v[76:79], v4, s[12:15], s67 offen offset:0 sc1
  v_mul_f32 v244, 0xbfb8aa3b, v164
  v_mul_f32 v245, 0xbfb8aa3b, v165
  v_mul_f32 v246, 0xbfb8aa3b, v166
  v_mul_f32 v247, 0xbfb8aa3b, v167
  s_waitcnt lgkmcnt(4)
  v_mfma_f32_32x32x16_bf16 v[212:227], v[140:143], v[72:75], v[212:227]
  ds_read_b64_tr_b16 v[116:117], v2 offset:30848
  ds_read_b64_tr_b16 v[118:119], v2 offset:31616
  v_mul_f32 v248, 0xbfb8aa3b, v168
  v_mul_f32 v249, 0xbfb8aa3b, v169
  v_mul_f32 v250, 0xbfb8aa3b, v170
  v_mul_f32 v251, 0xbfb8aa3b, v171
  v_exp_f32 v244, v244
  v_exp_f32 v245, v245
  v_exp_f32 v246, v246
  s_waitcnt lgkmcnt(4)
  v_mfma_f32_32x32x16_bf16 v[228:243], v[144:147], v[72:75], v[228:243]
  ds_read_b64_tr_b16 v[120:121], v2 offset:30880
  ds_read_b64_tr_b16 v[122:123], v2 offset:31648
  v_exp_f32 v247, v247
  v_exp_f32 v248, v248
  v_exp_f32 v249, v249
  v_exp_f32 v250, v250
  v_exp_f32 v251, v251
  v_add_f32 v244, 1.0, v244
  v_add_f32 v245, 1.0, v245
  s_waitcnt lgkmcnt(4)
  v_mfma_f32_32x32x16_bf16 v[196:211], v[112:115], v[8:11], v[196:211]
  ds_read_b64_tr_b16 v[136:137], v2 offset:33888
  ds_read_b64_tr_b16 v[138:139], v2 offset:34656
  v_add_f32 v246, 1.0, v246
  v_add_f32 v247, 1.0, v247
  v_add_f32 v248, 1.0, v248
  v_add_f32 v249, 1.0, v249
  v_add_f32 v250, 1.0, v250
  v_add_f32 v251, 1.0, v251
  v_rcp_f32 v244, v244
  s_waitcnt lgkmcnt(4)
  v_mfma_f32_32x32x16_bf16 v[212:227], v[116:119], v[8:11], v[212:227]
  ds_read_b64_tr_b16 v[140:141], v2 offset:33920
  ds_read_b64_tr_b16 v[142:143], v2 offset:34688
  v_rcp_f32 v245, v245
  v_rcp_f32 v246, v246
  v_rcp_f32 v247, v247
  v_rcp_f32 v248, v248
  v_rcp_f32 v249, v249
  v_rcp_f32 v250, v250
  v_rcp_f32 v251, v251
  s_waitcnt lgkmcnt(4)
  v_mfma_f32_32x32x16_bf16 v[228:243], v[120:123], v[8:11], v[228:243]
  ds_read_b64_tr_b16 v[144:145], v2 offset:33952
  ds_read_b64_tr_b16 v[146:147], v2 offset:34720
  v_mul_f32 v244, v244, v172
  v_mul_f32 v245, v245, v173
  v_mul_f32 v246, v246, v174
  v_mul_f32 v247, v247, v175
  v_mul_f32 v248, v248, v176
  v_mul_f32 v249, v249, v177
  v_mul_f32 v250, v250, v178
  s_waitcnt lgkmcnt(4)
  v_mfma_f32_32x32x16_bf16 v[196:211], v[136:139], v[12:15], v[196:211]
  ds_read_b64_tr_b16 v[112:113], v2 offset:36960
  ds_read_b64_tr_b16 v[114:115], v2 offset:37728
  v_mul_f32 v251, v251, v179
  v_cvt_pk_bf16_f32 v252, v244, v245
  v_cvt_pk_bf16_f32 v253, v246, v247
  v_cvt_pk_bf16_f32 v254, v248, v249
  v_cvt_pk_bf16_f32 v255, v250, v251
  buffer_store_dwordx4 v[252:255], v4, s[12:15], s67 offen offset:512 sc1
  v_mul_f32 v244, 0xbfb8aa3b, v180
  s_waitcnt lgkmcnt(4)
  v_mfma_f32_32x32x16_bf16 v[212:227], v[140:143], v[12:15], v[212:227]
  ds_read_b64_tr_b16 v[116:117], v2 offset:36992
  ds_read_b64_tr_b16 v[118:119], v2 offset:37760
  v_mul_f32 v245, 0xbfb8aa3b, v181
  v_mul_f32 v246, 0xbfb8aa3b, v182
  v_mul_f32 v247, 0xbfb8aa3b, v183
  v_mul_f32 v248, 0xbfb8aa3b, v184
  v_mul_f32 v249, 0xbfb8aa3b, v185
  v_mul_f32 v250, 0xbfb8aa3b, v186
  v_mul_f32 v251, 0xbfb8aa3b, v187
  s_waitcnt lgkmcnt(4)
  v_mfma_f32_32x32x16_bf16 v[228:243], v[144:147], v[12:15], v[228:243]
  ds_read_b64_tr_b16 v[120:121], v2 offset:37024
  ds_read_b64_tr_b16 v[122:123], v2 offset:37792
  v_exp_f32 v244, v244
  v_exp_f32 v245, v245
  v_exp_f32 v246, v246
  v_exp_f32 v247, v247
  v_exp_f32 v248, v248
  v_exp_f32 v249, v249
  v_exp_f32 v250, v250
  s_waitcnt lgkmcnt(4)
  v_mfma_f32_32x32x16_bf16 v[196:211], v[112:115], v[16:19], v[196:211]
  ds_read_b64_tr_b16 v[136:137], v2 offset:40032
  ds_read_b64_tr_b16 v[138:139], v2 offset:40800
  v_exp_f32 v251, v251
  v_add_f32 v244, 1.0, v244
  v_add_f32 v245, 1.0, v245
  v_add_f32 v246, 1.0, v246
  v_add_f32 v247, 1.0, v247
  v_add_f32 v248, 1.0, v248
  v_add_f32 v249, 1.0, v249
  s_waitcnt lgkmcnt(4)
  v_mfma_f32_32x32x16_bf16 v[212:227], v[116:119], v[16:19], v[212:227]
  ds_read_b64_tr_b16 v[140:141], v2 offset:40064
  ds_read_b64_tr_b16 v[142:143], v2 offset:40832
  v_add_f32 v250, 1.0, v250
  v_add_f32 v251, 1.0, v251
  v_rcp_f32 v244, v244
  v_rcp_f32 v245, v245
  v_rcp_f32 v246, v246
  v_rcp_f32 v247, v247
  v_rcp_f32 v248, v248
  s_waitcnt lgkmcnt(4)
  v_mfma_f32_32x32x16_bf16 v[228:243], v[120:123], v[16:19], v[228:243]
  ds_read_b64_tr_b16 v[144:145], v2 offset:40096
  ds_read_b64_tr_b16 v[146:147], v2 offset:40864
  v_rcp_f32 v249, v249
  v_rcp_f32 v250, v250
  v_rcp_f32 v251, v251
  v_mul_f32 v244, v244, v188
  v_mul_f32 v245, v245, v189
  v_mul_f32 v246, v246, v190
  v_mul_f32 v247, v247, v191
  s_waitcnt lgkmcnt(4)
  v_mfma_f32_32x32x16_bf16 v[196:211], v[136:139], v[20:23], v[196:211]
  v_mul_f32 v248, v248, v192
  v_mul_f32 v249, v249, v193
  v_mul_f32 v250, v250, v194
  v_mul_f32 v251, v251, v195
  v_cvt_pk_bf16_f32 v76, v244, v245
  v_cvt_pk_bf16_f32 v77, v246, v247
  v_cvt_pk_bf16_f32 v78, v248, v249
  s_waitcnt lgkmcnt(2)
  v_mfma_f32_32x32x16_bf16 v[212:227], v[140:143], v[20:23], v[212:227]
  v_cvt_pk_bf16_f32 v79, v250, v251
  buffer_store_dwordx4 v[76:79], v4, s[12:15], s67 offen offset:1024 sc1
  s_waitcnt lgkmcnt(0)
  v_mfma_f32_32x32x16_bf16 v[228:243], v[144:147], v[20:23], v[228:243]
  s_waitcnt lgkmcnt(0)
  s_barrier
  v_mul_f32 v244, 0xbfb8aa3b, v196
  v_mul_f32 v245, 0xbfb8aa3b, v197
  v_mul_f32 v246, 0xbfb8aa3b, v198
  v_mul_f32 v247, 0xbfb8aa3b, v199
  v_mul_f32 v248, 0xbfb8aa3b, v200
  v_mul_f32 v249, 0xbfb8aa3b, v201
  v_mul_f32 v250, 0xbfb8aa3b, v202
  v_mul_f32 v251, 0xbfb8aa3b, v203
  v_exp_f32 v244, v244
  v_exp_f32 v245, v245
  v_exp_f32 v246, v246
  v_exp_f32 v247, v247
  v_exp_f32 v248, v248
  v_exp_f32 v249, v249
  v_exp_f32 v250, v250
  v_exp_f32 v251, v251
  v_add_f32 v244, 1.0, v244
  v_add_f32 v245, 1.0, v245
  v_add_f32 v246, 1.0, v246
  v_add_f32 v247, 1.0, v247
  v_add_f32 v248, 1.0, v248
  v_add_f32 v249, 1.0, v249
  v_add_f32 v250, 1.0, v250
  v_add_f32 v251, 1.0, v251
  v_rcp_f32 v244, v244
  v_rcp_f32 v245, v245
  v_rcp_f32 v246, v246
  v_rcp_f32 v247, v247
  v_rcp_f32 v248, v248
  v_rcp_f32 v249, v249
  v_rcp_f32 v250, v250
  v_rcp_f32 v251, v251
  v_mul_f32 v244, v244, v204
  v_mul_f32 v245, v245, v205
  v_mul_f32 v246, v246, v206
  v_mul_f32 v247, v247, v207
  v_mul_f32 v248, v248, v208
  v_mul_f32 v249, v249, v209
  v_mul_f32 v250, v250, v210
  v_mul_f32 v251, v251, v211
  v_cvt_pk_bf16_f32 v252, v244, v245
  v_cvt_pk_bf16_f32 v253, v246, v247
  v_cvt_pk_bf16_f32 v254, v248, v249
  v_cvt_pk_bf16_f32 v255, v250, v251
  buffer_store_dwordx4 v[252:255], v4, s[12:15], s67 offen offset:1536 sc1
  v_mul_f32 v244, 0xbfb8aa3b, v212
  v_mul_f32 v245, 0xbfb8aa3b, v213
  v_mul_f32 v246, 0xbfb8aa3b, v214
  v_mul_f32 v247, 0xbfb8aa3b, v215
  v_mul_f32 v248, 0xbfb8aa3b, v216
  v_mul_f32 v249, 0xbfb8aa3b, v217
  v_mul_f32 v250, 0xbfb8aa3b, v218
  v_mul_f32 v251, 0xbfb8aa3b, v219
  v_exp_f32 v244, v244
  v_exp_f32 v245, v245
  v_exp_f32 v246, v246
  v_exp_f32 v247, v247
  v_exp_f32 v248, v248
  v_exp_f32 v249, v249
  v_exp_f32 v250, v250
  v_exp_f32 v251, v251
  v_add_f32 v244, 1.0, v244
  v_add_f32 v245, 1.0, v245
  v_add_f32 v246, 1.0, v246
  v_add_f32 v247, 1.0, v247
  v_add_f32 v248, 1.0, v248
  v_add_f32 v249, 1.0, v249
  v_add_f32 v250, 1.0, v250
  v_add_f32 v251, 1.0, v251
  v_rcp_f32 v244, v244
  v_rcp_f32 v245, v245
  v_rcp_f32 v246, v246
  v_rcp_f32 v247, v247
  v_rcp_f32 v248, v248
  v_rcp_f32 v249, v249
  v_rcp_f32 v250, v250
  v_rcp_f32 v251, v251
  v_mul_f32 v244, v244, v220
  v_mul_f32 v245, v245, v221
  v_mul_f32 v246, v246, v222
  v_mul_f32 v247, v247, v223
  v_mul_f32 v248, v248, v224
  v_mul_f32 v249, v249, v225
  v_mul_f32 v250, v250, v226
  v_mul_f32 v251, v251, v227
  v_cvt_pk_bf16_f32 v76, v244, v245
  v_cvt_pk_bf16_f32 v77, v246, v247
  v_cvt_pk_bf16_f32 v78, v248, v249
  v_cvt_pk_bf16_f32 v79, v250, v251
  buffer_store_dwordx4 v[76:79], v4, s[12:15], s67 offen offset:2048 sc1
  v_mul_f32 v244, 0xbfb8aa3b, v228
  v_mul_f32 v245, 0xbfb8aa3b, v229
  v_mul_f32 v246, 0xbfb8aa3b, v230
  v_mul_f32 v247, 0xbfb8aa3b, v231
  v_mul_f32 v248, 0xbfb8aa3b, v232
  v_mul_f32 v249, 0xbfb8aa3b, v233
  v_mul_f32 v250, 0xbfb8aa3b, v234
  v_mul_f32 v251, 0xbfb8aa3b, v235
  v_exp_f32 v244, v244
  v_exp_f32 v245, v245
  v_exp_f32 v246, v246
  v_exp_f32 v247, v247
  v_exp_f32 v248, v248
  v_exp_f32 v249, v249
  v_exp_f32 v250, v250
  v_exp_f32 v251, v251
  v_add_f32 v244, 1.0, v244
  v_add_f32 v245, 1.0, v245
  v_add_f32 v246, 1.0, v246
  v_add_f32 v247, 1.0, v247
  v_add_f32 v248, 1.0, v248
  v_add_f32 v249, 1.0, v249
  v_add_f32 v250, 1.0, v250
  v_add_f32 v251, 1.0, v251
  v_rcp_f32 v244, v244
  v_rcp_f32 v245, v245
  v_rcp_f32 v246, v246
  v_rcp_f32 v247, v247
  v_rcp_f32 v248, v248
  v_rcp_f32 v249, v249
  v_rcp_f32 v250, v250
  v_rcp_f32 v251, v251
  v_mul_f32 v244, v244, v236
  v_mul_f32 v245, v245, v237
  v_mul_f32 v246, v246, v238
  v_mul_f32 v247, v247, v239
  v_mul_f32 v248, v248, v240
  v_mul_f32 v249, v249, v241
  v_mul_f32 v250, v250, v242
  v_mul_f32 v251, v251, v243
  v_cvt_pk_bf16_f32 v252, v244, v245
  v_cvt_pk_bf16_f32 v253, v246, v247
  v_cvt_pk_bf16_f32 v254, v248, v249
  v_cvt_pk_bf16_f32 v255, v250, v251
  buffer_store_dwordx4 v[252:255], v4, s[12:15], s67 offen offset:2560 sc1
  s_lshl_b32 s60, s54, 12
  s_lshl_b32 s61, s55, 4
  s_add_u32 s60, s60, s61
  s_lshl_b32 s61, s57, 2
  s_add_u32 s60, s60, s61
  s_add_u32 s60, s60, 67072
  v_mov_b32 v5, 0
  v_mov_b32 v6, s52
  s_mov_b64 exec, 1
  s_cmp_lg_u32 s59, 0
  s_waitcnt vmcnt(0)
  s_cbranch_scc1 L_sigslow_33
  buffer_store_dword v6, v5, s[12:15], s60 offen
L_sigdone_34:
  s_mov_b64 exec, -1
  v_lshrrev_b32 v3, 5, v1
  v_bfe_u32 v4, v1, 4, 1
  v_lshlrev_b32 v3, 4, v3
  v_lshl_add_u32 v3, v4, 2, v3
  v_bfe_u32 v4, v1, 2, 2
  v_add_u32 v3, v3, v4
  v_mul_u32_u24 v3, 0xa0, v3
  v_and_b32 v4, 3, v1
  v_lshl_add_u32 v3, v4, 3, v3
  s_and_b32 s60, s57, 1
  s_mul_i32 s60, s60, 0
  s_add_u32 s60, s60, 2048
  v_add_u32 v2, s60, v3
  v_add_u32 v3, 61440, v2
  s_mul_i32 s60, s54, 786432
  s_cmp_eq_u32 s59, 0
  s_cselect_b32 s61, 8912896, 0
  s_add_u32 s60, s60, s61
  s_add_u32 s60, s60, 8912896
  s_and_b32 s61, s77, 1
  s_mul_i32 s61, s61, 24576
  s_add_u32 s60, s60, s61
  s_lshr_b32 s65, s77, 1
  s_mul_i32 s65, s65, 3
  s_lshl_b32 s61, s65, 12
  s_add_u32 s60, s60, s61
  s_sub_u32 s65, 5, s65
  s_lshl_b32 s61, s77, 2
  s_add_u32 s62, s61, s57
  s_mul_i32 s66, s62, 49152
  s_add_u32 s66, s66, s60
  s_xor_b32 s62, s62, 4
  s_mul_i32 s67, s62, 49152
  s_add_u32 s67, s67, s60
  s_and_b32 s61, s77, 2
  s_lshl_b32 s61, s61, 7
  s_lshl_b32 s60, s54, 12
  s_add_u32 s60, s60, s61
  s_add_u32 s60, s60, 67072
  v_lshlrev_b32 v4, 2, v1
  s_mov_b32 s74, 0
L_poll_35:
  buffer_load_dword v5, v4, s[12:15], s60 offen sc1
  s_add_u32 s74, s74, 1
  s_cmp_gt_u32 s74, 131072
  s_cbranch_scc1 L_pdone_36
  s_waitcnt vmcnt(0)
  v_cmp_ne_u32 vcc, s52, v5
  s_nop 3
  s_cbranch_vccnz L_poll_35
L_pdone_36:
  s_waitcnt vmcnt(0)
  s_cmp_eq_u32 s59, 0
  s_cbranch_scc1 L_noacq_37
  buffer_inv sc1
  s_waitcnt vmcnt(0)
L_noacq_37:
  buffer_load_dwordx4 v[4:7], v0, s[12:15], s66 offen offset:0 sc1
  buffer_load_dwordx4 v[8:11], v0, s[12:15], s67 offen offset:0 sc1
  buffer_load_dwordx4 v[12:15], v0, s[12:15], s66 offen offset:1024 sc1
  buffer_load_dwordx4 v[16:19], v0, s[12:15], s67 offen offset:1024 sc1
  buffer_load_dwordx4 v[20:23], v0, s[12:15], s66 offen offset:2048 sc1
  buffer_load_dwordx4 v[24:27], v0, s[12:15], s67 offen offset:2048 sc1
  s_barrier
  ds_read_b64_tr_b16 v[108:109], v2 offset:0
  ds_read_b64_tr_b16 v[110:111], v2 offset:1280
  ds_read_b64_tr_b16 v[112:113], v2 offset:32
  ds_read_b64_tr_b16 v[114:115], v2 offset:1312
  ds_read_b64_tr_b16 v[116:117], v2 offset:64
  ds_read_b64_tr_b16 v[118:119], v2 offset:1344
  ds_read_b64_tr_b16 v[120:121], v2 offset:96
  ds_read_b64_tr_b16 v[122:123], v2 offset:1376
  ds_read_b64_tr_b16 v[124:125], v2 offset:128
  ds_read_b64_tr_b16 v[126:127], v2 offset:1408
  s_waitcnt vmcnt(5) lgkmcnt(8)
  v_mfma_f32_16x16x32_bf16 v[148:151], v[108:111], v[4:7], 0
  ds_read_b64_tr_b16 v[128:129], v2 offset:5120
  s_waitcnt vmcnt(4)
  v_mfma_f32_16x16x32_bf16 v[168:171], v[108:111], v[8:11], 0
  ds_read_b64_tr_b16 v[130:131], v2 offset:6400
  buffer_load_dwordx4 v[28:31], v0, s[12:15], s66 offen offset:3072 sc1
  s_waitcnt lgkmcnt(8)
  v_mfma_f32_16x16x32_bf16 v[152:155], v[112:115], v[4:7], 0
  ds_read_b64_tr_b16 v[132:133], v2 offset:5152
  v_mfma_f32_16x16x32_bf16 v[172:175], v[112:115], v[8:11], 0
  ds_read_b64_tr_b16 v[134:135], v2 offset:6432
  buffer_load_dwordx4 v[32:35], v0, s[12:15], s67 offen offset:3072 sc1
  s_cmp_eq_u32 s65, 0
  s_cselect_b32 s60, -5, 1
  s_lshl_b32 s60, s60, 12
  s_add_u32 s66, s66, s60
  s_add_u32 s67, s67, s60
  s_waitcnt lgkmcnt(8)
  v_mfma_f32_16x16x32_bf16 v[156:159], v[116:119], v[4:7], 0
  ds_read_b64_tr_b16 v[136:137], v2 offset:5184
  v_mfma_f32_16x16x32_bf16 v[176:179], v[116:119], v[8:11], 0
  ds_read_b64_tr_b16 v[138:139], v2 offset:6464
  buffer_load_dwordx4 v[36:39], v0, s[12:15], s66 offen offset:0 sc1
  s_waitcnt lgkmcnt(8)
  v_mfma_f32_16x16x32_bf16 v[160:163], v[120:123], v[4:7], 0
  ds_read_b64_tr_b16 v[140:141], v2 offset:5216
  v_mfma_f32_16x16x32_bf16 v[180:183], v[120:123], v[8:11], 0
  ds_read_b64_tr_b16 v[142:143], v2 offset:6496
  buffer_load_dwordx4 v[60:63], v0, s[12:15], s67 offen offset:0 sc1
  s_waitcnt lgkmcnt(8)
  v_mfma_f32_16x16x32_bf16 v[164:167], v[124:127], v[4:7], 0
  ds_read_b64_tr_b16 v[144:145], v2 offset:5248
  v_mfma_f32_16x16x32_bf16 v[184:187], v[124:127], v[8:11], 0
  ds_read_b64_tr_b16 v[146:147], v2 offset:6528
  s_waitcnt vmcnt(7) lgkmcnt(8)
  v_mfma_f32_16x16x32_bf16 v[148:151], v[128:131], v[12:15], v[148:151]
  ds_read_b64_tr_b16 v[108:109], v2 offset:10240
  s_waitcnt vmcnt(6)
  v_mfma_f32_16x16x32_bf16 v[168:171], v[128:131], v[16:19], v[168:171]
  ds_read_b64_tr_b16 v[110:111], v2 offset:11520
  buffer_load_dwordx4 v[64:67], v0, s[12:15], s66 offen offset:1024 sc1
  s_waitcnt lgkmcnt(8)
  v_mfma_f32_16x16x32_bf16 v[152:155], v[132:135], v[12:15], v[152:155]
  ds_read_b64_tr_b16 v[112:113], v2 offset:10272
  v_mfma_f32_16x16x32_bf16 v[172:175], v[132:135], v[16:19], v[172:175]
  ds_read_b64_tr_b16 v[114:115], v2 offset:11552
  buffer_load_dwordx4 v[68:71], v0, s[12:15], s67 offen offset:1024 sc1
  s_waitcnt lgkmcnt(8)
  v_mfma_f32_16x16x32_bf16 v[156:159], v[136:139], v[12:15], v[156:159]
  ds_read_b64_tr_b16 v[116:117], v2 offset:10304
  v_mfma_f32_16x16x32_bf16 v[176:179], v[136:139], v[16:19], v[176:179]
  ds_read_b64_tr_b16 v[118:119], v2 offset:11584
  buffer_load_dwordx4 v[72:75], v0, s[12:15], s66 offen offset:2048 sc1
  s_waitcnt lgkmcnt(8)
  v_mfma_f32_16x16x32_bf16 v[160:163], v[140:143], v[12:15], v[160:163]
  ds_read_b64_tr_b16 v[120:121], v2 offset:10336
  v_mfma_f32_16x16x32_bf16 v[180:183], v[140:143], v[16:19], v[180:183]
  ds_read_b64_tr_b16 v[122:123], v2 offset:11616
  buffer_load_dwordx4 v[76:79], v0, s[12:15], s67 offen offset:2048 sc1
  s_waitcnt lgkmcnt(8)
  v_mfma_f32_16x16x32_bf16 v[164:167], v[144:147], v[12:15], v[164:167]
  ds_read_b64_tr_b16 v[124:125], v2 offset:10368
  v_mfma_f32_16x16x32_bf16 v[184:187], v[144:147], v[16:19], v[184:187]
  ds_read_b64_tr_b16 v[126:127], v2 offset:11648
  s_waitcnt vmcnt(9) lgkmcnt(8)
  v_mfma_f32_16x16x32_bf16 v[148:151], v[108:111], v[20:23], v[148:151]
  ds_read_b64_tr_b16 v[128:129], v2 offset:15360
  s_waitcnt vmcnt(8)
  v_mfma_f32_16x16x32_bf16 v[168:171], v[108:111], v[24:27], v[168:171]
  ds_read_b64_tr_b16 v[130:131], v2 offset:16640
  buffer_load_dwordx4 v[100:103], v0, s[12:15], s66 offen offset:3072 sc1
  s_waitcnt lgkmcnt(8)
  v_mfma_f32_16x16x32_bf16 v[152:155], v[112:115], v[20:23], v[152:155]
  ds_read_b64_tr_b16 v[132:133], v2 offset:15392
  v_mfma_f32_16x16x32_bf16 v[172:175], v[112:115], v[24:27], v[172:175]
  ds_read_b64_tr_b16 v[134:135], v2 offset:16672
  buffer_load_dwordx4 v[104:107], v0, s[12:15], s67 offen offset:3072 sc1
  s_cmp_eq_u32 s65, 1
  s_cselect_b32 s60, -5, 1
  s_lshl_b32 s60, s60, 12
  s_add_u32 s66, s66, s60
  s_add_u32 s67, s67, s60
  s_waitcnt lgkmcnt(8)
  v_mfma_f32_16x16x32_bf16 v[156:159], v[116:119], v[20:23], v[156:159]
  ds_read_b64_tr_b16 v[136:137], v2 offset:15424
  v_mfma_f32_16x16x32_bf16 v[176:179], v[116:119], v[24:27], v[176:179]
  ds_read_b64_tr_b16 v[138:139], v2 offset:16704
  buffer_load_dwordx4 v[4:7], v0, s[12:15], s66 offen offset:0 sc1
  s_waitcnt lgkmcnt(8)
  v_mfma_f32_16x16x32_bf16 v[160:163], v[120:123], v[20:23], v[160:163]
  ds_read_b64_tr_b16 v[140:141], v2 offset:15456
  v_mfma_f32_16x16x32_bf16 v[180:183], v[120:123], v[24:27], v[180:183]
  ds_read_b64_tr_b16 v[142:143], v2 offset:16736
  buffer_load_dwordx4 v[8:11], v0, s[12:15], s67 offen offset:0 sc1
  s_waitcnt lgkmcnt(8)
  v_mfma_f32_16x16x32_bf16 v[164:167], v[124:127], v[20:23], v[164:167]
  ds_read_b64_tr_b16 v[144:145], v2 offset:15488
  v_mfma_f32_16x16x32_bf16 v[184:187], v[124:127], v[24:27], v[184:187]
  ds_read_b64_tr_b16 v[146:147], v2 offset:16768
  s_waitcnt vmcnt(11) lgkmcnt(8)
  v_mfma_f32_16x16x32_bf16 v[148:151], v[128:131], v[28:31], v[148:151]
  ds_read_b64_tr_b16 v[108:109], v2 offset:20480
  s_waitcnt vmcnt(10)
  v_mfma_f32_16x16x32_bf16 v[168:171], v[128:131], v[32:35], v[168:171]
  ds_read_b64_tr_b16 v[110:111], v2 offset:21760
  buffer_load_dwordx4 v[12:15], v0, s[12:15], s66 offen offset:1024 sc1
  s_waitcnt lgkmcnt(8)
  v_mfma_f32_16x16x32_bf16 v[152:155], v[132:135], v[28:31], v[152:155]
  ds_read_b64_tr_b16 v[112:113], v2 offset:20512
  v_mfma_f32_16x16x32_bf16 v[172:175], v[132:135], v[32:35], v[172:175]
  ds_read_b64_tr_b16 v[114:115], v2 offset:21792
  buffer_load_dwordx4 v[16:19], v0, s[12:15], s67 offen offset:1024 sc1
  s_waitcnt lgkmcnt(8)
  v_mfma_f32_16x16x32_bf16 v[156:159], v[136:139], v[28:31], v[156:159]
  ds_read_b64_tr_b16 v[116:117], v2 offset:20544
  v_mfma_f32_16x16x32_bf16 v[176:179], v[136:139], v[32:35], v[176:179]
  ds_read_b64_tr_b16 v[118:119], v2 offset:21824
  buffer_load_dwordx4 v[20:23], v0, s[12:15], s66 offen offset:2048 sc1
  s_waitcnt lgkmcnt(8)
  v_mfma_f32_16x16x32_bf16 v[160:163], v[140:143], v[28:31], v[160:163]
  ds_read_b64_tr_b16 v[120:121], v2 offset:20576
  v_mfma_f32_16x16x32_bf16 v[180:183], v[140:143], v[32:35], v[180:183]
  ds_read_b64_tr_b16 v[122:123], v2 offset:21856
  buffer_load_dwordx4 v[24:27], v0, s[12:15], s67 offen offset:2048 sc1
  s_waitcnt lgkmcnt(8)
  v_mfma_f32_16x16x32_bf16 v[164:167], v[144:147], v[28:31], v[164:167]
  ds_read_b64_tr_b16 v[124:125], v2 offset:20608
  v_mfma_f32_16x16x32_bf16 v[184:187], v[144:147], v[32:35], v[184:187]
  ds_read_b64_tr_b16 v[126:127], v2 offset:21888
  s_waitcnt vmcnt(13) lgkmcnt(8)
  v_mfma_f32_16x16x32_bf16 v[148:151], v[108:111], v[36:39], v[148:151]
  ds_read_b64_tr_b16 v[128:129], v2 offset:25600
  s_waitcnt vmcnt(12)
  v_mfma_f32_16x16x32_bf16 v[168:171], v[108:111], v[60:63], v[168:171]
  ds_read_b64_tr_b16 v[130:131], v2 offset:26880
  s_waitcnt lgkmcnt(8)
  v_mfma_f32_16x16x32_bf16 v[152:155], v[112:115], v[36:39], v[152:155]
  ds_read_b64_tr_b16 v[132:133], v2 offset:25632
  v_mfma_f32_16x16x32_bf16 v[172:175], v[112:115], v[60:63], v[172:175]
  ds_read_b64_tr_b16 v[134:135], v2 offset:26912
  buffer_load_dwordx4 v[28:31], v0, s[12:15], s66 offen offset:3072 sc1
  s_waitcnt lgkmcnt(8)
  v_mfma_f32_16x16x32_bf16 v[156:159], v[116:119], v[36:39], v[156:159]
  ds_read_b64_tr_b16 v[136:137], v2 offset:25664
  v_mfma_f32_16x16x32_bf16 v[176:179], v[116:119], v[60:63], v[176:179]
  ds_read_b64_tr_b16 v[138:139], v2 offset:26944
  s_waitcnt lgkmcnt(8)
  v_mfma_f32_16x16x32_bf16 v[160:163], v[120:123], v[36:39], v[160:163]
  ds_read_b64_tr_b16 v[140:141], v2 offset:25696
  v_mfma_f32_16x16x32_bf16 v[180:183], v[120:123], v[60:63], v[180:183]
  ds_read_b64_tr_b16 v[142:143], v2 offset:26976
  buffer_load_dwordx4 v[32:35], v0, s[12:15], s67 offen offset:3072 sc1
  s_cmp_eq_u32 s65, 2
  s_cselect_b32 s60, -5, 1
  s_lshl_b32 s60, s60, 12
  s_add_u32 s66, s66, s60
  s_add_u32 s67, s67, s60
  s_waitcnt lgkmcnt(8)
  v_mfma_f32_16x16x32_bf16 v[164:167], v[124:127], v[36:39], v[164:167]
  ds_read_b64_tr_b16 v[144:145], v2 offset:25728
  v_mfma_f32_16x16x32_bf16 v[184:187], v[124:127], v[60:63], v[184:187]
  ds_read_b64_tr_b16 v[146:147], v2 offset:27008
  s_waitcnt vmcnt(13) lgkmcnt(8)
  v_mfma_f32_16x16x32_bf16 v[148:151], v[128:131], v[64:67], v[148:151]
  ds_read_b64_tr_b16 v[108:109], v2 offset:30720
  s_waitcnt vmcnt(12)
  v_mfma_f32_16x16x32_bf16 v[168:171], v[128:131], v[68:71], v[168:171]
  ds_read_b64_tr_b16 v[110:111], v2 offset:32000
  s_waitcnt lgkmcnt(8)
  v_mfma_f32_16x16x32_bf16 v[152:155], v[132:135], v[64:67], v[152:155]
  ds_read_b64_tr_b16 v[112:113], v2 offset:30752
  v_mfma_f32_16x16x32_bf16 v[172:175], v[132:135], v[68:71], v[172:175]
  ds_read_b64_tr_b16 v[114:115], v2 offset:32032
  buffer_load_dwordx4 v[36:39], v0, s[12:15], s66 offen offset:0 sc1
  s_waitcnt lgkmcnt(8)
  v_mfma_f32_16x16x32_bf16 v[156:159], v[136:139], v[64:67], v[156:159]
  ds_read_b64_tr_b16 v[116:117], v2 offset:30784
  v_mfma_f32_16x16x32_bf16 v[176:179], v[136:139], v[68:71], v[176:179]
  ds_read_b64_tr_b16 v[118:119], v2 offset:32064
  s_waitcnt lgkmcnt(8)
  v_mfma_f32_16x16x32_bf16 v[160:163], v[140:143], v[64:67], v[160:163]
  ds_read_b64_tr_b16 v[120:121], v2 offset:30816
  v_mfma_f32_16x16x32_bf16 v[180:183], v[140:143], v[68:71], v[180:183]
  ds_read_b64_tr_b16 v[122:123], v2 offset:32096
  buffer_load_dwordx4 v[60:63], v0, s[12:15], s67 offen offset:0 sc1
  s_waitcnt lgkmcnt(8)
  v_mfma_f32_16x16x32_bf16 v[164:167], v[144:147], v[64:67], v[164:167]
  ds_read_b64_tr_b16 v[124:125], v2 offset:30848
  v_mfma_f32_16x16x32_bf16 v[184:187], v[144:147], v[68:71], v[184:187]
  ds_read_b64_tr_b16 v[126:127], v2 offset:32128
  s_waitcnt vmcnt(13) lgkmcnt(8)
  v_mfma_f32_16x16x32_bf16 v[148:151], v[108:111], v[72:75], v[148:151]
  ds_read_b64_tr_b16 v[128:129], v2 offset:35840
  s_waitcnt vmcnt(12)
  v_mfma_f32_16x16x32_bf16 v[168:171], v[108:111], v[76:79], v[168:171]
  ds_read_b64_tr_b16 v[130:131], v2 offset:37120
  s_waitcnt lgkmcnt(8)
  v_mfma_f32_16x16x32_bf16 v[152:155], v[112:115], v[72:75], v[152:155]
  ds_read_b64_tr_b16 v[132:133], v2 offset:35872
  v_mfma_f32_16x16x32_bf16 v[172:175], v[112:115], v[76:79], v[172:175]
  ds_read_b64_tr_b16 v[134:135], v2 offset:37152
  buffer_load_dwordx4 v[64:67], v0, s[12:15], s66 offen offset:1024 sc1
  s_waitcnt lgkmcnt(8)
  v_mfma_f32_16x16x32_bf16 v[156:159], v[116:119], v[72:75], v[156:159]
  ds_read_b64_tr_b16 v[136:137], v2 offset:35904
  v_mfma_f32_16x16x32_bf16 v[176:179], v[116:119], v[76:79], v[176:179]
  ds_read_b64_tr_b16 v[138:139], v2 offset:37184
  s_waitcnt lgkmcnt(8)
  v_mfma_f32_16x16x32_bf16 v[160:163], v[120:123], v[72:75], v[160:163]
  ds_read_b64_tr_b16 v[140:141], v2 offset:35936
  v_mfma_f32_16x16x32_bf16 v[180:183], v[120:123], v[76:79], v[180:183]
  ds_read_b64_tr_b16 v[142:143], v2 offset:37216
  buffer_load_dwordx4 v[68:71], v0, s[12:15], s67 offen offset:1024 sc1
  s_waitcnt lgkmcnt(8)
  v_mfma_f32_16x16x32_bf16 v[164:167], v[124:127], v[72:75], v[164:167]
  ds_read_b64_tr_b16 v[144:145], v2 offset:35968
  v_mfma_f32_16x16x32_bf16 v[184:187], v[124:127], v[76:79], v[184:187]
  ds_read_b64_tr_b16 v[146:147], v2 offset:37248
  s_barrier
  s_waitcnt vmcnt(13) lgkmcnt(8)
  v_mfma_f32_16x16x32_bf16 v[148:151], v[128:131], v[100:103], v[148:151]
  ds_read_b64_tr_b16 v[108:109], v2 offset:40960
  s_waitcnt vmcnt(12)
  v_mfma_f32_16x16x32_bf16 v[168:171], v[128:131], v[104:107], v[168:171]
  ds_read_b64_tr_b16 v[110:111], v2 offset:42240
  s_waitcnt lgkmcnt(8)
  v_mfma_f32_16x16x32_bf16 v[152:155], v[132:135], v[100:103], v[152:155]
  ds_read_b64_tr_b16 v[112:113], v2 offset:40992
  v_mfma_f32_16x16x32_bf16 v[172:175], v[132:135], v[104:107], v[172:175]
  ds_read_b64_tr_b16 v[114:115], v2 offset:42272
  buffer_load_dwordx4 v[72:75], v0, s[12:15], s66 offen offset:2048 sc1
  s_waitcnt lgkmcnt(8)
  v_mfma_f32_16x16x32_bf16 v[156:159], v[136:139], v[100:103], v[156:159]
  ds_read_b64_tr_b16 v[116:117], v2 offset:41024
  v_mfma_f32_16x16x32_bf16 v[176:179], v[136:139], v[104:107], v[176:179]
  ds_read_b64_tr_b16 v[118:119], v2 offset:42304
  s_waitcnt lgkmcnt(8)
  v_mfma_f32_16x16x32_bf16 v[160:163], v[140:143], v[100:103], v[160:163]
  ds_read_b64_tr_b16 v[120:121], v2 offset:41056
  v_mfma_f32_16x16x32_bf16 v[180:183], v[140:143], v[104:107], v[180:183]
  ds_read_b64_tr_b16 v[122:123], v2 offset:42336
  buffer_load_dwordx4 v[76:79], v0, s[12:15], s67 offen offset:2048 sc1
  s_waitcnt lgkmcnt(8)
  v_mfma_f32_16x16x32_bf16 v[164:167], v[144:147], v[100:103], v[164:167]
  ds_read_b64_tr_b16 v[124:125], v2 offset:41088
  v_mfma_f32_16x16x32_bf16 v[184:187], v[144:147], v[104:107], v[184:187]
  ds_read_b64_tr_b16 v[126:127], v2 offset:42368
  s_waitcnt vmcnt(13) lgkmcnt(8)
  v_mfma_f32_16x16x32_bf16 v[148:151], v[108:111], v[4:7], v[148:151]
  ds_read_b64_tr_b16 v[128:129], v2 offset:46080
  s_waitcnt vmcnt(12)
  v_mfma_f32_16x16x32_bf16 v[168:171], v[108:111], v[8:11], v[168:171]
  ds_read_b64_tr_b16 v[130:131], v2 offset:47360
  s_waitcnt lgkmcnt(8)
  v_mfma_f32_16x16x32_bf16 v[152:155], v[112:115], v[4:7], v[152:155]
  ds_read_b64_tr_b16 v[132:133], v2 offset:46112
  v_mfma_f32_16x16x32_bf16 v[172:175], v[112:115], v[8:11], v[172:175]
  ds_read_b64_tr_b16 v[134:135], v2 offset:47392
  buffer_load_dwordx4 v[100:103], v0, s[12:15], s66 offen offset:3072 sc1
  s_waitcnt lgkmcnt(8)
  v_mfma_f32_16x16x32_bf16 v[156:159], v[116:119], v[4:7], v[156:159]
  ds_read_b64_tr_b16 v[136:137], v2 offset:46144
  v_mfma_f32_16x16x32_bf16 v[176:179], v[116:119], v[8:11], v[176:179]
  ds_read_b64_tr_b16 v[138:139], v2 offset:47424
  s_waitcnt lgkmcnt(8)
  v_mfma_f32_16x16x32_bf16 v[160:163], v[120:123], v[4:7], v[160:163]
  ds_read_b64_tr_b16 v[140:141], v2 offset:46176
  v_mfma_f32_16x16x32_bf16 v[180:183], v[120:123], v[8:11], v[180:183]
  ds_read_b64_tr_b16 v[142:143], v2 offset:47456
  buffer_load_dwordx4 v[104:107], v0, s[12:15], s67 offen offset:3072 sc1
  s_cmp_eq_u32 s65, 3
  s_cselect_b32 s60, -5, 1
  s_lshl_b32 s60, s60, 12
  s_add_u32 s66, s66, s60
  s_add_u32 s67, s67, s60
  s_waitcnt lgkmcnt(8)
  v_mfma_f32_16x16x32_bf16 v[164:167], v[124:127], v[4:7], v[164:167]
  ds_read_b64_tr_b16 v[144:145], v2 offset:46208
  v_mfma_f32_16x16x32_bf16 v[184:187], v[124:127], v[8:11], v[184:187]
  ds_read_b64_tr_b16 v[146:147], v2 offset:47488
  s_waitcnt vmcnt(13) lgkmcnt(8)
  v_mfma_f32_16x16x32_bf16 v[148:151], v[128:131], v[12:15], v[148:151]
  ds_read_b64_tr_b16 v[108:109], v2 offset:51200
  s_waitcnt vmcnt(12)
  v_mfma_f32_16x16x32_bf16 v[168:171], v[128:131], v[16:19], v[168:171]
  ds_read_b64_tr_b16 v[110:111], v2 offset:52480
  s_waitcnt lgkmcnt(8)
  v_mfma_f32_16x16x32_bf16 v[152:155], v[132:135], v[12:15], v[152:155]
  ds_read_b64_tr_b16 v[112:113], v2 offset:51232
  v_mfma_f32_16x16x32_bf16 v[172:175], v[132:135], v[16:19], v[172:175]
  ds_read_b64_tr_b16 v[114:115], v2 offset:52512
  buffer_load_dwordx4 v[4:7], v0, s[12:15], s66 offen offset:0 sc1
  s_waitcnt lgkmcnt(8)
  v_mfma_f32_16x16x32_bf16 v[156:159], v[136:139], v[12:15], v[156:159]
  ds_read_b64_tr_b16 v[116:117], v2 offset:51264
  v_mfma_f32_16x16x32_bf16 v[176:179], v[136:139], v[16:19], v[176:179]
  ds_read_b64_tr_b16 v[118:119], v2 offset:52544
  s_waitcnt lgkmcnt(8)
  v_mfma_f32_16x16x32_bf16 v[160:163], v[140:143], v[12:15], v[160:163]
  ds_read_b64_tr_b16 v[120:121], v2 offset:51296
  v_mfma_f32_16x16x32_bf16 v[180:183], v[140:143], v[16:19], v[180:183]
  ds_read_b64_tr_b16 v[122:123], v2 offset:52576
  buffer_load_dwordx4 v[8:11], v0, s[12:15], s67 offen offset:0 sc1
  s_waitcnt lgkmcnt(8)
  v_mfma_f32_16x16x32_bf16 v[164:167], v[144:147], v[12:15], v[164:167]
  ds_read_b64_tr_b16 v[124:125], v2 offset:51328
  v_mfma_f32_16x16x32_bf16 v[184:187], v[144:147], v[16:19], v[184:187]
  ds_read_b64_tr_b16 v[126:127], v2 offset:52608
  s_waitcnt vmcnt(13) lgkmcnt(8)
  v_mfma_f32_16x16x32_bf16 v[148:151], v[108:111], v[20:23], v[148:151]
  ds_read_b64_tr_b16 v[128:129], v2 offset:56320
  s_waitcnt vmcnt(12)
  v_mfma_f32_16x16x32_bf16 v[168:171], v[108:111], v[24:27], v[168:171]
  ds_read_b64_tr_b16 v[130:131], v2 offset:57600
  s_waitcnt lgkmcnt(8)
  v_mfma_f32_16x16x32_bf16 v[152:155], v[112:115], v[20:23], v[152:155]
  ds_read_b64_tr_b16 v[132:133], v2 offset:56352
  v_mfma_f32_16x16x32_bf16 v[172:175], v[112:115], v[24:27], v[172:175]
  ds_read_b64_tr_b16 v[134:135], v2 offset:57632
  buffer_load_dwordx4 v[12:15], v0, s[12:15], s66 offen offset:1024 sc1
  s_waitcnt lgkmcnt(8)
  v_mfma_f32_16x16x32_bf16 v[156:159], v[116:119], v[20:23], v[156:159]
  ds_read_b64_tr_b16 v[136:137], v2 offset:56384
  v_mfma_f32_16x16x32_bf16 v[176:179], v[116:119], v[24:27], v[176:179]
  ds_read_b64_tr_b16 v[138:139], v2 offset:57664
  s_waitcnt lgkmcnt(8)
  v_mfma_f32_16x16x32_bf16 v[160:163], v[120:123], v[20:23], v[160:163]
  ds_read_b64_tr_b16 v[140:141], v2 offset:56416
  v_mfma_f32_16x16x32_bf16 v[180:183], v[120:123], v[24:27], v[180:183]
  ds_read_b64_tr_b16 v[142:143], v2 offset:57696
  buffer_load_dwordx4 v[16:19], v0, s[12:15], s67 offen offset:1024 sc1
  s_waitcnt lgkmcnt(8)
  v_mfma_f32_16x16x32_bf16 v[164:167], v[124:127], v[20:23], v[164:167]
  ds_read_b64_tr_b16 v[144:145], v2 offset:56448
  v_mfma_f32_16x16x32_bf16 v[184:187], v[124:127], v[24:27], v[184:187]
  ds_read_b64_tr_b16 v[146:147], v2 offset:57728
  s_waitcnt vmcnt(13) lgkmcnt(8)
  v_mfma_f32_16x16x32_bf16 v[148:151], v[128:131], v[28:31], v[148:151]
  ds_read_b64_tr_b16 v[108:109], v3 offset:0
  s_waitcnt vmcnt(12)
  v_mfma_f32_16x16x32_bf16 v[168:171], v[128:131], v[32:35], v[168:171]
  ds_read_b64_tr_b16 v[110:111], v3 offset:1280
  s_waitcnt lgkmcnt(8)
  v_mfma_f32_16x16x32_bf16 v[152:155], v[132:135], v[28:31], v[152:155]
  ds_read_b64_tr_b16 v[112:113], v3 offset:32
  v_mfma_f32_16x16x32_bf16 v[172:175], v[132:135], v[32:35], v[172:175]
  ds_read_b64_tr_b16 v[114:115], v3 offset:1312
  buffer_load_dwordx4 v[20:23], v0, s[12:15], s66 offen offset:2048 sc1
  s_waitcnt lgkmcnt(8)
  v_mfma_f32_16x16x32_bf16 v[156:159], v[136:139], v[28:31], v[156:159]
  ds_read_b64_tr_b16 v[116:117], v3 offset:64
  v_mfma_f32_16x16x32_bf16 v[176:179], v[136:139], v[32:35], v[176:179]
  ds_read_b64_tr_b16 v[118:119], v3 offset:1344
  s_waitcnt lgkmcnt(8)
  v_mfma_f32_16x16x32_bf16 v[160:163], v[140:143], v[28:31], v[160:163]
  ds_read_b64_tr_b16 v[120:121], v3 offset:96
  v_mfma_f32_16x16x32_bf16 v[180:183], v[140:143], v[32:35], v[180:183]
  ds_read_b64_tr_b16 v[122:123], v3 offset:1376
  buffer_load_dwordx4 v[24:27], v0, s[12:15], s67 offen offset:2048 sc1
  s_waitcnt lgkmcnt(8)
  v_mfma_f32_16x16x32_bf16 v[164:167], v[144:147], v[28:31], v[164:167]
  ds_read_b64_tr_b16 v[124:125], v3 offset:128
  v_mfma_f32_16x16x32_bf16 v[184:187], v[144:147], v[32:35], v[184:187]
  ds_read_b64_tr_b16 v[126:127], v3 offset:1408
  s_waitcnt vmcnt(13) lgkmcnt(8)
  v_mfma_f32_16x16x32_bf16 v[148:151], v[108:111], v[36:39], v[148:151]
  ds_read_b64_tr_b16 v[128:129], v3 offset:5120
  s_waitcnt vmcnt(12)
  v_mfma_f32_16x16x32_bf16 v[168:171], v[108:111], v[60:63], v[168:171]
  ds_read_b64_tr_b16 v[130:131], v3 offset:6400
  s_waitcnt lgkmcnt(8)
  v_mfma_f32_16x16x32_bf16 v[152:155], v[112:115], v[36:39], v[152:155]
  ds_read_b64_tr_b16 v[132:133], v3 offset:5152
  v_mfma_f32_16x16x32_bf16 v[172:175], v[112:115], v[60:63], v[172:175]
  ds_read_b64_tr_b16 v[134:135], v3 offset:6432
  buffer_load_dwordx4 v[28:31], v0, s[12:15], s66 offen offset:3072 sc1
  s_waitcnt lgkmcnt(8)
  v_mfma_f32_16x16x32_bf16 v[156:159], v[116:119], v[36:39], v[156:159]
  ds_read_b64_tr_b16 v[136:137], v3 offset:5184
  v_mfma_f32_16x16x32_bf16 v[176:179], v[116:119], v[60:63], v[176:179]
  ds_read_b64_tr_b16 v[138:139], v3 offset:6464
  s_waitcnt lgkmcnt(8)
  v_mfma_f32_16x16x32_bf16 v[160:163], v[120:123], v[36:39], v[160:163]
  ds_read_b64_tr_b16 v[140:141], v3 offset:5216
  v_mfma_f32_16x16x32_bf16 v[180:183], v[120:123], v[60:63], v[180:183]
  ds_read_b64_tr_b16 v[142:143], v3 offset:6496
  buffer_load_dwordx4 v[32:35], v0, s[12:15], s67 offen offset:3072 sc1
  s_cmp_eq_u32 s65, 4
  s_cselect_b32 s60, -5, 1
  s_lshl_b32 s60, s60, 12
  s_add_u32 s66, s66, s60
  s_add_u32 s67, s67, s60
  s_waitcnt lgkmcnt(8)
  v_mfma_f32_16x16x32_bf16 v[164:167], v[124:127], v[36:39], v[164:167]
  ds_read_b64_tr_b16 v[144:145], v3 offset:5248
  v_mfma_f32_16x16x32_bf16 v[184:187], v[124:127], v[60:63], v[184:187]
  ds_read_b64_tr_b16 v[146:147], v3 offset:6528
  s_waitcnt vmcnt(13) lgkmcnt(8)
  v_mfma_f32_16x16x32_bf16 v[148:151], v[128:131], v[64:67], v[148:151]
  ds_read_b64_tr_b16 v[108:109], v3 offset:10240
  s_waitcnt vmcnt(12)
  v_mfma_f32_16x16x32_bf16 v[168:171], v[128:131], v[68:71], v[168:171]
  ds_read_b64_tr_b16 v[110:111], v3 offset:11520
  s_waitcnt lgkmcnt(8)
  v_mfma_f32_16x16x32_bf16 v[152:155], v[132:135], v[64:67], v[152:155]
  ds_read_b64_tr_b16 v[112:113], v3 offset:10272
  v_mfma_f32_16x16x32_bf16 v[172:175], v[132:135], v[68:71], v[172:175]
  ds_read_b64_tr_b16 v[114:115], v3 offset:11552
  buffer_load_dwordx4 v[36:39], v0, s[12:15], s66 offen offset:0 sc1
  s_waitcnt lgkmcnt(8)
  v_mfma_f32_16x16x32_bf16 v[156:159], v[136:139], v[64:67], v[156:159]
  ds_read_b64_tr_b16 v[116:117], v3 offset:10304
  v_mfma_f32_16x16x32_bf16 v[176:179], v[136:139], v[68:71], v[176:179]
  ds_read_b64_tr_b16 v[118:119], v3 offset:11584
  s_waitcnt lgkmcnt(8)
  v_mfma_f32_16x16x32_bf16 v[160:163], v[140:143], v[64:67], v[160:163]
  ds_read_b64_tr_b16 v[120:121], v3 offset:10336
  v_mfma_f32_16x16x32_bf16 v[180:183], v[140:143], v[68:71], v[180:183]
  ds_read_b64_tr_b16 v[122:123], v3 offset:11616
  buffer_load_dwordx4 v[60:63], v0, s[12:15], s67 offen offset:0 sc1
  s_waitcnt lgkmcnt(8)
  v_mfma_f32_16x16x32_bf16 v[164:167], v[144:147], v[64:67], v[164:167]
  ds_read_b64_tr_b16 v[124:125], v3 offset:10368
  v_mfma_f32_16x16x32_bf16 v[184:187], v[144:147], v[68:71], v[184:187]
  ds_read_b64_tr_b16 v[126:127], v3 offset:11648
  s_waitcnt vmcnt(13) lgkmcnt(8)
  v_mfma_f32_16x16x32_bf16 v[148:151], v[108:111], v[72:75], v[148:151]
  ds_read_b64_tr_b16 v[128:129], v3 offset:15360
  s_waitcnt vmcnt(12)
  v_mfma_f32_16x16x32_bf16 v[168:171], v[108:111], v[76:79], v[168:171]
  ds_read_b64_tr_b16 v[130:131], v3 offset:16640
  s_waitcnt lgkmcnt(8)
  v_mfma_f32_16x16x32_bf16 v[152:155], v[112:115], v[72:75], v[152:155]
  ds_read_b64_tr_b16 v[132:133], v3 offset:15392
  v_mfma_f32_16x16x32_bf16 v[172:175], v[112:115], v[76:79], v[172:175]
  ds_read_b64_tr_b16 v[134:135], v3 offset:16672
  buffer_load_dwordx4 v[64:67], v0, s[12:15], s66 offen offset:1024 sc1
  s_waitcnt lgkmcnt(8)
  v_mfma_f32_16x16x32_bf16 v[156:159], v[116:119], v[72:75], v[156:159]
  ds_read_b64_tr_b16 v[136:137], v3 offset:15424
  v_mfma_f32_16x16x32_bf16 v[176:179], v[116:119], v[76:79], v[176:179]
  ds_read_b64_tr_b16 v[138:139], v3 offset:16704
  s_waitcnt lgkmcnt(8)
  v_mfma_f32_16x16x32_bf16 v[160:163], v[120:123], v[72:75], v[160:163]
  ds_read_b64_tr_b16 v[140:141], v3 offset:15456
  v_mfma_f32_16x16x32_bf16 v[180:183], v[120:123], v[76:79], v[180:183]
  ds_read_b64_tr_b16 v[142:143], v3 offset:16736
  buffer_load_dwordx4 v[68:71], v0, s[12:15], s67 offen offset:1024 sc1
  s_waitcnt lgkmcnt(8)
  v_mfma_f32_16x16x32_bf16 v[164:167], v[124:127], v[72:75], v[164:167]
  ds_read_b64_tr_b16 v[144:145], v3 offset:15488
  v_mfma_f32_16x16x32_bf16 v[184:187], v[124:127], v[76:79], v[184:187]
  ds_read_b64_tr_b16 v[146:147], v3 offset:16768
  s_barrier
  s_waitcnt vmcnt(13) lgkmcnt(8)
  v_mfma_f32_16x16x32_bf16 v[148:151], v[128:131], v[100:103], v[148:151]
  ds_read_b64_tr_b16 v[108:109], v3 offset:20480
  s_waitcnt vmcnt(12)
  v_mfma_f32_16x16x32_bf16 v[168:171], v[128:131], v[104:107], v[168:171]
  ds_read_b64_tr_b16 v[110:111], v3 offset:21760
  s_waitcnt lgkmcnt(8)
  v_mfma_f32_16x16x32_bf16 v[152:155], v[132:135], v[100:103], v[152:155]
  ds_read_b64_tr_b16 v[112:113], v3 offset:20512
  v_mfma_f32_16x16x32_bf16 v[172:175], v[132:135], v[104:107], v[172:175]
  ds_read_b64_tr_b16 v[114:115], v3 offset:21792
  buffer_load_dwordx4 v[72:75], v0, s[12:15], s66 offen offset:2048 sc1
  s_waitcnt lgkmcnt(8)
  v_mfma_f32_16x16x32_bf16 v[156:159], v[136:139], v[100:103], v[156:159]
  ds_read_b64_tr_b16 v[116:117], v3 offset:20544
  v_mfma_f32_16x16x32_bf16 v[176:179], v[136:139], v[104:107], v[176:179]
  ds_read_b64_tr_b16 v[118:119], v3 offset:21824
  s_waitcnt lgkmcnt(8)
  v_mfma_f32_16x16x32_bf16 v[160:163], v[140:143], v[100:103], v[160:163]
  ds_read_b64_tr_b16 v[120:121], v3 offset:20576
  v_mfma_f32_16x16x32_bf16 v[180:183], v[140:143], v[104:107], v[180:183]
  ds_read_b64_tr_b16 v[122:123], v3 offset:21856
  buffer_load_dwordx4 v[76:79], v0, s[12:15], s67 offen offset:2048 sc1
  s_waitcnt lgkmcnt(8)
  v_mfma_f32_16x16x32_bf16 v[164:167], v[144:147], v[100:103], v[164:167]
  ds_read_b64_tr_b16 v[124:125], v3 offset:20608
  v_mfma_f32_16x16x32_bf16 v[184:187], v[144:147], v[104:107], v[184:187]
  ds_read_b64_tr_b16 v[126:127], v3 offset:21888
  s_waitcnt vmcnt(13) lgkmcnt(8)
  v_mfma_f32_16x16x32_bf16 v[148:151], v[108:111], v[4:7], v[148:151]
  ds_read_b64_tr_b16 v[128:129], v3 offset:25600
  s_waitcnt vmcnt(12)
  v_mfma_f32_16x16x32_bf16 v[168:171], v[108:111], v[8:11], v[168:171]
  ds_read_b64_tr_b16 v[130:131], v3 offset:26880
  s_waitcnt lgkmcnt(8)
  v_mfma_f32_16x16x32_bf16 v[152:155], v[112:115], v[4:7], v[152:155]
  ds_read_b64_tr_b16 v[132:133], v3 offset:25632
  v_mfma_f32_16x16x32_bf16 v[172:175], v[112:115], v[8:11], v[172:175]
  ds_read_b64_tr_b16 v[134:135], v3 offset:26912
  buffer_load_dwordx4 v[100:103], v0, s[12:15], s66 offen offset:3072 sc1
  s_waitcnt lgkmcnt(8)
  v_mfma_f32_16x16x32_bf16 v[156:159], v[116:119], v[4:7], v[156:159]
  ds_read_b64_tr_b16 v[136:137], v3 offset:25664
  v_mfma_f32_16x16x32_bf16 v[176:179], v[116:119], v[8:11], v[176:179]
  ds_read_b64_tr_b16 v[138:139], v3 offset:26944
  s_waitcnt lgkmcnt(8)
  v_mfma_f32_16x16x32_bf16 v[160:163], v[120:123], v[4:7], v[160:163]
  ds_read_b64_tr_b16 v[140:141], v3 offset:25696
  v_mfma_f32_16x16x32_bf16 v[180:183], v[120:123], v[8:11], v[180:183]
  ds_read_b64_tr_b16 v[142:143], v3 offset:26976
  buffer_load_dwordx4 v[104:107], v0, s[12:15], s67 offen offset:3072 sc1
  s_waitcnt lgkmcnt(8)
  v_mfma_f32_16x16x32_bf16 v[164:167], v[124:127], v[4:7], v[164:167]
  ds_read_b64_tr_b16 v[144:145], v3 offset:25728
  v_mfma_f32_16x16x32_bf16 v[184:187], v[124:127], v[8:11], v[184:187]
  ds_read_b64_tr_b16 v[146:147], v3 offset:27008
  s_waitcnt vmcnt(13) lgkmcnt(8)
  v_mfma_f32_16x16x32_bf16 v[148:151], v[128:131], v[12:15], v[148:151]
  ds_read_b64_tr_b16 v[108:109], v3 offset:30720
  s_waitcnt vmcnt(12)
  v_mfma_f32_16x16x32_bf16 v[168:171], v[128:131], v[16:19], v[168:171]
  ds_read_b64_tr_b16 v[110:111], v3 offset:32000
  s_waitcnt lgkmcnt(8)
  v_mfma_f32_16x16x32_bf16 v[152:155], v[132:135], v[12:15], v[152:155]
  ds_read_b64_tr_b16 v[112:113], v3 offset:30752
  v_mfma_f32_16x16x32_bf16 v[172:175], v[132:135], v[16:19], v[172:175]
  ds_read_b64_tr_b16 v[114:115], v3 offset:32032
  s_waitcnt lgkmcnt(8)
  v_mfma_f32_16x16x32_bf16 v[156:159], v[136:139], v[12:15], v[156:159]
  ds_read_b64_tr_b16 v[116:117], v3 offset:30784
  v_mfma_f32_16x16x32_bf16 v[176:179], v[136:139], v[16:19], v[176:179]
  ds_read_b64_tr_b16 v[118:119], v3 offset:32064
  s_waitcnt lgkmcnt(8)
  v_mfma_f32_16x16x32_bf16 v[160:163], v[140:143], v[12:15], v[160:163]
  ds_read_b64_tr_b16 v[120:121], v3 offset:30816
  v_mfma_f32_16x16x32_bf16 v[180:183], v[140:143], v[16:19], v[180:183]
  ds_read_b64_tr_b16 v[122:123], v3 offset:32096
  s_waitcnt lgkmcnt(8)
  v_mfma_f32_16x16x32_bf16 v[164:167], v[144:147], v[12:15], v[164:167]
  ds_read_b64_tr_b16 v[124:125], v3 offset:30848
  v_mfma_f32_16x16x32_bf16 v[184:187], v[144:147], v[16:19], v[184:187]
  ds_read_b64_tr_b16 v[126:127], v3 offset:32128
  s_waitcnt vmcnt(11) lgkmcnt(8)
  v_mfma_f32_16x16x32_bf16 v[148:151], v[108:111], v[20:23], v[148:151]
  ds_read_b64_tr_b16 v[128:129], v3 offset:35840
  s_waitcnt vmcnt(10)
  v_mfma_f32_16x16x32_bf16 v[168:171], v[108:111], v[24:27], v[168:171]
  ds_read_b64_tr_b16 v[130:131], v3 offset:37120
  s_waitcnt lgkmcnt(8)
  v_mfma_f32_16x16x32_bf16 v[152:155], v[112:115], v[20:23], v[152:155]
  ds_read_b64_tr_b16 v[132:133], v3 offset:35872
  v_mfma_f32_16x16x32_bf16 v[172:175], v[112:115], v[24:27], v[172:175]
  ds_read_b64_tr_b16 v[134:135], v3 offset:37152
  s_waitcnt lgkmcnt(8)
  v_mfma_f32_16x16x32_bf16 v[156:159], v[116:119], v[20:23], v[156:159]
  ds_read_b64_tr_b16 v[136:137], v3 offset:35904
  v_mfma_f32_16x16x32_bf16 v[176:179], v[116:119], v[24:27], v[176:179]
  ds_read_b64_tr_b16 v[138:139], v3 offset:37184
  s_waitcnt lgkmcnt(8)
  v_mfma_f32_16x16x32_bf16 v[160:163], v[120:123], v[20:23], v[160:163]
  ds_read_b64_tr_b16 v[140:141], v3 offset:35936
  v_mfma_f32_16x16x32_bf16 v[180:183], v[120:123], v[24:27], v[180:183]
  ds_read_b64_tr_b16 v[142:143], v3 offset:37216
  s_waitcnt lgkmcnt(8)
  v_mfma_f32_16x16x32_bf16 v[164:167], v[124:127], v[20:23], v[164:167]
  ds_read_b64_tr_b16 v[144:145], v3 offset:35968
  v_mfma_f32_16x16x32_bf16 v[184:187], v[124:127], v[24:27], v[184:187]
  ds_read_b64_tr_b16 v[146:147], v3 offset:37248
  s_waitcnt vmcnt(9) lgkmcnt(8)
  v_mfma_f32_16x16x32_bf16 v[148:151], v[128:131], v[28:31], v[148:151]
  ds_read_b64_tr_b16 v[108:109], v3 offset:40960
  s_waitcnt vmcnt(8)
  v_mfma_f32_16x16x32_bf16 v[168:171], v[128:131], v[32:35], v[168:171]
  ds_read_b64_tr_b16 v[110:111], v3 offset:42240
  s_waitcnt lgkmcnt(8)
  v_mfma_f32_16x16x32_bf16 v[152:155], v[132:135], v[28:31], v[152:155]
  ds_read_b64_tr_b16 v[112:113], v3 offset:40992
  v_mfma_f32_16x16x32_bf16 v[172:175], v[132:135], v[32:35], v[172:175]
  ds_read_b64_tr_b16 v[114:115], v3 offset:42272
  s_waitcnt lgkmcnt(8)
  v_mfma_f32_16x16x32_bf16 v[156:159], v[136:139], v[28:31], v[156:159]
  ds_read_b64_tr_b16 v[116:117], v3 offset:41024
  v_mfma_f32_16x16x32_bf16 v[176:179], v[136:139], v[32:35], v[176:179]
  ds_read_b64_tr_b16 v[118:119], v3 offset:42304
  s_waitcnt lgkmcnt(8)
  v_mfma_f32_16x16x32_bf16 v[160:163], v[140:143], v[28:31], v[160:163]
  ds_read_b64_tr_b16 v[120:121], v3 offset:41056
  v_mfma_f32_16x16x32_bf16 v[180:183], v[140:143], v[32:35], v[180:183]
  ds_read_b64_tr_b16 v[122:123], v3 offset:42336
  s_waitcnt lgkmcnt(8)
  v_mfma_f32_16x16x32_bf16 v[164:167], v[144:147], v[28:31], v[164:167]
  ds_read_b64_tr_b16 v[124:125], v3 offset:41088
  v_mfma_f32_16x16x32_bf16 v[184:187], v[144:147], v[32:35], v[184:187]
  ds_read_b64_tr_b16 v[126:127], v3 offset:42368
  s_waitcnt vmcnt(7) lgkmcnt(8)
  v_mfma_f32_16x16x32_bf16 v[148:151], v[108:111], v[36:39], v[148:151]
  ds_read_b64_tr_b16 v[128:129], v3 offset:46080
  s_waitcnt vmcnt(6)
  v_mfma_f32_16x16x32_bf16 v[168:171], v[108:111], v[60:63], v[168:171]
  ds_read_b64_tr_b16 v[130:131], v3 offset:47360
  s_waitcnt lgkmcnt(8)
  v_mfma_f32_16x16x32_bf16 v[152:155], v[112:115], v[36:39], v[152:155]
  ds_read_b64_tr_b16 v[132:133], v3 offset:46112
  v_mfma_f32_16x16x32_bf16 v[172:175], v[112:115], v[60:63], v[172:175]
  ds_read_b64_tr_b16 v[134:135], v3 offset:47392
  s_waitcnt lgkmcnt(8)
  v_mfma_f32_16x16x32_bf16 v[156:159], v[116:119], v[36:39], v[156:159]
  ds_read_b64_tr_b16 v[136:137], v3 offset:46144
  v_mfma_f32_16x16x32_bf16 v[176:179], v[116:119], v[60:63], v[176:179]
  ds_read_b64_tr_b16 v[138:139], v3 offset:47424
  s_waitcnt lgkmcnt(8)
  v_mfma_f32_16x16x32_bf16 v[160:163], v[120:123], v[36:39], v[160:163]
  ds_read_b64_tr_b16 v[140:141], v3 offset:46176
  v_mfma_f32_16x16x32_bf16 v[180:183], v[120:123], v[60:63], v[180:183]
  ds_read_b64_tr_b16 v[142:143], v3 offset:47456
  s_waitcnt lgkmcnt(8)
  v_mfma_f32_16x16x32_bf16 v[164:167], v[124:127], v[36:39], v[164:167]
  ds_read_b64_tr_b16 v[144:145], v3 offset:46208
  v_mfma_f32_16x16x32_bf16 v[184:187], v[124:127], v[60:63], v[184:187]
  ds_read_b64_tr_b16 v[146:147], v3 offset:47488
  s_waitcnt vmcnt(5) lgkmcnt(8)
  v_mfma_f32_16x16x32_bf16 v[148:151], v[128:131], v[64:67], v[148:151]
  ds_read_b64_tr_b16 v[108:109], v3 offset:51200
  s_waitcnt vmcnt(4)
  v_mfma_f32_16x16x32_bf16 v[168:171], v[128:131], v[68:71], v[168:171]
  ds_read_b64_tr_b16 v[110:111], v3 offset:52480
  s_waitcnt lgkmcnt(8)
  v_mfma_f32_16x16x32_bf16 v[152:155], v[132:135], v[64:67], v[152:155]
  ds_read_b64_tr_b16 v[112:113], v3 offset:51232
  v_mfma_f32_16x16x32_bf16 v[172:175], v[132:135], v[68:71], v[172:175]
  ds_read_b64_tr_b16 v[114:115], v3 offset:52512
  s_waitcnt lgkmcnt(8)
  v_mfma_f32_16x16x32_bf16 v[156:159], v[136:139], v[64:67], v[156:159]
  ds_read_b64_tr_b16 v[116:117], v3 offset:51264
  v_mfma_f32_16x16x32_bf16 v[176:179], v[136:139], v[68:71], v[176:179]
  ds_read_b64_tr_b16 v[118:119], v3 offset:52544
  s_waitcnt lgkmcnt(8)
  v_mfma_f32_16x16x32_bf16 v[160:163], v[140:143], v[64:67], v[160:163]
  ds_read_b64_tr_b16 v[120:121], v3 offset:51296
  v_mfma_f32_16x16x32_bf16 v[180:183], v[140:143], v[68:71], v[180:183]
  ds_read_b64_tr_b16 v[122:123], v3 offset:52576
  s_waitcnt lgkmcnt(8)
  v_mfma_f32_16x16x32_bf16 v[164:167], v[144:147], v[64:67], v[164:167]
  ds_read_b64_tr_b16 v[124:125], v3 offset:51328
  v_mfma_f32_16x16x32_bf16 v[184:187], v[144:147], v[68:71], v[184:187]
  ds_read_b64_tr_b16 v[126:127], v3 offset:52608
  s_waitcnt vmcnt(3) lgkmcnt(8)
  v_mfma_f32_16x16x32_bf16 v[148:151], v[108:111], v[72:75], v[148:151]
  ds_read_b64_tr_b16 v[128:129], v3 offset:56320
  s_waitcnt vmcnt(2)
  v_mfma_f32_16x16x32_bf16 v[168:171], v[108:111], v[76:79], v[168:171]
  ds_read_b64_tr_b16 v[130:131], v3 offset:57600
  s_waitcnt lgkmcnt(8)
  v_mfma_f32_16x16x32_bf16 v[152:155], v[112:115], v[72:75], v[152:155]
  ds_read_b64_tr_b16 v[132:133], v3 offset:56352
  v_mfma_f32_16x16x32_bf16 v[172:175], v[112:115], v[76:79], v[172:175]
  ds_read_b64_tr_b16 v[134:135], v3 offset:57632
  s_waitcnt lgkmcnt(8)
  v_mfma_f32_16x16x32_bf16 v[156:159], v[116:119], v[72:75], v[156:159]
  ds_read_b64_tr_b16 v[136:137], v3 offset:56384
  v_mfma_f32_16x16x32_bf16 v[176:179], v[116:119], v[76:79], v[176:179]
  ds_read_b64_tr_b16 v[138:139], v3 offset:57664
  s_waitcnt lgkmcnt(8)
  v_mfma_f32_16x16x32_bf16 v[160:163], v[120:123], v[72:75], v[160:163]
  ds_read_b64_tr_b16 v[140:141], v3 offset:56416
  v_mfma_f32_16x16x32_bf16 v[180:183], v[120:123], v[76:79], v[180:183]
  ds_read_b64_tr_b16 v[142:143], v3 offset:57696
  s_waitcnt lgkmcnt(8)
  v_mfma_f32_16x16x32_bf16 v[164:167], v[124:127], v[72:75], v[164:167]
  ds_read_b64_tr_b16 v[144:145], v3 offset:56448
  v_mfma_f32_16x16x32_bf16 v[184:187], v[124:127], v[76:79], v[184:187]
  ds_read_b64_tr_b16 v[146:147], v3 offset:57728
  s_waitcnt vmcnt(1) lgkmcnt(8)
  v_mfma_f32_16x16x32_bf16 v[148:151], v[128:131], v[100:103], v[148:151]
  s_waitcnt vmcnt(0)
  v_mfma_f32_16x16x32_bf16 v[168:171], v[128:131], v[104:107], v[168:171]
  s_waitcnt lgkmcnt(6)
  v_mfma_f32_16x16x32_bf16 v[152:155], v[132:135], v[100:103], v[152:155]
  v_mfma_f32_16x16x32_bf16 v[172:175], v[132:135], v[104:107], v[172:175]
  s_waitcnt lgkmcnt(4)
  v_mfma_f32_16x16x32_bf16 v[156:159], v[136:139], v[100:103], v[156:159]
  v_mfma_f32_16x16x32_bf16 v[176:179], v[136:139], v[104:107], v[176:179]
  s_waitcnt lgkmcnt(2)
  v_mfma_f32_16x16x32_bf16 v[160:163], v[140:143], v[100:103], v[160:163]
  v_mfma_f32_16x16x32_bf16 v[180:183], v[140:143], v[104:107], v[180:183]
  s_waitcnt lgkmcnt(0)
  v_mfma_f32_16x16x32_bf16 v[164:167], v[144:147], v[100:103], v[164:167]
  v_mfma_f32_16x16x32_bf16 v[184:187], v[144:147], v[104:107], v[184:187]
  s_mul_i32 s64, s54, 327680
  s_cmp_eq_u32 s59, 0
  s_cselect_b32 s61, -17301504, 0
  s_add_u32 s64, s64, s61
  s_add_u32 s64, s64, 32505856
  s_and_b32 s61, s77, 2
  s_mul_i32 s61, s61, 81920
  s_add_u32 s64, s64, s61
  s_mul_i32 s61, s57, 2560
  s_add_u32 s64, s64, s61
  s_and_b32 s61, s55, 15
  s_xor_b32 s62, s61, 8
  s_mul_i32 s61, s61, 10240
  s_mul_i32 s62, s62, 10240
  s_add_u32 s63, s64, s61
  s_add_u32 s64, s64, s62
  v_lshlrev_b32 v2, 3, v1
  v_cvt_pk_bf16_f32 v4, v168, v169
  v_cvt_pk_bf16_f32 v5, v170, v171
  v_cvt_pk_bf16_f32 v6, v172, v173
  v_cvt_pk_bf16_f32 v7, v174, v175
  buffer_store_dwordx4 v[4:7], v0, s[12:15], s63 offen offset:0
  v_cvt_pk_bf16_f32 v8, v176, v177
  v_cvt_pk_bf16_f32 v9, v178, v179
  v_cvt_pk_bf16_f32 v10, v180, v181
  v_cvt_pk_bf16_f32 v11, v182, v183
  buffer_store_dwordx4 v[8:11], v0, s[12:15], s63 offen offset:1024
  v_cvt_pk_bf16_f32 v12, v184, v185
  v_cvt_pk_bf16_f32 v13, v186, v187
  buffer_store_dwordx2 v[12:13], v2, s[12:15], s63 offen offset:2048
  s_lshl_b32 s60, s54, 12
  s_lshl_b32 s61, s55, 4
  s_add_u32 s60, s60, s61
  s_lshl_b32 s61, s57, 2
  s_add_u32 s60, s60, s61
  s_add_u32 s60, s60, 67584
  v_mov_b32 v3, 0
  v_mov_b32 v16, s52
  s_mov_b64 exec, 1
  s_cmp_lg_u32 s59, 0
  s_waitcnt vmcnt(0)
  s_cbranch_scc1 L_sigslow_38
  buffer_store_dword v16, v3, s[12:15], s60 offen
L_sigdone_39:
  s_mov_b64 exec, -1
  s_mul_i32 s62, s57, 2560
  s_add_u32 s62, s62, 124928
  v_and_b32 v16, 15, v1
  v_mul_u32_u24 v16, 0xa0, v16
  v_lshrrev_b32 v17, 4, v1
  v_lshl_add_u32 v16, v17, 3, v16
  v_add_u32 v18, s62, v16
  v_add_u32 v19, s62, v0
  s_lshl_b32 s60, s77, 6
  s_lshl_b32 s61, s57, 4
  s_add_u32 s60, s60, s61
  s_mul_i32 s60, s60, 1280
  s_mul_i32 s61, s78, 160
  s_add_u32 s60, s60, s61
  s_mul_i32 s61, s54, 327680
  s_add_u32 s61, s61, s60
  v_add_u32 v16, 0, v1
  v_mul_u32_u24 v17, 0x199a, v16
  v_lshrrev_b32 v17, 16, v17
  v_mul_u32_u24 v17, 0x460, v17
  v_lshl_add_u32 v32, v16, 4, v17
  v_add_u32 v16, 64, v1
  v_mul_u32_u24 v17, 0x199a, v16
  v_lshrrev_b32 v17, 16, v17
  v_mul_u32_u24 v17, 0x460, v17
  v_lshl_add_u32 v33, v16, 4, v17
  v_add_u32 v16, 128, v1
  v_mul_u32_u24 v17, 0x199a, v16
  v_lshrrev_b32 v17, 16, v17
  v_mul_u32_u24 v17, 0x460, v17
  v_lshl_add_u32 v34, v16, 4, v17
  s_xor_b32 s62, s55, 8
  s_lshl_b32 s62, s62, 4
  s_lshl_b32 s63, s57, 2
  s_add_u32 s62, s62, s63
  s_lshl_b32 s63, s54, 12
  s_add_u32 s62, s62, s63
  s_add_u32 s62, s62, 67584
  v_mov_b32 v16, 0
  s_mov_b32 s74, 0
L_poll_40:
  buffer_load_dword v17, v16, s[12:15], s62 offen sc1
  s_add_u32 s74, s74, 1
  s_cmp_gt_u32 s74, 131072
  s_cbranch_scc1 L_pdone_41
  s_waitcnt vmcnt(0)
  v_cmp_ne_u32 vcc, s52, v17
  s_nop 3
  s_cbranch_vccnz L_poll_40
L_pdone_41:
  s_waitcnt vmcnt(0)
  s_cmp_eq_u32 s59, 0
  s_cbranch_scc1 L_noacq_42
  buffer_inv sc1
  s_waitcnt vmcnt(0)
L_noacq_42:
  buffer_load_dwordx4 v[168:171], v0, s[12:15], s64 offen sc1
  buffer_load_dwordx4 v[172:175], v0, s[12:15], s64 offen offset:1024 sc1
  buffer_load_dwordx2 v[176:177], v2, s[12:15], s64 offen offset:2048 sc1
  s_waitcnt vmcnt(2)
  v_lshlrev_b32 v16, 16, v168
  v_and_b32 v17, 0xffff0000, v168
  v_pk_add_f32 v[148:149], v[148:149], v[16:17]
  v_pk_fma_f32 v[148:149], v[148:149], v[80:81], v[40:41]
  v_cvt_pk_bf16_f32 v20, v148, v149
  v_lshlrev_b32 v16, 16, v169
  v_and_b32 v17, 0xffff0000, v169
  v_pk_add_f32 v[150:151], v[150:151], v[16:17]
  v_pk_fma_f32 v[150:151], v[150:151], v[82:83], v[42:43]
  v_cvt_pk_bf16_f32 v21, v150, v151
  ds_write_b64 v18, v[20:21] offset:0
  v_lshlrev_b32 v16, 16, v170
  v_and_b32 v17, 0xffff0000, v170
  v_pk_add_f32 v[152:153], v[152:153], v[16:17]
  v_pk_fma_f32 v[152:153], v[152:153], v[84:85], v[44:45]
  v_cvt_pk_bf16_f32 v22, v152, v153
  v_lshlrev_b32 v16, 16, v171
  v_and_b32 v17, 0xffff0000, v171
  v_pk_add_f32 v[154:155], v[154:155], v[16:17]
  v_pk_fma_f32 v[154:155], v[154:155], v[86:87], v[46:47]
  v_cvt_pk_bf16_f32 v23, v154, v155
  ds_write_b64 v18, v[22:23] offset:32
  s_waitcnt vmcnt(1)
  v_lshlrev_b32 v16, 16, v172
  v_and_b32 v17, 0xffff0000, v172
  v_pk_add_f32 v[156:157], v[156:157], v[16:17]
  v_pk_fma_f32 v[156:157], v[156:157], v[88:89], v[48:49]
  v_cvt_pk_bf16_f32 v24, v156, v157
  v_lshlrev_b32 v16, 16, v173
  v_and_b32 v17, 0xffff0000, v173
  v_pk_add_f32 v[158:159], v[158:159], v[16:17]
  v_pk_fma_f32 v[158:159], v[158:159], v[90:91], v[50:51]
  v_cvt_pk_bf16_f32 v25, v158, v159
  ds_write_b64 v18, v[24:25] offset:64
  v_lshlrev_b32 v16, 16, v174
  v_and_b32 v17, 0xffff0000, v174
  v_pk_add_f32 v[160:161], v[160:161], v[16:17]
  v_pk_fma_f32 v[160:161], v[160:161], v[92:93], v[52:53]
  v_cvt_pk_bf16_f32 v26, v160, v161
  v_lshlrev_b32 v16, 16, v175
  v_and_b32 v17, 0xffff0000, v175
  v_pk_add_f32 v[162:163], v[162:163], v[16:17]
  v_pk_fma_f32 v[162:163], v[162:163], v[94:95], v[54:55]
  v_cvt_pk_bf16_f32 v27, v162, v163
  ds_write_b64 v18, v[26:27] offset:96
  s_waitcnt vmcnt(0)
  v_lshlrev_b32 v16, 16, v176
  v_and_b32 v17, 0xffff0000, v176
  v_pk_add_f32 v[164:165], v[164:165], v[16:17]
  v_pk_fma_f32 v[164:165], v[164:165], v[96:97], v[56:57]
  v_cvt_pk_bf16_f32 v28, v164, v165
  v_lshlrev_b32 v16, 16, v177
  v_and_b32 v17, 0xffff0000, v177
  v_pk_add_f32 v[166:167], v[166:167], v[16:17]
  v_pk_fma_f32 v[166:167], v[166:167], v[98:99], v[58:59]
  v_cvt_pk_bf16_f32 v29, v166, v167
  ds_write_b64 v18, v[28:29] offset:128
  ds_read_b128 v[148:151], v19 offset:0
  ds_read_b128 v[152:155], v19 offset:1024
  ds_read_b128 v[156:159], v19 offset:2048
  s_waitcnt lgkmcnt(2)
  buffer_store_dwordx4 v[148:151], v32, s[8:11], s61 offen
  s_waitcnt lgkmcnt(1)
  buffer_store_dwordx4 v[152:155], v33, s[8:11], s61 offen
  s_mov_b32 exec_hi, 0
  s_waitcnt lgkmcnt(0)
  buffer_store_dwordx4 v[156:159], v34, s[8:11], s61 offen
  s_mov_b32 exec_hi, -1
  s_endpgm
L_sigslow_7:
  buffer_wbl2 sc1
  s_waitcnt vmcnt(0)
  buffer_store_dword v3, v2, s[12:15], s60 offen sc1
  s_branch L_sigdone_8
L_hook_2:
  s_nop 7
  v_mov_b32 v148, 0xf1800000
  v_mov_b32 v164, 0xf1800000
  v_mov_b32 v52, 0xf1800000
  v_mov_b32 v149, 0xf1800000
  v_mov_b32 v165, 0xf1800000
  v_mov_b32 v53, 0xf1800000
  v_mov_b32 v150, 0xf1800000
  v_mov_b32 v166, 0xf1800000
  v_mov_b32 v54, 0xf1800000
  v_mov_b32 v151, 0xf1800000
  v_mov_b32 v167, 0xf1800000
  v_mov_b32 v55, 0xf1800000
  v_mov_b32 v152, 0xf1800000
  v_mov_b32 v168, 0xf1800000
  v_mov_b32 v56, 0xf1800000
  v_mov_b32 v153, 0xf1800000
  v_mov_b32 v169, 0xf1800000
  v_mov_b32 v57, 0xf1800000
  v_mov_b32 v154, 0xf1800000
  v_mov_b32 v170, 0xf1800000
  v_mov_b32 v58, 0xf1800000
  v_mov_b32 v155, 0xf1800000
  v_mov_b32 v171, 0xf1800000
  v_mov_b32 v59, 0xf1800000
  v_mov_b32 v156, 0xf1800000
  v_mov_b32 v172, 0xf1800000
  v_mov_b32 v60, 0xf1800000
  v_mov_b32 v157, 0xf1800000
  v_mov_b32 v173, 0xf1800000
  v_mov_b32 v61, 0xf1800000
  v_mov_b32 v158, 0xf1800000
  v_mov_b32 v174, 0xf1800000
  v_mov_b32 v62, 0xf1800000
  v_mov_b32 v159, 0xf1800000
  v_mov_b32 v175, 0xf1800000
  v_mov_b32 v63, 0xf1800000
  v_mov_b32 v160, 0xf1800000
  v_mov_b32 v176, 0xf1800000
  v_mov_b32 v64, 0xf1800000
  v_mov_b32 v161, 0xf1800000
  v_mov_b32 v177, 0xf1800000
  v_mov_b32 v65, 0xf1800000
  v_mov_b32 v162, 0xf1800000
  v_mov_b32 v178, 0xf1800000
  v_mov_b32 v66, 0xf1800000
  v_mov_b32 v163, 0xf1800000
  v_mov_b32 v179, 0xf1800000
  v_mov_b32 v67, 0xf1800000
  s_nop 0
  s_branch L_back_2
L_hook_4:
  s_nop 7
  v_mov_b32 v148, 0xf1800000
  v_mov_b32 v164, 0xf1800000
  v_mov_b32 v52, 0xf1800000
  v_mov_b32 v149, 0xf1800000
  v_mov_b32 v165, 0xf1800000
  v_mov_b32 v53, 0xf1800000
  v_mov_b32 v150, 0xf1800000
  v_mov_b32 v166, 0xf1800000
  v_mov_b32 v54, 0xf1800000
  v_mov_b32 v151, 0xf1800000
  v_mov_b32 v167, 0xf1800000
  v_mov_b32 v55, 0xf1800000
  v_mov_b32 v152, 0xf1800000
  v_mov_b32 v168, 0xf1800000
  v_mov_b32 v56, 0xf1800000
  v_mov_b32 v153, 0xf1800000
  v_mov_b32 v169, 0xf1800000
  v_mov_b32 v57, 0xf1800000
  v_mov_b32 v154, 0xf1800000
  v_mov_b32 v170, 0xf1800000
  v_mov_b32 v58, 0xf1800000
  v_mov_b32 v155, 0xf1800000
  v_mov_b32 v171, 0xf1800000
  v_mov_b32 v59, 0xf1800000
  v_mov_b32 v156, 0xf1800000
  v_mov_b32 v172, 0xf1800000
  v_mov_b32 v60, 0xf1800000
  v_mov_b32 v157, 0xf1800000
  v_mov_b32 v173, 0xf1800000
  v_mov_b32 v61, 0xf1800000
  v_mov_b32 v158, 0xf1800000
  v_mov_b32 v174, 0xf1800000
  v_mov_b32 v62, 0xf1800000
  v_mov_b32 v159, 0xf1800000
  v_mov_b32 v175, 0xf1800000
  v_mov_b32 v63, 0xf1800000
  v_mov_b32 v160, 0xf1800000
  v_mov_b32 v176, 0xf1800000
  v_mov_b32 v64, 0xf1800000
  v_mov_b32 v161, 0xf1800000
  v_mov_b32 v177, 0xf1800000
  v_mov_b32 v65, 0xf1800000
  v_mov_b32 v162, 0xf1800000
  v_mov_b32 v178, 0xf1800000
  v_mov_b32 v66, 0xf1800000
  v_mov_b32 v163, 0xf1800000
  v_mov_b32 v179, 0xf1800000
  v_mov_b32 v67, 0xf1800000
  s_nop 0
  s_branch L_back_4
L_hook_6:
  s_nop 7
  v_mov_b32 v148, 0xf1800000
  v_mov_b32 v164, 0xf1800000
  v_mov_b32 v52, 0xf1800000
  v_mov_b32 v149, 0xf1800000
  v_mov_b32 v165, 0xf1800000
  v_mov_b32 v53, 0xf1800000
  v_mov_b32 v150, 0xf1800000
  v_mov_b32 v166, 0xf1800000
  v_mov_b32 v54, 0xf1800000
  v_mov_b32 v151, 0xf1800000
  v_mov_b32 v167, 0xf1800000
  v_mov_b32 v55, 0xf1800000
  v_mov_b32 v152, 0xf1800000
  v_mov_b32 v168, 0xf1800000
  v_mov_b32 v56, 0xf1800000
  v_mov_b32 v153, 0xf1800000
  v_mov_b32 v169, 0xf1800000
  v_mov_b32 v57, 0xf1800000
  v_mov_b32 v154, 0xf1800000
  v_mov_b32 v170, 0xf1800000
  v_mov_b32 v58, 0xf1800000
  v_mov_b32 v155, 0xf1800000
  v_mov_b32 v171, 0xf1800000
  v_mov_b32 v59, 0xf1800000
  v_mov_b32 v156, 0xf1800000
  v_mov_b32 v172, 0xf1800000
  v_mov_b32 v60, 0xf1800000
  v_mov_b32 v157, 0xf1800000
  v_mov_b32 v173, 0xf1800000
  v_mov_b32 v61, 0xf1800000
  v_mov_b32 v158, 0xf1800000
  v_mov_b32 v174, 0xf1800000
  v_mov_b32 v62, 0xf1800000
  v_mov_b32 v159, 0xf1800000
  v_mov_b32 v175, 0xf1800000
  v_mov_b32 v63, 0xf1800000
  v_mov_b32 v160, 0xf1800000
  v_mov_b32 v176, 0xf1800000
  v_mov_b32 v64, 0xf1800000
  v_mov_b32 v161, 0xf1800000
  v_mov_b32 v177, 0xf1800000
  v_mov_b32 v65, 0xf1800000
  v_mov_b32 v162, 0xf1800000
  v_mov_b32 v178, 0xf1800000
  v_mov_b32 v66, 0xf1800000
  v_mov_b32 v163, 0xf1800000
  v_mov_b32 v179, 0xf1800000
  v_mov_b32 v67, 0xf1800000
  s_nop 0
  s_branch L_back_6
L_hook_8:
  s_nop 7
  v_mov_b32 v148, 0xf1800000
  v_mov_b32 v164, 0xf1800000
  v_mov_b32 v52, 0xf1800000
  v_mov_b32 v149, 0xf1800000
  v_mov_b32 v165, 0xf1800000
  v_mov_b32 v53, 0xf1800000
  v_mov_b32 v150, 0xf1800000
  v_mov_b32 v166, 0xf1800000
  v_mov_b32 v54, 0xf1800000
  v_mov_b32 v151, 0xf1800000
  v_mov_b32 v167, 0xf1800000
  v_mov_b32 v55, 0xf1800000
  v_mov_b32 v152, 0xf1800000
  v_mov_b32 v168, 0xf1800000
  v_mov_b32 v56, 0xf1800000
  v_mov_b32 v153, 0xf1800000
  v_mov_b32 v169, 0xf1800000
  v_mov_b32 v57, 0xf1800000
  v_mov_b32 v154, 0xf1800000
  v_mov_b32 v170, 0xf1800000
  v_mov_b32 v58, 0xf1800000
  v_mov_b32 v155, 0xf1800000
  v_mov_b32 v171, 0xf1800000
  v_mov_b32 v59, 0xf1800000
  v_mov_b32 v156, 0xf1800000
  v_mov_b32 v172, 0xf1800000
  v_mov_b32 v60, 0xf1800000
  v_mov_b32 v157, 0xf1800000
  v_mov_b32 v173, 0xf1800000
  v_mov_b32 v61, 0xf1800000
  v_mov_b32 v158, 0xf1800000
  v_mov_b32 v174, 0xf1800000
  v_mov_b32 v62, 0xf1800000
  v_mov_b32 v159, 0xf1800000
  v_mov_b32 v175, 0xf1800000
  v_mov_b32 v63, 0xf1800000
  v_mov_b32 v160, 0xf1800000
  v_mov_b32 v176, 0xf1800000
  v_mov_b32 v64, 0xf1800000
  v_mov_b32 v161, 0xf1800000
  v_mov_b32 v177, 0xf1800000
  v_mov_b32 v65, 0xf1800000
  v_mov_b32 v162, 0xf1800000
  v_mov_b32 v178, 0xf1800000
  v_mov_b32 v66, 0xf1800000
  v_mov_b32 v163, 0xf1800000
  v_mov_b32 v179, 0xf1800000
  v_mov_b32 v67, 0xf1800000
  s_nop 0
  s_branch L_back_8
L_fb:
  v_lshrrev_b32 v40, 5, v1
  v_lshlrev_b32 v40, 2, v40
  v_and_b32 v41, 31, v1
  v_sub_u32 v40, v41, v40
  v_mov_b32 v41, 0xf1800000
  v_subrev_u32 v52, 0, v40
  v_ashrrev_i32 v52, 31, v52
  v_and_b32 v52, v41, v52
  v_subrev_u32 v53, 1, v40
  v_ashrrev_i32 v53, 31, v53
  v_and_b32 v53, v41, v53
  v_subrev_u32 v54, 2, v40
  v_ashrrev_i32 v54, 31, v54
  v_and_b32 v54, v41, v54
  v_subrev_u32 v55, 3, v40
  v_ashrrev_i32 v55, 31, v55
  v_and_b32 v55, v41, v55
  v_subrev_u32 v56, 8, v40
  v_ashrrev_i32 v56, 31, v56
  v_and_b32 v56, v41, v56
  v_subrev_u32 v57, 9, v40
  v_ashrrev_i32 v57, 31, v57
  v_and_b32 v57, v41, v57
  v_subrev_u32 v58, 10, v40
  v_ashrrev_i32 v58, 31, v58
  v_and_b32 v58, v41, v58
  v_subrev_u32 v59, 11, v40
  v_ashrrev_i32 v59, 31, v59
  v_and_b32 v59, v41, v59
  v_subrev_u32 v60, 16, v40
  v_ashrrev_i32 v60, 31, v60
  v_and_b32 v60, v41, v60
  v_subrev_u32 v61, 17, v40
  v_ashrrev_i32 v61, 31, v61
  v_and_b32 v61, v41, v61
  v_subrev_u32 v62, 18, v40
  v_ashrrev_i32 v62, 31, v62
  v_and_b32 v62, v41, v62
  v_subrev_u32 v63, 19, v40
  v_ashrrev_i32 v63, 31, v63
  v_and_b32 v63, v41, v63
  v_subrev_u32 v64, 24, v40
  v_ashrrev_i32 v64, 31, v64
  v_and_b32 v64, v41, v64
  v_subrev_u32 v65, 25, v40
  v_ashrrev_i32 v65, 31, v65
  v_and_b32 v65, v41, v65
  v_subrev_u32 v66, 26, v40
  v_ashrrev_i32 v66, 31, v66
  v_and_b32 v66, v41, v66
  v_subrev_u32 v67, 27, v40
  v_ashrrev_i32 v67, 31, v67
  v_and_b32 v67, v41, v67
  v_sub_f32 v148, v41, v52
  v_sub_f32 v149, v41, v53
  v_sub_f32 v150, v41, v54
  v_sub_f32 v151, v41, v55
  v_sub_f32 v152, v41, v56
  v_sub_f32 v153, v41, v57
  v_sub_f32 v154, v41, v58
  v_sub_f32 v155, v41, v59
  v_sub_f32 v156, v41, v60
  v_sub_f32 v157, v41, v61
  v_sub_f32 v158, v41, v62
  v_sub_f32 v159, v41, v63
  v_sub_f32 v160, v41, v64
  v_sub_f32 v161, v41, v65
  v_sub_f32 v162, v41, v66
  v_sub_f32 v163, v41, v67
  s_cmp_le_u32 s75, 1
  s_cbranch_scc1 L_fbskip_43
  ds_read_b64 v[48:49], v2 offset:2048
  ds_read_b64 v[50:51], v2 offset:10368
  ds_read_b64 v[188:189], v3 offset:2048
  s_waitcnt lgkmcnt(1)
  v_mfma_f32_32x32x16_bf16 v[68:83], v[48:51], v[4:7], 0
  s_waitcnt lgkmcnt(0)
  v_mfma_f32_32x32x8bf16_1k v[68:83], v[188:189], v[12:13], v[68:83]
  s_nop 11
  v_max3_f32 v192, v68, v69, v192
  v_max3_f32 v192, v70, v71, v192
  v_max3_f32 v192, v72, v73, v192
  v_max3_f32 v192, v74, v75, v192
  v_max3_f32 v192, v76, v77, v192
  v_max3_f32 v192, v78, v79, v192
  v_max3_f32 v192, v80, v81, v192
  v_max3_f32 v192, v82, v83, v192
L_fbskip_43:
  s_cmp_le_u32 s75, 2
  s_cbranch_scc1 L_fbskip_44
  ds_read_b64 v[48:49], v2 offset:1792
  ds_read_b64 v[50:51], v2 offset:10112
  ds_read_b64 v[188:189], v3 offset:1792
  s_waitcnt lgkmcnt(1)
  v_mfma_f32_32x32x16_bf16 v[68:83], v[48:51], v[4:7], 0
  s_waitcnt lgkmcnt(0)
  v_mfma_f32_32x32x8bf16_1k v[68:83], v[188:189], v[12:13], v[68:83]
  v_mfma_f32_32x32x16_bf16 v[84:99], v[48:51], v[8:11], 0
  v_mfma_f32_32x32x8bf16_1k v[84:99], v[188:189], v[14:15], v[84:99]
  s_nop 9
  v_max3_f32 v192, v68, v69, v192
  v_max3_f32 v192, v70, v71, v192
  v_max3_f32 v192, v72, v73, v192
  v_max3_f32 v192, v74, v75, v192
  v_max3_f32 v192, v76, v77, v192
  v_max3_f32 v192, v78, v79, v192
  v_max3_f32 v192, v80, v81, v192
  v_max3_f32 v192, v82, v83, v192
  v_max3_f32 v193, v84, v85, v193
  v_max3_f32 v193, v86, v87, v193
  v_max3_f32 v193, v88, v89, v193
  v_max3_f32 v193, v90, v91, v193
  v_max3_f32 v193, v92, v93, v193
  v_max3_f32 v193, v94, v95, v193
  v_max3_f32 v193, v96, v97, v193
  v_max3_f32 v193, v98, v99, v193
L_fbskip_44:
  s_cmp_le_u32 s75, 3
  s_cbranch_scc1 L_fbskip_45
  ds_read_b64 v[48:49], v2 offset:1536
  ds_read_b64 v[50:51], v2 offset:9856
  ds_read_b64 v[188:189], v3 offset:1536
  s_waitcnt lgkmcnt(1)
  v_mfma_f32_32x32x16_bf16 v[68:83], v[48:51], v[4:7], 0
  s_waitcnt lgkmcnt(0)
  v_mfma_f32_32x32x8bf16_1k v[68:83], v[188:189], v[12:13], v[68:83]
  v_mfma_f32_32x32x16_bf16 v[84:99], v[48:51], v[8:11], 0
  v_mfma_f32_32x32x8bf16_1k v[84:99], v[188:189], v[14:15], v[84:99]
  s_nop 9
  v_max3_f32 v192, v68, v69, v192
  v_max3_f32 v192, v70, v71, v192
  v_max3_f32 v192, v72, v73, v192
  v_max3_f32 v192, v74, v75, v192
  v_max3_f32 v192, v76, v77, v192
  v_max3_f32 v192, v78, v79, v192
  v_max3_f32 v192, v80, v81, v192
  v_max3_f32 v192, v82, v83, v192
  v_max3_f32 v193, v84, v85, v193
  v_max3_f32 v193, v86, v87, v193
  v_max3_f32 v193, v88, v89, v193
  v_max3_f32 v193, v90, v91, v193
  v_max3_f32 v193, v92, v93, v193
  v_max3_f32 v193, v94, v95, v193
  v_max3_f32 v193, v96, v97, v193
  v_max3_f32 v193, v98, v99, v193
L_fbskip_45:
  s_cmp_le_u32 s75, 4
  s_cbranch_scc1 L_fbskip_46
  ds_read_b64 v[48:49], v2 offset:1280
  ds_read_b64 v[50:51], v2 offset:9600
  ds_read_b64 v[188:189], v3 offset:1280
  s_waitcnt lgkmcnt(1)
  v_mfma_f32_32x32x16_bf16 v[68:83], v[48:51], v[4:7], 0
  s_waitcnt lgkmcnt(0)
  v_mfma_f32_32x32x8bf16_1k v[68:83], v[188:189], v[12:13], v[68:83]
  v_mfma_f32_32x32x16_bf16 v[84:99], v[48:51], v[8:11], 0
  v_mfma_f32_32x32x8bf16_1k v[84:99], v[188:189], v[14:15], v[84:99]
  s_nop 9
  v_max3_f32 v192, v68, v69, v192
  v_max3_f32 v192, v70, v71, v192
  v_max3_f32 v192, v72, v73, v192
  v_max3_f32 v192, v74, v75, v192
  v_max3_f32 v192, v76, v77, v192
  v_max3_f32 v192, v78, v79, v192
  v_max3_f32 v192, v80, v81, v192
  v_max3_f32 v192, v82, v83, v192
  v_max3_f32 v193, v84, v85, v193
  v_max3_f32 v193, v86, v87, v193
  v_max3_f32 v193, v88, v89, v193
  v_max3_f32 v193, v90, v91, v193
  v_max3_f32 v193, v92, v93, v193
  v_max3_f32 v193, v94, v95, v193
  v_max3_f32 v193, v96, v97, v193
  v_max3_f32 v193, v98, v99, v193
L_fbskip_46:
  s_cmp_le_u32 s75, 5
  s_cbranch_scc1 L_fbskip_47
  ds_read_b64 v[48:49], v2 offset:1024
  ds_read_b64 v[50:51], v2 offset:9344
  ds_read_b64 v[188:189], v3 offset:1024
  s_waitcnt lgkmcnt(1)
  v_mfma_f32_32x32x16_bf16 v[68:83], v[48:51], v[4:7], 0
  s_waitcnt lgkmcnt(0)
  v_mfma_f32_32x32x8bf16_1k v[68:83], v[188:189], v[12:13], v[68:83]
  v_mfma_f32_32x32x16_bf16 v[84:99], v[48:51], v[8:11], 0
  v_mfma_f32_32x32x8bf16_1k v[84:99], v[188:189], v[14:15], v[84:99]
  s_nop 9
  v_max3_f32 v192, v68, v69, v192
  v_max3_f32 v192, v70, v71, v192
  v_max3_f32 v192, v72, v73, v192
  v_max3_f32 v192, v74, v75, v192
  v_max3_f32 v192, v76, v77, v192
  v_max3_f32 v192, v78, v79, v192
  v_max3_f32 v192, v80, v81, v192
  v_max3_f32 v192, v82, v83, v192
  v_max3_f32 v193, v84, v85, v193
  v_max3_f32 v193, v86, v87, v193
  v_max3_f32 v193, v88, v89, v193
  v_max3_f32 v193, v90, v91, v193
  v_max3_f32 v193, v92, v93, v193
  v_max3_f32 v193, v94, v95, v193
  v_max3_f32 v193, v96, v97, v193
  v_max3_f32 v193, v98, v99, v193
L_fbskip_47:
  s_cmp_le_u32 s75, 6
  s_cbranch_scc1 L_fbskip_48
  ds_read_b64 v[48:49], v2 offset:768
  ds_read_b64 v[50:51], v2 offset:9088
  ds_read_b64 v[188:189], v3 offset:768
  s_waitcnt lgkmcnt(1)
  v_mfma_f32_32x32x16_bf16 v[68:83], v[48:51], v[4:7], 0
  s_waitcnt lgkmcnt(0)
  v_mfma_f32_32x32x8bf16_1k v[68:83], v[188:189], v[12:13], v[68:83]
  v_mfma_f32_32x32x16_bf16 v[84:99], v[48:51], v[8:11], 0
  v_mfma_f32_32x32x8bf16_1k v[84:99], v[188:189], v[14:15], v[84:99]
  s_nop 9
  v_max3_f32 v192, v68, v69, v192
  v_max3_f32 v192, v70, v71, v192
  v_max3_f32 v192, v72, v73, v192
  v_max3_f32 v192, v74, v75, v192
  v_max3_f32 v192, v76, v77, v192
  v_max3_f32 v192, v78, v79, v192
  v_max3_f32 v192, v80, v81, v192
  v_max3_f32 v192, v82, v83, v192
  v_max3_f32 v193, v84, v85, v193
  v_max3_f32 v193, v86, v87, v193
  v_max3_f32 v193, v88, v89, v193
  v_max3_f32 v193, v90, v91, v193
  v_max3_f32 v193, v92, v93, v193
  v_max3_f32 v193, v94, v95, v193
  v_max3_f32 v193, v96, v97, v193
  v_max3_f32 v193, v98, v99, v193
L_fbskip_48:
  s_cmp_le_u32 s75, 7
  s_cbranch_scc1 L_fbskip_49
  ds_read_b64 v[48:49], v2 offset:512
  ds_read_b64 v[50:51], v2 offset:8832
  ds_read_b64 v[188:189], v3 offset:512
  s_waitcnt lgkmcnt(1)
  v_mfma_f32_32x32x16_bf16 v[68:83], v[48:51], v[4:7], 0
  s_waitcnt lgkmcnt(0)
  v_mfma_f32_32x32x8bf16_1k v[68:83], v[188:189], v[12:13], v[68:83]
  v_mfma_f32_32x32x16_bf16 v[84:99], v[48:51], v[8:11], 0
  v_mfma_f32_32x32x8bf16_1k v[84:99], v[188:189], v[14:15], v[84:99]
  s_nop 9
  v_max3_f32 v192, v68, v69, v192
  v_max3_f32 v192, v70, v71, v192
  v_max3_f32 v192, v72, v73, v192
  v_max3_f32 v192, v74, v75, v192
  v_max3_f32 v192, v76, v77, v192
  v_max3_f32 v192, v78, v79, v192
  v_max3_f32 v192, v80, v81, v192
  v_max3_f32 v192, v82, v83, v192
  v_max3_f32 v193, v84, v85, v193
  v_max3_f32 v193, v86, v87, v193
  v_max3_f32 v193, v88, v89, v193
  v_max3_f32 v193, v90, v91, v193
  v_max3_f32 v193, v92, v93, v193
  v_max3_f32 v193, v94, v95, v193
  v_max3_f32 v193, v96, v97, v193
  v_max3_f32 v193, v98, v99, v193
L_fbskip_49:
  s_cmp_le_u32 s75, 8
  s_cbranch_scc1 L_fbskip_50
  ds_read_b64 v[48:49], v2 offset:256
  ds_read_b64 v[50:51], v2 offset:8576
  ds_read_b64 v[188:189], v3 offset:256
  s_waitcnt lgkmcnt(1)
  v_mfma_f32_32x32x16_bf16 v[68:83], v[48:51], v[4:7], v[148:163]
  s_waitcnt lgkmcnt(0)
  v_mfma_f32_32x32x8bf16_1k v[68:83], v[188:189], v[12:13], v[68:83]
  v_mfma_f32_32x32x16_bf16 v[84:99], v[48:51], v[8:11], 0
  v_mfma_f32_32x32x8bf16_1k v[84:99], v[188:189], v[14:15], v[84:99]
  s_nop 9
  v_max3_f32 v192, v68, v69, v192
  v_max3_f32 v192, v70, v71, v192
  v_max3_f32 v192, v72, v73, v192
  v_max3_f32 v192, v74, v75, v192
  v_max3_f32 v192, v76, v77, v192
  v_max3_f32 v192, v78, v79, v192
  v_max3_f32 v192, v80, v81, v192
  v_max3_f32 v192, v82, v83, v192
  v_max3_f32 v193, v84, v85, v193
  v_max3_f32 v193, v86, v87, v193
  v_max3_f32 v193, v88, v89, v193
  v_max3_f32 v193, v90, v91, v193
  v_max3_f32 v193, v92, v93, v193
  v_max3_f32 v193, v94, v95, v193
  v_max3_f32 v193, v96, v97, v193
  v_max3_f32 v193, v98, v99, v193
L_fbskip_50:
  s_cmp_le_u32 s75, 9
  s_cbranch_scc1 L_fbskip_51
  ds_read_b64 v[48:49], v2 offset:0
  ds_read_b64 v[50:51], v2 offset:8320
  ds_read_b64 v[188:189], v3 offset:0
  s_waitcnt lgkmcnt(1)
  v_mfma_f32_32x32x16_bf16 v[84:99], v[48:51], v[8:11], v[148:163]
  s_waitcnt lgkmcnt(0)
  v_mfma_f32_32x32x8bf16_1k v[84:99], v[188:189], v[14:15], v[84:99]
  s_nop 11
  v_max3_f32 v193, v84, v85, v193
  v_max3_f32 v193, v86, v87, v193
  v_max3_f32 v193, v88, v89, v193
  v_max3_f32 v193, v90, v91, v193
  v_max3_f32 v193, v92, v93, v193
  v_max3_f32 v193, v94, v95, v193
  v_max3_f32 v193, v96, v97, v193
  v_max3_f32 v193, v98, v99, v193
L_fbskip_51:
  s_mov_b32 s76, 1
  s_branch L_att
L_sigslow_17:
  buffer_wbl2 sc1
  s_waitcnt vmcnt(0)
  buffer_store_dword v3, v2, s[12:15], s60 offen sc1
  s_branch L_sigdone_18
L_modagain_19:
  s_mov_b32 s74, 0
L_poll_52:
  buffer_load_dwordx4 v[32:35], v39, s[12:15], s64 offen sc1
  s_add_u32 s74, s74, 1
  s_cmp_gt_u32 s74, 131072
  s_cbranch_scc1 L_pdone_53
  s_waitcnt vmcnt(0)
  v_cmp_ne_u64 vcc, s[52:53], v[34:35]
  s_nop 3
  s_cbranch_vccnz L_poll_52
L_pdone_53:
  s_waitcnt vmcnt(0)
  s_branch L_modhave_20
L_stslow_24:
  buffer_store_dwordx4 v[8:11], v37, s[12:15], s61 offen sc1
  s_nop 0
  s_branch L_stdone_25
L_sigslow_28:
  buffer_wbl2 sc1
  s_waitcnt vmcnt(0)
  buffer_store_dword v31, v18, s[12:15], s60 offen sc1
  s_branch L_sigdone_29
L_sigslow_33:
  buffer_wbl2 sc1
  s_waitcnt vmcnt(0)
  buffer_store_dword v6, v5, s[12:15], s60 offen sc1
  s_branch L_sigdone_34
L_sigslow_38:
  buffer_wbl2 sc1
  s_waitcnt vmcnt(0)
  buffer_store_dword v16, v3, s[12:15], s60 offen sc1
  s_branch L_sigdone_39
L_helper:
  v_mov_b32 v4, 0
  v_mov_b32 v5, 0
  v_mov_b32 v6, 0
  v_mov_b32 v7, 0
  ds_write_b128 v4, v[4:7] offset:1280
  ds_write_b128 v4, v[4:7] offset:1296
  s_load_dwordx2 s[20:21], s[0:1], 8
  s_load_dwordx2 s[16:17], s[0:1], 16
  s_load_dwordx2 s[24:25], s[0:1], 32
  s_load_dwordx2 s[28:29], s[0:1], 40
  s_load_dwordx2 s[32:33], s[0:1], 48
  s_load_dwordx2 s[8:9], s[0:1], 72
  s_mov_b32 s22, 2457600
  s_mov_b32 s23, 0x20000
  s_mov_b32 s18, 819200
  s_mov_b32 s19, 0x20000
  s_mov_b32 s26, 1966080
  s_mov_b32 s27, 0x20000
  s_mov_b32 s30, 1966080
  s_mov_b32 s31, 0x20000
  s_mov_b32 s34, 1966080
  s_mov_b32 s35, 0x20000
  s_mov_b32 s10, 2621440
  s_mov_b32 s11, 0x20000
  s_getreg_b32 s58, hwreg(HW_REG_XCC_ID, 0, 4)
  s_mov_b32 s72, 0
  s_mov_b32 s73, -1
  s_lshr_b32 s77, s55, 3
  s_and_b32 s78, s55, 7
  s_cmp_ge_u32 s55, 15
  s_cselect_b32 s46, 1, 0
  s_cselect_b32 s60, 15, 0
  s_sub_u32 s47, s55, s60
  s_min_u32 s47, s47, 14
  v_lshrrev_b32 v2, 4, v1
  v_lshlrev_b32 v9, 2, v2
  v_and_b32 v8, 15, v1
  v_xor_b32 v8, v8, v9
  v_lshlrev_b32 v8, 4, v8
  v_mul_u32_u24 v2, 0xf00, v2
  s_lshl_b32 s60, s47, 8
  s_mul_i32 s61, s57, 15360
  s_add_u32 s60, s60, s61
  v_add3_u32 v8, v8, v2, s60
  s_mul_i32 s66, s46, 1228800
  s_mul_i32 s65, s46, 2457600
  s_sub_u32 s65, 61440, s65
  s_lshl_b32 s67, s57, 10
  s_waitcnt lgkmcnt(0)
  s_load_dword s52, s[12:13], 0
  s_mov_b32 s14, 35127296
  s_mov_b32 s15, 0x20000
  s_waitcnt lgkmcnt(0)
  s_add_u32 s52, s52, 1
  s_not_b32 s53, s52
  s_cmp_eq_u32 s57, 0
  s_cselect_b32 s64, 0, 2130706432
  s_add_u32 s64, s64, 36864
  s_lshl_b32 s61, s54, 5
  s_add_u32 s61, s61, s55
  s_lshl_b32 s61, s61, 4
  s_add_u32 s61, s61, s64
  s_xor_b32 s62, s53, s58
  v_mov_b32 v6, s52
  v_mov_b32 v7, s62
  s_mov_b64 exec, 1
  buffer_store_dwordx4 v[4:7], v4, s[12:15], s61 offen sc1
  s_mov_b64 exec, -1
  s_nop 1
  s_lshl_b32 s63, s55, 2
  s_add_u32 s63, s63, s57
  s_mul_i32 s60, s78, 160
  v_add_u32 v4, 0, v1
  v_mul_u32_u24 v5, 0x199a, v4
  v_lshrrev_b32 v5, 16, v5
  v_mul_u32_u24 v10, 0x460, v5
  v_lshl_add_u32 v10, v4, 4, v10
  v_add_u32 v10, s60, v10
  v_add_u32 v4, 64, v1
  v_mul_u32_u24 v5, 0x199a, v4
  v_lshrrev_b32 v5, 16, v5
  v_mul_u32_u24 v11, 0x460, v5
  v_lshl_add_u32 v11, v4, 4, v11
  v_add_u32 v11, s60, v11
  v_add_u32 v4, 128, v1
  v_mul_u32_u24 v5, 0x199a, v4
  v_lshrrev_b32 v5, 16, v5
  v_mul_u32_u24 v12, 0x460, v5
  v_lshl_add_u32 v12, v4, 4, v12
  v_add_u32 v12, s60, v12
  v_add_u32 v4, 192, v1
  v_mul_u32_u24 v5, 0x199a, v4
  v_lshrrev_b32 v5, 16, v5
  v_mul_u32_u24 v13, 0x460, v5
  v_lshl_add_u32 v13, v4, 4, v13
  v_add_u32 v13, s60, v13
  v_add_u32 v4, 256, v1
  v_mul_u32_u24 v5, 0x199a, v4
  v_lshrrev_b32 v5, 16, v5
  v_mul_u32_u24 v14, 0x460, v5
  v_lshl_add_u32 v14, v4, 4, v14
  v_add_u32 v14, s60, v14
  s_and_b32 s60, s55, 15
  s_mul_i32 s60, s60, 192
  v_add_u32 v2, 0, v1
  v_mul_u32_u24 v9, 0x1556, v2
  v_lshrrev_b32 v9, 16, v9
  v_lshlrev_b32 v2, 4, v2
  v_mul_u32_u24 v4, 0xb40, v9
  v_add3_u32 v4, v4, v2, s60
  v_add_u32 v2, 64, v1
  v_mul_u32_u24 v9, 0x1556, v2
  v_lshrrev_b32 v9, 16, v9
  v_lshlrev_b32 v2, 4, v2
  v_mul_u32_u24 v5, 0xb40, v9
  v_add3_u32 v5, v5, v2, s60
  v_add_u32 v2, 128, v1
  v_mul_u32_u24 v9, 0x1556, v2
  v_lshrrev_b32 v9, 16, v9
  v_lshlrev_b32 v2, 4, v2
  v_mul_u32_u24 v6, 0xb40, v9
  v_add3_u32 v6, v6, v2, s60
  s_bitcmp1_b32 s57, 0
  s_cselect_b32 s24, s28, s24
  s_cselect_b32 s25, s29, s25
  s_mov_b32 s49, s63
  s_lshr_b32 s50, s63, 2
  s_lshl_b32 s50, s50, 1
  s_lshr_b32 s60, s57, 1
  s_add_u32 s50, s50, s60
  s_and_b32 s64, s63, 63
  s_mul_i32 s61, s54, 4096
  s_mul_i32 s62, s64, 64
  s_add_u32 s61, s61, s62
  s_add_u32 s61, s61, 65536
  s_add_u32 s70, s12, s61
  s_addc_u32 s71, s13, 0
  s_load_dword s79, s[70:71], 0
  s_mul_i32 s61, s54, 327680
  s_mul_i32 s62, s63, 2560
  s_add_u32 s61, s61, s62
  s_add_u32 s61, s61, 15204352
  s_add_u32 s70, s12, s61
  s_addc_u32 s71, s13, 0
  s_barrier
  s_add_u32 m0, s67, 12288
  s_nop 0
  buffer_load_dwordx4 v8, s[20:23], s66 offen lds
  s_add_u32 s66, s66, 61440
  s_add_u32 m0, s67, 16384
  s_nop 0
  buffer_load_dwordx4 v8, s[20:23], s66 offen lds
  s_add_u32 s66, s66, 61440
  s_add_u32 m0, s67, 20480
  s_nop 0
  buffer_load_dwordx4 v8, s[20:23], s66 offen lds
  s_add_u32 s66, s66, 61440
  s_add_u32 m0, s67, 24576
  s_nop 0
  buffer_load_dwordx4 v8, s[20:23], s66 offen lds
  s_add_u32 s66, s66, 61440
  s_add_u32 m0, s67, 28672
  s_nop 0
  buffer_load_dwordx4 v8, s[20:23], s66 offen lds
  s_add_u32 s66, s66, 61440
  s_add_u32 m0, s67, 32768
  s_nop 0
  buffer_load_dwordx4 v8, s[20:23], s66 offen lds
  s_add_u32 s66, s66, 61440
  s_add_u32 m0, s67, 36864
  s_nop 0
  buffer_load_dwordx4 v8, s[20:23], s66 offen lds
  s_add_u32 s66, s66, 61440
  s_add_u32 m0, s67, 40960
  s_nop 0
  buffer_load_dwordx4 v8, s[20:23], s66 offen lds
  s_add_u32 s66, s66, 61440
  s_add_u32 m0, s67, 45056
  s_nop 0
  buffer_load_dwordx4 v8, s[20:23], s66 offen lds
  s_add_u32 s66, s66, 61440
  s_add_u32 m0, s67, 49152
  s_nop 0
  buffer_load_dwordx4 v8, s[20:23], s66 offen lds
  s_add_u32 s66, s66, 61440
  s_add_u32 m0, s67, 53248
  s_nop 0
  buffer_load_dwordx4 v8, s[20:23], s66 offen lds
  s_add_u32 s66, s66, 61440
  s_add_u32 m0, s67, 57344
  s_nop 0
  buffer_load_dwordx4 v8, s[20:23], s66 offen lds
  s_add_u32 s66, s66, 61440
  s_add_u32 m0, s67, 61440
  s_nop 0
  buffer_load_dwordx4 v8, s[20:23], s66 offen lds
  s_add_u32 s66, s66, 61440
  s_add_u32 m0, s67, 65536
  s_nop 0
  buffer_load_dwordx4 v8, s[20:23], s66 offen lds
  s_add_u32 s66, s66, 61440
  s_add_u32 m0, s67, 69632
  s_nop 0
  buffer_load_dwordx4 v8, s[20:23], s66 offen lds
  s_add_u32 s66, s66, 61440
  s_add_u32 m0, s67, 73728
  s_nop 0
  buffer_load_dwordx4 v8, s[20:23], s66 offen lds
  s_add_u32 s66, s66, 61440
  s_load_dword s79, s[70:71], 0
  s_load_dword s79, s[70:71], 64
  s_load_dword s79, s[70:71], 128
  s_load_dword s79, s[70:71], 192
  s_load_dword s79, s[70:71], 256
  s_load_dword s79, s[70:71], 320
  s_load_dword s79, s[70:71], 384
  s_load_dword s79, s[70:71], 448
  s_load_dword s79, s[70:71], 512
  s_load_dword s79, s[70:71], 576
  s_load_dword s79, s[70:71], 640
  s_load_dword s79, s[70:71], 704
  s_load_dword s79, s[70:71], 768
  s_load_dword s79, s[70:71], 832
  s_load_dword s79, s[70:71], 896
  s_load_dword s79, s[70:71], 960
  s_load_dword s79, s[70:71], 1024
  s_load_dword s79, s[70:71], 1088
  s_load_dword s79, s[70:71], 1152
  s_load_dword s79, s[70:71], 1216
  s_load_dword s79, s[70:71], 1280
  s_load_dword s79, s[70:71], 1344
  s_load_dword s79, s[70:71], 1408
  s_load_dword s79, s[70:71], 1472
  s_load_dword s79, s[70:71], 1536
  s_load_dword s79, s[70:71], 1600
  s_load_dword s79, s[70:71], 1664
  s_load_dword s79, s[70:71], 1728
  s_load_dword s79, s[70:71], 1792
  s_load_dword s79, s[70:71], 1856
  s_load_dword s79, s[70:71], 1920
  s_load_dword s79, s[70:71], 1984
  s_load_dword s79, s[70:71], 2048
  s_load_dword s79, s[70:71], 2112
  s_load_dword s79, s[70:71], 2176
  s_load_dword s79, s[70:71], 2240
  s_load_dword s79, s[70:71], 2304
  s_load_dword s79, s[70:71], 2368
  s_load_dword s79, s[70:71], 2432
  s_load_dword s79, s[70:71], 2496
  s_mul_i32 s61, s54, 32768
  s_mul_i32 s62, s63, 256
  s_add_u32 s61, s61, s62
  s_add_u32 s61, s61, 131072
  s_add_u32 s70, s12, s61
  s_addc_u32 s71, s13, 0
  s_load_dword s79, s[70:71], 0
  s_load_dword s79, s[70:71], 64
  s_load_dword s79, s[70:71], 128
  s_load_dword s79, s[70:71], 192
  s_mul_i32 s61, s54, 786432
  s_mul_i32 s62, s63, 6144
  s_add_u32 s61, s61, s62
  s_add_u32 s61, s61, 17825792
  s_add_u32 s42, s12, s61
  s_addc_u32 s43, s13, 0
  v_mov_b32 v7, 0
  s_mov_b32 s74, 0
L_lspin_54:
  ds_read_b32 v9, v7 offset:1288
  s_add_u32 s74, s74, 1
  s_cmp_gt_u32 s74, 1048576
  s_cbranch_scc1 L_lsdone_55
  s_waitcnt lgkmcnt(0)
  v_cmp_gt_u32 vcc, 4, v9
  s_nop 3
  s_cbranch_vccnz L_lspin_54
L_lsdone_55:
  s_waitcnt lgkmcnt(0)
  s_lshr_b32 s60, s55, 4
  s_mul_i32 s51, s60, 1966080
  s_sub_u32 s51, 98304, s51
  s_mul_i32 s60, s60, 20
  s_lshr_b32 s61, s57, 1
  s_add_u32 s60, s60, s61
  s_mul_i32 s48, s60, 49152
  s_mul_i32 s45, s61, 3072
  s_and_b32 s61, s57, 1
  s_mul_i32 s61, s61, 79904
  s_add_u32 s45, s45, s61
  s_add_u32 s45, s45, 2048
  v_add_u32 v7, s45, v0
  s_waitcnt vmcnt(8)
  s_barrier
  s_waitcnt vmcnt(0)
  s_barrier
  s_add_u32 m0, s67, 77824
  s_nop 0
  buffer_load_dwordx4 v8, s[20:23], s66 offen lds
  s_add_u32 s66, s66, 61440
  s_add_u32 m0, s67, 81920
  s_nop 0
  buffer_load_dwordx4 v8, s[20:23], s66 offen lds
  s_add_u32 s66, s66, 61440
  s_add_u32 m0, s67, 86016
  s_nop 0
  buffer_load_dwordx4 v8, s[20:23], s66 offen lds
  s_add_u32 s66, s66, 61440
  s_add_u32 m0, s67, 90112
  s_nop 0
  buffer_load_dwordx4 v8, s[20:23], s66 offen lds
  s_add_u32 s66, s66, s65
  s_add_u32 m0, s67, 94208
  s_nop 0
  buffer_load_dwordx4 v8, s[20:23], s66 offen lds
  s_add_u32 s66, s66, 61440
  s_add_u32 m0, s67, 98304
  s_nop 0
  buffer_load_dwordx4 v8, s[20:23], s66 offen lds
  s_add_u32 s66, s66, 61440
  s_add_u32 m0, s67, 102400
  s_nop 0
  buffer_load_dwordx4 v8, s[20:23], s66 offen lds
  s_add_u32 s66, s66, 61440
  s_add_u32 m0, s67, 106496
  s_nop 0
  buffer_load_dwordx4 v8, s[20:23], s66 offen lds
  s_add_u32 s66, s66, 61440
  s_waitcnt vmcnt(0)
  s_barrier
  s_add_u32 m0, s67, 110592
  s_nop 0
  buffer_load_dwordx4 v8, s[20:23], s66 offen lds
  s_add_u32 s66, s66, 61440
  s_add_u32 m0, s67, 114688
  s_nop 0
  buffer_load_dwordx4 v8, s[20:23], s66 offen lds
  s_add_u32 s66, s66, 61440
  s_add_u32 m0, s67, 118784
  s_nop 0
  buffer_load_dwordx4 v8, s[20:23], s66 offen lds
  s_add_u32 s66, s66, 61440
  s_add_u32 m0, s67, 122880
  s_nop 0
  buffer_load_dwordx4 v8, s[20:23], s66 offen lds
  s_add_u32 s66, s66, 61440
  s_add_u32 m0, s67, 126976
  s_nop 0
  buffer_load_dwordx4 v8, s[20:23], s66 offen lds
  s_add_u32 s66, s66, 61440
  s_add_u32 m0, s67, 131072
  s_nop 0
  buffer_load_dwordx4 v8, s[20:23], s66 offen lds
  s_add_u32 s66, s66, 61440
  s_add_u32 m0, s67, 135168
  s_nop 0
  buffer_load_dwordx4 v8, s[20:23], s66 offen lds
  s_add_u32 s66, s66, 61440
  s_add_u32 m0, s67, 139264
  s_nop 0
  buffer_load_dwordx4 v8, s[20:23], s66 offen lds
  s_add_u32 s66, s66, 61440
  s_waitcnt vmcnt(0)
  s_barrier
  s_add_u32 m0, s67, 143360
  s_nop 0
  buffer_load_dwordx4 v8, s[20:23], s66 offen lds
  s_add_u32 s66, s66, 61440
  s_add_u32 m0, s67, 147456
  s_nop 0
  buffer_load_dwordx4 v8, s[20:23], s66 offen lds
  s_add_u32 s66, s66, 61440
  s_add_u32 m0, s67, 151552
  s_nop 0
  buffer_load_dwordx4 v8, s[20:23], s66 offen lds
  s_add_u32 s66, s66, 61440
  s_add_u32 m0, s67, 155648
  s_nop 0
  buffer_load_dwordx4 v8, s[20:23], s66 offen lds
  s_add_u32 s66, s66, 61440
  s_add_u32 m0, s67, 159744
  s_nop 0
  buffer_load_dwordx4 v8, s[20:23], s66 offen lds
  s_add_u32 s66, s66, 61440
  s_add_u32 m0, s67, 12288
  s_nop 0
  buffer_load_dwordx4 v8, s[20:23], s66 offen lds
  s_add_u32 s66, s66, 61440
  s_add_u32 m0, s67, 16384
  s_nop 0
  buffer_load_dwordx4 v8, s[20:23], s66 offen lds
  s_add_u32 s66, s66, 61440
  s_add_u32 m0, s67, 20480
  s_nop 0
  buffer_load_dwordx4 v8, s[20:23], s66 offen lds
  s_waitcnt vmcnt(0)
  s_barrier
  v_mov_b32 v88, 0x3f80
  v_mov_b32 v89, 0
  v_mov_b32 v90, 0x3f80
  v_mov_b32 v91, 0
  v_add_u32 v2, s67, v0
  s_barrier
  ds_write_b128 v2, v[88:91] offset:53888
  s_waitcnt lgkmcnt(0)
  s_barrier
  s_add_u32 s62, s77, 0
  s_cmp_ge_u32 s62, 5
  s_cselect_b32 s63, 5, 0
  s_sub_u32 s62, s62, s63
  s_lshl_b32 s62, s62, 2
  s_add_u32 s62, s62, s57
  s_mul_i32 s63, s62, 40960
  s_mul_i32 s62, s62, 5120
  s_add_u32 s62, s62, 58112
  s_add_u32 m0, s62, 0
  s_nop 0
  buffer_load_dwordx4 v10, s[16:19], s63 offen lds
  s_add_u32 m0, s62, 1024
  s_nop 0
  buffer_load_dwordx4 v11, s[16:19], s63 offen lds
  s_add_u32 m0, s62, 2048
  s_nop 0
  buffer_load_dwordx4 v12, s[16:19], s63 offen lds
  s_add_u32 m0, s62, 3072
  s_nop 0
  buffer_load_dwordx4 v13, s[16:19], s63 offen lds
  s_add_u32 m0, s62, 4096
  s_nop 0
  buffer_load_dwordx4 v14, s[16:19], s63 offen lds
  s_add_u32 s62, s77, 1
  s_cmp_ge_u32 s62, 5
  s_cselect_b32 s63, 5, 0
  s_sub_u32 s62, s62, s63
  s_lshl_b32 s62, s62, 2
  s_add_u32 s62, s62, s57
  s_mul_i32 s63, s62, 40960
  s_mul_i32 s62, s62, 5120
  s_add_u32 s62, s62, 58112
  s_add_u32 m0, s62, 0
  s_nop 0
  buffer_load_dwordx4 v10, s[16:19], s63 offen lds
  s_add_u32 m0, s62, 1024
  s_nop 0
  buffer_load_dwordx4 v11, s[16:19], s63 offen lds
  s_add_u32 m0, s62, 2048
  s_nop 0
  buffer_load_dwordx4 v12, s[16:19], s63 offen lds
  s_add_u32 m0, s62, 3072
  s_nop 0
  buffer_load_dwordx4 v13, s[16:19], s63 offen lds
  s_add_u32 m0, s62, 4096
  s_nop 0
  buffer_load_dwordx4 v14, s[16:19], s63 offen lds
  s_add_u32 s62, s77, 2
  s_cmp_ge_u32 s62, 5
  s_cselect_b32 s63, 5, 0
  s_sub_u32 s62, s62, s63
  s_lshl_b32 s62, s62, 2
  s_add_u32 s62, s62, s57
  s_mul_i32 s63, s62, 40960
  s_mul_i32 s62, s62, 5120
  s_add_u32 s62, s62, 58112
  s_add_u32 m0, s62, 0
  s_nop 0
  buffer_load_dwordx4 v10, s[16:19], s63 offen lds
  s_add_u32 m0, s62, 1024
  s_nop 0
  buffer_load_dwordx4 v11, s[16:19], s63 offen lds
  s_add_u32 m0, s62, 2048
  s_nop 0
  buffer_load_dwordx4 v12, s[16:19], s63 offen lds
  s_add_u32 m0, s62, 3072
  s_nop 0
  buffer_load_dwordx4 v13, s[16:19], s63 offen lds
  s_add_u32 m0, s62, 4096
  s_nop 0
  buffer_load_dwordx4 v14, s[16:19], s63 offen lds
  s_add_u32 s62, s77, 3
  s_cmp_ge_u32 s62, 5
  s_cselect_b32 s63, 5, 0
  s_sub_u32 s62, s62, s63
  s_lshl_b32 s62, s62, 2
  s_add_u32 s62, s62, s57
  s_mul_i32 s63, s62, 40960
  s_mul_i32 s62, s62, 5120
  s_add_u32 s62, s62, 58112
  s_add_u32 m0, s62, 0
  s_nop 0
  buffer_load_dwordx4 v10, s[16:19], s63 offen lds
  s_add_u32 m0, s62, 1024
  s_nop 0
  buffer_load_dwordx4 v11, s[16:19], s63 offen lds
  s_add_u32 m0, s62, 2048
  s_nop 0
  buffer_load_dwordx4 v12, s[16:19], s63 offen lds
  s_add_u32 m0, s62, 3072
  s_nop 0
  buffer_load_dwordx4 v13, s[16:19], s63 offen lds
  s_add_u32 m0, s62, 4096
  s_nop 0
  buffer_load_dwordx4 v14, s[16:19], s63 offen lds
  s_add_u32 s62, s77, 4
  s_cmp_ge_u32 s62, 5
  s_cselect_b32 s63, 5, 0
  s_sub_u32 s62, s62, s63
  s_lshl_b32 s62, s62, 2
  s_add_u32 s62, s62, s57
  s_mul_i32 s63, s62, 40960
  s_mul_i32 s62, s62, 5120
  s_add_u32 s62, s62, 58112
  s_add_u32 m0, s62, 0
  s_nop 0
  buffer_load_dwordx4 v10, s[16:19], s63 offen lds
  s_add_u32 m0, s62, 1024
  s_nop 0
  buffer_load_dwordx4 v11, s[16:19], s63 offen lds
  s_add_u32 m0, s62, 2048
  s_nop 0
  buffer_load_dwordx4 v12, s[16:19], s63 offen lds
  s_add_u32 m0, s62, 3072
  s_nop 0
  buffer_load_dwordx4 v13, s[16:19], s63 offen lds
  s_add_u32 m0, s62, 4096
  s_nop 0
  buffer_load_dwordx4 v14, s[16:19], s63 offen lds
  buffer_load_dwordx4 v[16:19], v4, s[24:27], s48 offen
  buffer_load_dwordx4 v[20:23], v5, s[24:27], s48 offen
  buffer_load_dwordx4 v[24:27], v6, s[24:27], s48 offen
  s_add_u32 s48, s48, 98304
  buffer_load_dwordx4 v[28:31], v4, s[24:27], s48 offen
  buffer_load_dwordx4 v[32:35], v5, s[24:27], s48 offen
  buffer_load_dwordx4 v[36:39], v6, s[24:27], s48 offen
  s_add_u32 s48, s48, 98304
  buffer_load_dwordx4 v[40:43], v4, s[24:27], s48 offen
  buffer_load_dwordx4 v[44:47], v5, s[24:27], s48 offen
  buffer_load_dwordx4 v[48:51], v6, s[24:27], s48 offen
  s_add_u32 s48, s48, 98304
  s_waitcnt vmcnt(9)
  s_barrier
  s_barrier
  buffer_load_dwordx4 v[52:55], v4, s[24:27], s48 offen
  buffer_load_dwordx4 v[56:59], v5, s[24:27], s48 offen
  buffer_load_dwordx4 v[60:63], v6, s[24:27], s48 offen
  s_add_u32 s48, s48, 98304
  buffer_load_dwordx4 v[64:67], v4, s[24:27], s48 offen
  buffer_load_dwordx4 v[68:71], v5, s[24:27], s48 offen
  buffer_load_dwordx4 v[72:75], v6, s[24:27], s48 offen
  s_add_u32 s48, s48, 98304
  buffer_load_dwordx4 v[76:79], v4, s[24:27], s48 offen
  buffer_load_dwordx4 v[80:83], v5, s[24:27], s48 offen
  buffer_load_dwordx4 v[84:87], v6, s[24:27], s48 offen
  s_add_u32 s48, s48, 98304
  s_barrier
  s_waitcnt vmcnt(17)
  ds_write_b128 v7, v[16:19] offset:0
  s_waitcnt vmcnt(16)
  ds_write_b128 v7, v[20:23] offset:1024
  s_waitcnt vmcnt(15)
  ds_write_b128 v7, v[24:27] offset:2048
  s_waitcnt vmcnt(14)
  ds_write_b128 v7, v[28:31] offset:6144
  s_waitcnt vmcnt(13)
  ds_write_b128 v7, v[32:35] offset:7168
  s_waitcnt vmcnt(12)
  ds_write_b128 v7, v[36:39] offset:8192
  s_waitcnt vmcnt(11)
  ds_write_b128 v7, v[40:43] offset:12288
  s_waitcnt vmcnt(10)
  ds_write_b128 v7, v[44:47] offset:13312
  s_waitcnt vmcnt(9)
  ds_write_b128 v7, v[48:51] offset:14336
  s_waitcnt vmcnt(8)
  ds_write_b128 v7, v[52:55] offset:18432
  s_waitcnt vmcnt(7)
  ds_write_b128 v7, v[56:59] offset:19456
  s_waitcnt vmcnt(6)
  ds_write_b128 v7, v[60:63] offset:20480
  s_waitcnt vmcnt(5)
  ds_write_b128 v7, v[64:67] offset:24576
  s_waitcnt vmcnt(4)
  ds_write_b128 v7, v[68:71] offset:25600
  s_waitcnt vmcnt(3)
  ds_write_b128 v7, v[72:75] offset:26624
  v_mov_b32 v8, 0
  s_mov_b32 s74, 0
L_lspin_56:
  ds_read_b32 v9, v8 offset:1292
  s_add_u32 s74, s74, 1
  s_cmp_gt_u32 s74, 1048576
  s_cbranch_scc1 L_lsdone_57
  s_waitcnt lgkmcnt(0)
  v_cmp_gt_u32 vcc, 4, v9
  s_nop 3
  s_cbranch_vccnz L_lspin_56
L_lsdone_57:
  s_waitcnt lgkmcnt(0)
  s_waitcnt lgkmcnt(0)
  s_barrier
  s_waitcnt vmcnt(2)
  ds_write_b128 v7, v[76:79] offset:30720
  s_waitcnt vmcnt(1)
  ds_write_b128 v7, v[80:83] offset:31744
  s_waitcnt vmcnt(0)
  ds_write_b128 v7, v[84:87] offset:32768
  s_add_u32 m0, s45, 36864
  s_nop 0
  buffer_load_dwordx4 v4, s[24:27], s48 offen lds
  s_add_u32 m0, s45, 37888
  s_nop 0
  buffer_load_dwordx4 v5, s[24:27], s48 offen lds
  s_add_u32 m0, s45, 38912
  s_nop 0
  buffer_load_dwordx4 v6, s[24:27], s48 offen lds
  s_add_u32 s48, s48, 98304
  s_add_u32 m0, s45, 43008
  s_nop 0
  buffer_load_dwordx4 v4, s[24:27], s48 offen lds
  s_add_u32 m0, s45, 44032
  s_nop 0
  buffer_load_dwordx4 v5, s[24:27], s48 offen lds
  s_add_u32 m0, s45, 45056
  s_nop 0
  buffer_load_dwordx4 v6, s[24:27], s48 offen lds
  s_add_u32 s48, s48, 98304
  s_add_u32 m0, s45, 49152
  s_nop 0
  buffer_load_dwordx4 v4, s[24:27], s48 offen lds
  s_add_u32 m0, s45, 50176
  s_nop 0
  buffer_load_dwordx4 v5, s[24:27], s48 offen lds
  s_add_u32 m0, s45, 51200
  s_nop 0
  buffer_load_dwordx4 v6, s[24:27], s48 offen lds
  s_add_u32 s48, s48, 98304
  s_add_u32 m0, s45, 55296
  s_nop 0
  buffer_load_dwordx4 v4, s[24:27], s48 offen lds
  s_add_u32 m0, s45, 56320
  s_nop 0
  buffer_load_dwordx4 v5, s[24:27], s48 offen lds
  s_add_u32 m0, s45, 57344
  s_nop 0
  buffer_load_dwordx4 v6, s[24:27], s48 offen lds
  s_add_u32 s48, s48, s51
  s_add_u32 m0, s45, 61440
  s_nop 0
  buffer_load_dwordx4 v4, s[24:27], s48 offen lds
  s_add_u32 m0, s45, 62464
  s_nop 0
  buffer_load_dwordx4 v5, s[24:27], s48 offen lds
  s_add_u32 m0, s45, 63488
  s_nop 0
  buffer_load_dwordx4 v6, s[24:27], s48 offen lds
  s_add_u32 s48, s48, 98304
  s_waitcnt vmcnt(9)
  s_waitcnt lgkmcnt(0)
  s_barrier
  s_add_u32 m0, s45, 67584
  s_nop 0
  buffer_load_dwordx4 v4, s[24:27], s48 offen lds
  s_add_u32 m0, s45, 68608
  s_nop 0
  buffer_load_dwordx4 v5, s[24:27], s48 offen lds
  s_add_u32 m0, s45, 69632
  s_nop 0
  buffer_load_dwordx4 v6, s[24:27], s48 offen lds
  s_add_u32 s48, s48, 98304
  s_add_u32 m0, s45, 73728
  s_nop 0
  buffer_load_dwordx4 v4, s[24:27], s48 offen lds
  s_add_u32 m0, s45, 74752
  s_nop 0
  buffer_load_dwordx4 v5, s[24:27], s48 offen lds
  s_add_u32 m0, s45, 75776
  s_nop 0
  buffer_load_dwordx4 v6, s[24:27], s48 offen lds
  s_add_u32 s48, s48, 98304
  s_add_u32 m0, s45, 0
  s_nop 0
  buffer_load_dwordx4 v4, s[24:27], s48 offen lds
  s_add_u32 m0, s45, 1024
  s_nop 0
  buffer_load_dwordx4 v5, s[24:27], s48 offen lds
  s_add_u32 m0, s45, 2048
  s_nop 0
  buffer_load_dwordx4 v6, s[24:27], s48 offen lds
  s_add_u32 s48, s48, 98304
  s_waitcnt vmcnt(9)
  s_waitcnt lgkmcnt(0)
  s_barrier
  s_add_u32 m0, s45, 6144
  s_nop 0
  buffer_load_dwordx4 v4, s[24:27], s48 offen lds
  s_add_u32 m0, s45, 7168
  s_nop 0
  buffer_load_dwordx4 v5, s[24:27], s48 offen lds
  s_add_u32 m0, s45, 8192
  s_nop 0
  buffer_load_dwordx4 v6, s[24:27], s48 offen lds
  s_add_u32 s48, s48, 98304
  s_add_u32 m0, s45, 12288
  s_nop 0
  buffer_load_dwordx4 v4, s[24:27], s48 offen lds
  s_add_u32 m0, s45, 13312
  s_nop 0
  buffer_load_dwordx4 v5, s[24:27], s48 offen lds
  s_add_u32 m0, s45, 14336
  s_nop 0
  buffer_load_dwordx4 v6, s[24:27], s48 offen lds
  s_add_u32 s48, s48, 98304
  s_add_u32 m0, s45, 18432
  s_nop 0
  buffer_load_dwordx4 v4, s[24:27], s48 offen lds
  s_add_u32 m0, s45, 19456
  s_nop 0
  buffer_load_dwordx4 v5, s[24:27], s48 offen lds
  s_add_u32 m0, s45, 20480
  s_nop 0
  buffer_load_dwordx4 v6, s[24:27], s48 offen lds
  s_add_u32 s48, s48, 98304
  s_waitcnt vmcnt(9)
  s_waitcnt lgkmcnt(0)
  s_barrier
  s_add_u32 m0, s45, 24576
  s_nop 0
  buffer_load_dwordx4 v4, s[24:27], s48 offen lds
  s_add_u32 m0, s45, 25600
  s_nop 0
  buffer_load_dwordx4 v5, s[24:27], s48 offen lds
  s_add_u32 m0, s45, 26624
  s_nop 0
  buffer_load_dwordx4 v6, s[24:27], s48 offen lds
  s_add_u32 s48, s48, 98304
  s_add_u32 m0, s45, 30720
  s_nop 0
  buffer_load_dwordx4 v4, s[24:27], s48 offen lds
  s_add_u32 m0, s45, 31744
  s_nop 0
  buffer_load_dwordx4 v5, s[24:27], s48 offen lds
  s_add_u32 m0, s45, 32768
  s_nop 0
  buffer_load_dwordx4 v6, s[24:27], s48 offen lds
  s_add_u32 s48, s48, 98304
  s_waitcnt vmcnt(9)
  s_waitcnt lgkmcnt(0)
  s_barrier
  s_add_u32 m0, s45, 36864
  s_nop 0
  buffer_load_dwordx4 v4, s[24:27], s48 offen lds
  s_add_u32 m0, s45, 37888
  s_nop 0
  buffer_load_dwordx4 v5, s[24:27], s48 offen lds
  s_add_u32 m0, s45, 38912
  s_nop 0
  buffer_load_dwordx4 v6, s[24:27], s48 offen lds
  s_waitcnt vmcnt(0)
  s_waitcnt lgkmcnt(0)
  s_barrier
  s_and_b32 s64, s77, 1
  s_lshr_b32 s65, s77, 1
  s_mul_i32 s65, s65, 3
  s_mul_i32 s66, s64, 24
  s_lshl_b32 s61, s65, 2
  s_add_u32 s66, s66, s61
  s_add_u32 s66, s66, s57
  s_mul_i32 s66, s66, 40960
  s_sub_u32 s65, 5, s65
  s_mul_i32 s67, s57, 5120
  s_add_u32 s67, s67, 2048
  v_add_u32 v4, s67, v0
  buffer_load_dwordx4 v[16:19], v10, s[32:35], s66 offen
  buffer_load_dwordx4 v[20:23], v11, s[32:35], s66 offen
  buffer_load_dwordx4 v[24:27], v12, s[32:35], s66 offen
  buffer_load_dwordx4 v[28:31], v13, s[32:35], s66 offen
  buffer_load_dwordx4 v[32:35], v14, s[32:35], s66 offen
  s_cmp_eq_u32 s65, 0
  s_cselect_b32 s62, -5, 1
  s_mul_i32 s62, s62, 163840
  s_add_u32 s66, s66, s62
  buffer_load_dwordx4 v[36:39], v10, s[32:35], s66 offen
  buffer_load_dwordx4 v[40:43], v11, s[32:35], s66 offen
  buffer_load_dwordx4 v[44:47], v12, s[32:35], s66 offen
  buffer_load_dwordx4 v[48:51], v13, s[32:35], s66 offen
  buffer_load_dwordx4 v[52:55], v14, s[32:35], s66 offen
  s_cmp_eq_u32 s65, 1
  s_cselect_b32 s62, -5, 1
  s_mul_i32 s62, s62, 163840
  s_add_u32 s66, s66, s62
  s_barrier
  s_add_u32 s61, s67, 40960
  s_add_u32 m0, s61, 0
  s_nop 0
  buffer_load_dwordx4 v10, s[32:35], s66 offen lds
  s_add_u32 m0, s61, 1024
  s_nop 0
  buffer_load_dwordx4 v11, s[32:35], s66 offen lds
  s_add_u32 m0, s61, 2048
  s_nop 0
  buffer_load_dwordx4 v12, s[32:35], s66 offen lds
  s_add_u32 m0, s61, 3072
  s_nop 0
  buffer_load_dwordx4 v13, s[32:35], s66 offen lds
  s_add_u32 m0, s61, 4096
  s_nop 0
  buffer_load_dwordx4 v14, s[32:35], s66 offen lds
  s_cmp_eq_u32 s65, 2
  s_cselect_b32 s62, -5, 1
  s_mul_i32 s62, s62, 163840
  s_add_u32 s66, s66, s62
  s_add_u32 s61, s67, 61440
  s_add_u32 m0, s61, 0
  s_nop 0
  buffer_load_dwordx4 v10, s[32:35], s66 offen lds
  s_add_u32 m0, s61, 1024
  s_nop 0
  buffer_load_dwordx4 v11, s[32:35], s66 offen lds
  s_add_u32 m0, s61, 2048
  s_nop 0
  buffer_load_dwordx4 v12, s[32:35], s66 offen lds
  s_add_u32 m0, s61, 3072
  s_nop 0
  buffer_load_dwordx4 v13, s[32:35], s66 offen lds
  s_add_u32 m0, s61, 4096
  s_nop 0
  buffer_load_dwordx4 v14, s[32:35], s66 offen lds
  s_cmp_eq_u32 s65, 3
  s_cselect_b32 s62, -5, 1
  s_mul_i32 s62, s62, 163840
  s_add_u32 s66, s66, s62
  s_add_u32 s61, s67, 81920
  s_add_u32 m0, s61, 0
  s_nop 0
  buffer_load_dwordx4 v10, s[32:35], s66 offen lds
  s_add_u32 m0, s61, 1024
  s_nop 0
  buffer_load_dwordx4 v11, s[32:35], s66 offen lds
  s_add_u32 m0, s61, 2048
  s_nop 0
  buffer_load_dwordx4 v12, s[32:35], s66 offen lds
  s_add_u32 m0, s61, 3072
  s_nop 0
  buffer_load_dwordx4 v13, s[32:35], s66 offen lds
  s_add_u32 m0, s61, 4096
  s_nop 0
  buffer_load_dwordx4 v14, s[32:35], s66 offen lds
  s_cmp_eq_u32 s65, 4
  s_cselect_b32 s62, -5, 1
  s_mul_i32 s62, s62, 163840
  s_add_u32 s66, s66, s62
  s_add_u32 s61, s67, 102400
  s_add_u32 m0, s61, 0
  s_nop 0
  buffer_load_dwordx4 v10, s[32:35], s66 offen lds
  s_add_u32 m0, s61, 1024
  s_nop 0
  buffer_load_dwordx4 v11, s[32:35], s66 offen lds
  s_add_u32 m0, s61, 2048
  s_nop 0
  buffer_load_dwordx4 v12, s[32:35], s66 offen lds
  s_add_u32 m0, s61, 3072
  s_nop 0
  buffer_load_dwordx4 v13, s[32:35], s66 offen lds
  s_add_u32 m0, s61, 4096
  s_nop 0
  buffer_load_dwordx4 v14, s[32:35], s66 offen lds
  s_waitcnt vmcnt(29)
  ds_write_b128 v4, v[16:19] offset:0
  s_waitcnt vmcnt(28)
  ds_write_b128 v4, v[20:23] offset:1024
  s_waitcnt vmcnt(27)
  ds_write_b128 v4, v[24:27] offset:2048
  s_waitcnt vmcnt(26)
  ds_write_b128 v4, v[28:31] offset:3072
  s_waitcnt vmcnt(25)
  ds_write_b128 v4, v[32:35] offset:4096
  s_waitcnt vmcnt(24)
  ds_write_b128 v4, v[36:39] offset:20480
  s_waitcnt vmcnt(23)
  ds_write_b128 v4, v[40:43] offset:21504
  s_waitcnt vmcnt(22)
  ds_write_b128 v4, v[44:47] offset:22528
  s_waitcnt vmcnt(21)
  ds_write_b128 v4, v[48:51] offset:23552
  s_waitcnt vmcnt(20)
  ds_write_b128 v4, v[52:55] offset:24576
  s_waitcnt lgkmcnt(0)
  s_barrier
  s_waitcnt vmcnt(15)
  s_waitcnt vmcnt(10)
  s_waitcnt lgkmcnt(0)
  s_barrier
  s_waitcnt vmcnt(5)
  s_waitcnt vmcnt(0)
  s_waitcnt lgkmcnt(0)
  s_barrier
  s_lshl_b32 s60, s2, 2
  s_add_u32 s60, s60, s57
  s_cmp_lg_u32 s60, 0
  s_cbranch_scc1 L_noepoch_58
  s_mov_b32 s61, 36872
  s_mov_b32 s74, 0
L_poll_59:
  buffer_load_dword v6, v0, s[12:15], s61 offen offset:0 sc1
  buffer_load_dword v7, v0, s[12:15], s61 offen offset:1024 sc1
  buffer_load_dword v8, v0, s[12:15], s61 offen offset:2048 sc1
  buffer_load_dword v9, v0, s[12:15], s61 offen offset:3072 sc1
  s_add_u32 s74, s74, 1
  s_cmp_gt_u32 s74, 131072
  s_cbranch_scc1 L_pdone_60
  s_waitcnt vmcnt(0)
  v_cmp_ne_u32 vcc, s52, v6
  v_cmp_ne_u32 s[68:69], s52, v7
  s_nop 0
  s_or_b64 vcc, vcc, s[68:69]
  v_cmp_ne_u32 s[68:69], s52, v8
  s_nop 0
  s_or_b64 vcc, vcc, s[68:69]
  v_cmp_ne_u32 s[68:69], s52, v9
  s_nop 0
  s_or_b64 vcc, vcc, s[68:69]
  s_nop 1
  s_cbranch_vccnz L_poll_59
L_pdone_60:
  s_waitcnt vmcnt(0)
  v_mov_b32 v2, 0
  v_mov_b32 v3, s52
  s_mov_b64 exec, 1
  buffer_store_dword v3, v2, s[12:15], 0 offen offset:0 sc1
  s_mov_b64 exec, -1
L_noepoch_58:
  s_endpgm
L_end:
  s_endpgm
.section .rodata,"a"
.p2align 6
.amdhsa_kernel adaLN_cond__sliding_block__glu_gated_glu__prompt_kernel
  .amdhsa_next_free_vgpr 256
  .amdhsa_next_free_sgpr 102
  .amdhsa_accum_offset 256
  .amdhsa_group_segment_fixed_size 0
  .amdhsa_kernarg_size 96
  .amdhsa_user_sgpr_count 2
  .amdhsa_user_sgpr_kernarg_segment_ptr 1
  .amdhsa_system_sgpr_workgroup_id_x 1
.end_amdhsa_kernel
```
